```python
import torch

def _softmax(x, axis=-1):
    return torch.softmax(x, dim=axis)
def _gelu(x):
    return torch.nn.functional.gelu(x, approximate="tanh")
def _silu(x):
    return torch.nn.functional.silu(x)
def _sigmoid(x):
    return torch.sigmoid(x)
def _layernorm(x, axis=-1, eps=1e-5):
    m = x.mean(dim=axis, keepdim=True)
    v = x.var(dim=axis, keepdim=True, unbiased=False)
    return (x - m) / torch.sqrt(v + eps)
def _scatter_add(tgt, idx, src, axis=0):
    return tgt.clone().index_add_(axis, idx, src)
def _segment_sum(src, seg, n):
    out = torch.zeros((n,) + src.shape[1:], dtype=src.dtype)
    return out.index_add_(0, seg, src)
def _pad(x, pw):
    flat = tuple(v for pair in reversed(pw) for v in pair)
    return torch.nn.functional.pad(x, flat)

kernel_name = 'parallel_sum__softmax_full_mha__dense_activation_squared_relu__prompt'

def setup_inputs():

    _w = (lambda a: (lambda t: t.to(torch.bfloat16) if t.is_floating_point() else t)(torch.as_tensor(a)))
    def _A_setup():
        B, S, D = 1, 2048, 640
        return {
            "x": _w((lambda *s: torch.randn(*s, dtype=torch.bfloat16) * 0.05)(B, S, D)),
            "wqkv": _w((lambda *s: torch.randn(*s, dtype=torch.bfloat16) * 0.2)(D, 3 * D)),
            "wo": _w((lambda *s: torch.randn(*s, dtype=torch.bfloat16) * 0.1)(D, D)),
        }
    _A_in = _A_setup()

    def _B_setup():
        B, S, D, F = 1, 2048, 640, 1536
        return {
            "x": _w((lambda *s: torch.randn(*s, dtype=torch.bfloat16) * 0.05)(B, S, D)),
            "w1": _w((lambda *s: torch.randn(*s, dtype=torch.bfloat16) * 0.1)(D, F)),
            "b1": _w((lambda *s: torch.randn(*s, dtype=torch.bfloat16) * 0.1)(F)),
            "w2": _w((lambda *s: torch.randn(*s, dtype=torch.bfloat16) * 0.1)(F, D)),
            "b2": _w((lambda *s: torch.randn(*s, dtype=torch.bfloat16) * 0.1)(D)),
        }
    _B_in = _B_setup()

    return {
        "A_x": _A_in["x"],
        "A_wqkv": _A_in["wqkv"],
        "A_wo": _A_in["wo"],
        "B_x": _B_in["x"],
        "B_w1": _B_in["w1"],
        "B_b1": _B_in["b1"],
        "B_w2": _B_in["w2"],
        "B_b2": _B_in["b2"],
    }

def reference(A_x, A_wqkv, A_wo, B_x, B_w1, B_b1, B_w2, B_b2):
    def _A_ref(x, wqkv, wo):
        B, S, D = x.shape
        H = 32; Dh = D // H
        qkv = (lambda x, *d: x.permute(*d))((x @ wqkv).reshape(B, S, 3, H, Dh), 2, 0, 3, 1, 4)
        q, k, v = qkv[0], qkv[1], qkv[2]
        scale = Dh ** -0.5
        scores = torch.einsum("bhqd,bhkd->bhqk", q, k) * scale
        p = _softmax(scores, axis=-1)
        o = torch.einsum("bhqk,bhkd->bhqd", p, v)
        return (lambda x, *d: x.permute(*d))(o, 0, 2, 1, 3).reshape(B, S, D) @ wo

    def _B_ref(x, w1, b1, w2, b2):
        h = torch.einsum("bsd,df->bsf", x, w1) + b1
        zero = torch.zeros_like(h)
        r = torch.where(h > zero, h, zero)
        h = r * r
        out = torch.einsum("bsf,fd->bsd", h, w2) + b2
        return out

    x = A_x
    xn = _layernorm(x, axis=-1)
    return x + _A_ref(xn, A_wqkv, A_wo) + _B_ref(xn, B_w1, B_b1, B_w2, B_b2)
```

```asm
; @launch kernel=k1_kernel grid=(256,1,1) block=(512,1,1) lds=149504
; @launch kernel=k2_kernel grid=(768,1,1) block=(256,1,1) lds=53248
.amdgcn_target "amdgcn-amd-amdhsa--gfx950"
.text
.globl k1_kernel
.p2align 8
.type k1_kernel,@function
k1_kernel:
    s_cmp_ge_u32 s2, 256
    s_cbranch_scc1 .k1end_1
    s_cmp_lt_u32 s2, 32
    s_cbranch_scc1 .k1st_2
    s_cmp_ge_u32 s2, 248
    s_cbranch_scc1 .k1pr_3
    s_sub_u32 s41, s2, 32
    s_and_b32 s39, s41, 7
    s_lshr_b32 s40, s41, 3
    s_lshr_b32 s33, s39, 1
    s_mul_i32 s33, s33, 27
    s_add_u32 s33, s33, s40
    s_and_b32 s32, s33, 3
    s_lshr_b32 s33, s33, 2
    s_and_b32 s39, s39, 1
    s_lshl_b32 s39, s39, 2
    s_add_u32 s32, s32, s39
    s_load_dwordx2 s[4:5], s[0:1], 0
    s_load_dwordx2 s[6:7], s[0:1], 8
    s_load_dwordx4 s[8:11], s[0:1], 32
    s_load_dwordx2 s[12:13], s[0:1], 80
    s_load_dwordx2 s[14:15], s[0:1], 72
    v_and_b32 v1, 63, v0
    v_lshrrev_b32 v2, 6, v0
    s_nop 0
    v_readfirstlane_b32 s34, v2
    s_nop 3
    s_lshr_b32 s35, s34, 1
    s_and_b32 s36, s34, 1
    s_mov_b32 s53, s36
    s_xor_b32 s54, s36, 1
    s_and_b32 s55, s35, 1
    s_xor_b32 s56, s55, 1
    s_lshl_b32 s39, s32, 8
    s_lshl_b32 s40, s34, 5
    s_add_u32 s39, s39, s40
    s_mul_i32 s39, s39, 1280
    v_lshrrev_b32 v2, 3, v1
    v_mul_u32_u24 v3, 1280, v2
    v_add_u32 v3, s39, v3
    v_lshrrev_b32 v4, 4, v1
    v_and_b32 v5, 7, v1
    v_xor_b32 v4, v4, v5
    v_xor_b32 v5, 0, v4
    v_lshlrev_b32 v5, 4, v5
    v_add_u32 v6, v3, v5
    v_xor_b32 v5, 4, v4
    v_lshlrev_b32 v5, 4, v5
    v_add_u32 v7, v3, v5
    v_add_u32 v7, 9216, v7
    v_xor_b32 v5, 0, v4
    v_lshlrev_b32 v5, 4, v5
    v_add_u32 v8, v3, v5
    v_add_u32 v8, 18432, v8
    v_xor_b32 v5, 4, v4
    v_lshlrev_b32 v5, 4, v5
    v_add_u32 v9, v3, v5
    v_add_u32 v9, 27648, v9
    s_cmp_ge_u32 s33, 15
    s_mov_b32 s37, 3840
    s_cselect_b32 s37, 3072, s37
    s_cselect_b32 s39, 15, 0
    s_sub_u32 s38, s33, s39
    s_lshl_b32 s38, s38, 8
    v_lshrrev_b32 v2, 4, v1
    s_mul_i32 s39, s34, 8
    v_add_u32 v3, s39, v2
    v_mul_lo_u32 v3, v3, s37
    v_add_u32 v3, s38, v3
    v_bfe_u32 v4, v1, 2, 2
    v_xor_b32 v4, v4, v2
    v_lshlrev_b32 v4, 6, v4
    v_and_b32 v5, 3, v1
    v_lshlrev_b32 v5, 4, v5
    v_add3_u32 v10, v3, v4, v5
    s_lshl_b32 s39, s37, 2
    s_sub_u32 s39, s39, 1024
    v_add_u32 v11, s39, v10
    s_lshl_b32 s52, s37, 6
    s_lshl_b32 s50, s34, 12
    s_mul_i32 s51, s34, 2048
    s_add_u32 s51, s51, 32768
    s_waitcnt lgkmcnt(0)
    s_mov_b32 s16, s4
    s_mov_b32 s17, s5
    s_mov_b32 s18, 2621440
    s_mov_b32 s19, 0x00020000
    s_cmp_ge_u32 s33, 15
    s_cbranch_scc1 .e1f_4
    s_mov_b32 s20, s6
    s_mov_b32 s21, s7
    s_mov_b32 s22, 2457600
    s_mov_b32 s23, 0x00020000
    s_branch .e1w_5
.e1f_4:
    s_mov_b32 s20, s8
    s_mov_b32 s21, s9
    s_mov_b32 s22, 1966080
    s_mov_b32 s23, 0x00020000
.e1w_5:
    s_add_u32 m0, s50, 0
    s_mov_b32 s42, 0
    buffer_load_dwordx4 v6, s[16:19], s42 offen offset:0 lds
    buffer_load_dwordx4 v7, s[16:19], s42 offen offset:1024 lds
    buffer_load_dwordx4 v8, s[16:19], s42 offen offset:2048 lds
    buffer_load_dwordx4 v9, s[16:19], s42 offen offset:3072 lds
    s_add_u32 m0, s51, 0
    s_mul_i32 s43, s52, 0
    buffer_load_dwordx4 v10, s[20:23], s43 offen offset:0 lds
    buffer_load_dwordx4 v11, s[20:23], s43 offen offset:1024 lds
    s_add_u32 m0, s50, 49152
    s_mov_b32 s42, 128
    buffer_load_dwordx4 v6, s[16:19], s42 offen offset:0 lds
    buffer_load_dwordx4 v7, s[16:19], s42 offen offset:1024 lds
    buffer_load_dwordx4 v8, s[16:19], s42 offen offset:2048 lds
    buffer_load_dwordx4 v9, s[16:19], s42 offen offset:3072 lds
    s_add_u32 m0, s51, 49152
    s_mul_i32 s43, s52, 1
    buffer_load_dwordx4 v10, s[20:23], s43 offen offset:0 lds
    buffer_load_dwordx4 v11, s[20:23], s43 offen offset:1024 lds
    s_mov_b32 s28, s10
    s_mov_b32 s29, s11
    s_mov_b32 s30, 3072
    s_mov_b32 s31, 0x00020000
    s_lshl_b32 s40, s36, 7
    s_add_u32 s39, s38, s40
    v_lshrrev_b32 v2, 5, v1
    v_lshlrev_b32 v2, 3, v2
    v_add_u32 v2, s39, v2
    s_lshl_b32 s40, s55, 6
    buffer_load_dwordx2 v[16:17], v2, s[28:31], s40 offen offset:0
    buffer_load_dwordx2 v[18:19], v2, s[28:31], s40 offen offset:16
    buffer_load_dwordx2 v[20:21], v2, s[28:31], s40 offen offset:32
    buffer_load_dwordx2 v[22:23], v2, s[28:31], s40 offen offset:48
    s_lshl_b32 s40, s56, 6
    buffer_load_dwordx2 v[24:25], v2, s[28:31], s40 offen offset:0
    buffer_load_dwordx2 v[26:27], v2, s[28:31], s40 offen offset:16
    buffer_load_dwordx2 v[28:29], v2, s[28:31], s40 offen offset:32
    buffer_load_dwordx2 v[30:31], v2, s[28:31], s40 offen offset:48
    s_add_u32 s60, s12, 28311552
    s_addc_u32 s61, s13, 0
    s_mov_b32 s62, 16384
    s_mov_b32 s63, 0x00020000
    s_lshl_b32 s39, s32, 8
    s_lshl_b32 s40, s35, 6
    s_add_u32 s39, s39, s40
    s_lshr_b32 s68, s39, 7
    v_and_b32 v2, 31, v1
    v_add_u32 v2, s39, v2
    v_lshlrev_b32 v86, 2, v2
    v_lshrrev_b32 v2, 5, v1
    v_lshlrev_b32 v2, 2, v2
    v_add_u32 v2, s39, v2
    v_lshlrev_b32 v87, 2, v2
    s_mov_b32 s64, s14
    s_mov_b32 s65, s15
    s_mov_b32 s66, 256
    s_mov_b32 s67, 0x00020000
    s_lshl_b32 s39, s68, 2
    v_mov_b32 v84, s39
    v_and_b32 v88, 31, v1
    v_lshlrev_b32 v88, 2, v88
    v_lshrrev_b32 v89, 5, v1
    v_lshlrev_b32 v89, 4, v89
    s_cmp_ge_u32 s33, 10
    s_cselect_b32 s39, 1, 0
    s_cmp_lt_u32 s33, 15
    s_cselect_b32 s40, 1, 0
    s_and_b32 s39, s39, s40
    s_cmp_eq_u32 s39, 1
    s_cbranch_scc1 .setV_7
    s_cmp_ge_u32 s33, 15
    s_cbranch_scc1 .setF_8
    s_cmp_ge_u32 s33, 5
    s_cbranch_scc1 .e1K_9
    s_mov_b32 s24, s12
    s_mov_b32 s25, s13
    s_mov_b32 s26, 3145728
    s_mov_b32 s27, 0x00020000
    s_mov_b32 s45, 98304
    s_mov_b32 s57, 1536
    s_lshl_b32 s47, s33, 4
    s_branch .e1QK_10
.e1K_9:
    s_add_u32 s24, s12, 3145728
    s_addc_u32 s25, s13, 0
    s_mov_b32 s26, 6291456
    s_mov_b32 s27, 0x00020000
    s_mov_b32 s45, 196608
    s_mov_b32 s57, 3072
    s_sub_u32 s47, s33, 5
    s_lshl_b32 s47, s47, 4
.e1QK_10:
    s_mul_i32 s39, s32, 8
    s_lshl_b32 s40, s35, 1
    s_add_u32 s39, s39, s40
    v_lshlrev_b32 v2, 2, v88
    s_add_u32 s40, s39, s53
    s_mul_i32 s40, s40, s57
    v_add_u32 v90, s40, v2
    s_add_u32 s40, s39, s54
    s_mul_i32 s40, s40, s57
    v_add_u32 v91, s40, v2
    s_lshl_b32 s39, s36, 3
    s_add_u32 s47, s47, s39
    v_lshrrev_b32 v2, 5, v1
    s_lshl_b32 s46, s45, 1
    s_sub_u32 s41, s45, 1536
    s_lshl_b32 s39, s55, 2
    s_add_u32 s39, s39, s47
    s_add_u32 s39, s39, 0
    v_add_u32 v94, s39, v2
    v_mul_u32_u24 v95, 205, v94
    v_lshrrev_b32 v95, 10, v95
    v_mul_u32_u24 v3, 5, v95
    v_sub_u32 v94, v94, v3
    v_mul_lo_u32 v95, v95, s46
    v_lshlrev_b32 v3, 9, v94
    v_add_u32 v95, v95, v3
    v_cmp_le_u32 vcc, 3, v94
    v_mov_b32 v3, s41
    s_nop 0
    v_cndmask_b32 v3, 0, v3, vcc
    v_add_u32 v96, v95, v3
    s_lshl_b32 s39, s55, 2
    s_add_u32 s39, s39, s47
    s_add_u32 s39, s39, 2
    v_add_u32 v94, s39, v2
    v_mul_u32_u24 v95, 205, v94
    v_lshrrev_b32 v95, 10, v95
    v_mul_u32_u24 v3, 5, v95
    v_sub_u32 v94, v94, v3
    v_mul_lo_u32 v95, v95, s46
    v_lshlrev_b32 v3, 9, v94
    v_add_u32 v95, v95, v3
    v_cmp_le_u32 vcc, 3, v94
    v_mov_b32 v3, s41
    s_nop 0
    v_cndmask_b32 v3, 0, v3, vcc
    v_add_u32 v97, v95, v3
    s_lshl_b32 s39, s56, 2
    s_add_u32 s39, s39, s47
    s_add_u32 s39, s39, 0
    v_add_u32 v94, s39, v2
    v_mul_u32_u24 v95, 205, v94
    v_lshrrev_b32 v95, 10, v95
    v_mul_u32_u24 v3, 5, v95
    v_sub_u32 v94, v94, v3
    v_mul_lo_u32 v95, v95, s46
    v_lshlrev_b32 v3, 9, v94
    v_add_u32 v95, v95, v3
    v_cmp_le_u32 vcc, 3, v94
    v_mov_b32 v3, s41
    s_nop 0
    v_cndmask_b32 v3, 0, v3, vcc
    v_add_u32 v98, v95, v3
    s_lshl_b32 s39, s56, 2
    s_add_u32 s39, s39, s47
    s_add_u32 s39, s39, 2
    v_add_u32 v94, s39, v2
    v_mul_u32_u24 v95, 205, v94
    v_lshrrev_b32 v95, 10, v95
    v_mul_u32_u24 v3, 5, v95
    v_sub_u32 v94, v94, v3
    v_mul_lo_u32 v95, v95, s46
    v_lshlrev_b32 v3, 9, v94
    v_add_u32 v95, v95, v3
    v_cmp_le_u32 vcc, 3, v94
    v_mov_b32 v3, s41
    s_nop 0
    v_cndmask_b32 v3, 0, v3, vcc
    v_add_u32 v99, v95, v3
    s_branch .setdone_6
.setF_8:
    s_add_u32 s24, s12, 9437184
    s_addc_u32 s25, s13, 0
    s_mov_b32 s26, 6291456
    s_mov_b32 s27, 0x00020000
    v_bfe_u32 v2, v1, 4, 1
    v_mul_u32_u24 v2, 49152, v2
    v_lshlrev_b32 v3, 4, v89
    v_and_b32 v4, 15, v1
    v_lshlrev_b32 v4, 4, v4
    v_add3_u32 v2, v2, v3, v4
    s_mul_i32 s39, s32, 16
    s_lshl_b32 s40, s35, 2
    s_add_u32 s39, s39, s40
    s_lshl_b32 s40, s53, 1
    s_add_u32 s40, s40, s39
    s_mul_i32 s40, s40, 49152
    v_add_u32 v90, s40, v2
    s_lshl_b32 s40, s54, 1
    s_add_u32 s40, s40, s39
    s_mul_i32 s40, s40, 49152
    v_add_u32 v91, s40, v2
    s_sub_u32 s39, s33, 15
    s_lshl_b32 s39, s39, 2
    s_lshl_b32 s40, s36, 1
    s_add_u32 s39, s39, s40
    s_add_u32 s45, s39, s55
    s_lshl_b32 s45, s45, 10
    s_add_u32 s46, s39, s56
    s_lshl_b32 s46, s46, 10
    s_branch .setdone_6
.setV_7:
    s_add_u32 s24, s12, 3145728
    s_addc_u32 s25, s13, 0
    s_mov_b32 s26, 6291456
    s_mov_b32 s27, 0x00020000
    s_sub_u32 s39, s33, 10
    s_lshl_b32 s39, s39, 7
    s_lshl_b32 s40, s36, 6
    s_add_u32 s47, s39, s40
    v_and_b32 v94, 31, v1
    v_lshrrev_b32 v92, 5, v1
    v_mul_u32_u24 v92, 384, v92
    v_add_u32 v92, 1536, v92
    s_mov_b32 s45, 196608
    s_lshl_b32 s39, s55, 5
    s_add_u32 s39, s39, s47
    v_add_u32 v5, s39, v94
    v_mul_u32_u24 v95, 3277, v5
    v_lshrrev_b32 v95, 16, v95
    v_mul_u32_u24 v3, 20, v95
    v_sub_u32 v5, v5, v3
    v_mul_lo_u32 v95, v95, s45
    v_lshlrev_b32 v5, 4, v5
    v_add3_u32 v90, v95, v5, v92
    s_lshl_b32 s39, s56, 5
    s_add_u32 s39, s39, s47
    v_add_u32 v5, s39, v94
    v_mul_u32_u24 v95, 3277, v5
    v_lshrrev_b32 v95, 16, v95
    v_mul_u32_u24 v3, 20, v95
    v_sub_u32 v5, v5, v3
    v_mul_lo_u32 v95, v95, s45
    v_lshlrev_b32 v5, 4, v5
    v_add3_u32 v91, v95, v5, v92
.setdone_6:
    v_and_b32 v2, 31, v1
    s_lshl_b32 s39, s35, 6
    v_add_u32 v2, s39, v2
    v_lshlrev_b32 v3, 7, v2
    v_bfe_u32 v4, v2, 1, 3
    v_lshrrev_b32 v5, 5, v1
    v_xor_b32 v4, v4, v5
    s_lshl_b32 s39, s53, 12
    s_lshl_b32 s40, s54, 12
    v_xor_b32 v5, 0, v4
    v_lshlrev_b32 v5, 4, v5
    v_add_u32 v5, v3, v5
    v_add_u32 v100, s39, v5
    v_add_u32 v104, s40, v5
    v_add_u32 v108, 49152, v100
    v_add_u32 v112, 49152, v104
    v_add_u32 v116, 98304, v100
    v_add_u32 v120, 98304, v104
    v_xor_b32 v5, 2, v4
    v_lshlrev_b32 v5, 4, v5
    v_add_u32 v5, v3, v5
    v_add_u32 v101, s39, v5
    v_add_u32 v105, s40, v5
    v_add_u32 v109, 49152, v101
    v_add_u32 v113, 49152, v105
    v_add_u32 v117, 98304, v101
    v_add_u32 v121, 98304, v105
    v_xor_b32 v5, 4, v4
    v_lshlrev_b32 v5, 4, v5
    v_add_u32 v5, v3, v5
    v_add_u32 v102, s39, v5
    v_add_u32 v106, s40, v5
    v_add_u32 v110, 49152, v102
    v_add_u32 v114, 49152, v106
    v_add_u32 v118, 98304, v102
    v_add_u32 v122, 98304, v106
    v_xor_b32 v5, 6, v4
    v_lshlrev_b32 v5, 4, v5
    v_add_u32 v5, v3, v5
    v_add_u32 v103, s39, v5
    v_add_u32 v107, s40, v5
    v_add_u32 v111, 49152, v103
    v_add_u32 v115, 49152, v107
    v_add_u32 v119, 98304, v103
    v_add_u32 v123, 98304, v107
    v_bfe_u32 v2, v1, 2, 2
    v_lshrrev_b32 v3, 5, v1
    v_lshlrev_b32 v3, 3, v3
    v_add_u32 v3, v3, v2
    v_lshlrev_b32 v3, 8, v3
    v_bfe_u32 v4, v1, 4, 1
    v_lshlrev_b32 v4, 5, v4
    v_add_u32 v3, v3, v4
    v_and_b32 v4, 3, v1
    v_lshlrev_b32 v4, 3, v4
    v_add_u32 v3, v3, v4
    s_lshl_b32 s39, s36, 1
    s_add_u32 s40, s39, s55
    v_xor_b32 v4, s40, v2
    v_lshlrev_b32 v4, 6, v4
    v_add_u32 v124, v3, v4
    v_add_u32 v126, 49152, v124
    v_add_u32 v128, 98304, v124
    s_add_u32 s40, s39, s56
    v_xor_b32 v4, s40, v2
    v_lshlrev_b32 v4, 6, v4
    v_add_u32 v125, v3, v4
    v_add_u32 v127, 49152, v125
    v_add_u32 v129, 98304, v125
    v_and_b32 v2, 15, v1
    v_bfe_u32 v3, v1, 4, 1
    v_cmp_eq_u32 vcc, v2, v3
    v_mov_b32 v4, 0x3f803f80
    s_nop 0
    v_cndmask_b32 v232, 0, v4, vcc
    v_cndmask_b32 v233, 0, v4, vcc
    v_cndmask_b32 v234, 0, v4, vcc
    v_cndmask_b32 v235, 0, v4, vcc
    s_cmp_ge_u32 s33, 10
    s_cselect_b32 s39, 1, 0
    s_cmp_lt_u32 s33, 15
    s_cselect_b32 s40, 1, 0
    s_and_b32 s49, s39, s40
    s_cmp_eq_u32 s49, 1
    s_cbranch_scc1 .e1v_11
    s_cmp_ge_u32 s35, 2
    s_cbranch_scc1 .nocs_14
    s_waitcnt vmcnt(14)
    s_waitcnt lgkmcnt(0)
    s_barrier
    ds_read_b64_tr_b16 v[212:213], v124 offset:32768
    ds_read_b64_tr_b16 v[214:215], v124 offset:33792
    ds_read_b128 v[196:199], v100 offset:0
    ds_read_b128 v[200:203], v104 offset:0
    ds_read_b64_tr_b16 v[216:217], v125 offset:32768
    ds_read_b64_tr_b16 v[218:219], v125 offset:33792
    s_waitcnt lgkmcnt(3)
    v_mfma_f32_32x32x16_bf16 v[132:147], v[212:215], v[196:199], 0
    ds_read_b64_tr_b16 v[220:221], v124 offset:36864
    ds_read_b64_tr_b16 v[222:223], v124 offset:37888
    s_add_u32 m0, s50, 98304
    s_mov_b32 s42, 256
    buffer_load_dwordx4 v6, s[16:19], s42 offen offset:0 lds
    s_waitcnt lgkmcnt(4)
    v_mfma_f32_32x32x16_bf16 v[148:163], v[212:215], v[200:203], 0
    ds_read_b128 v[204:207], v101 offset:0
    ds_read_b128 v[208:211], v105 offset:0
    v_mfma_f32_16x16x32_bf16 v[228:231], v[212:215], v[232:235], 0
    buffer_load_dwordx4 v7, s[16:19], s42 offen offset:1024 lds
    s_waitcnt lgkmcnt(4)
    v_mfma_f32_32x32x16_bf16 v[164:179], v[216:219], v[196:199], 0
    ds_read_b64_tr_b16 v[224:225], v125 offset:36864
    ds_read_b64_tr_b16 v[226:227], v125 offset:37888
    v_mfma_f32_32x32x16_bf16 v[180:195], v[216:219], v[200:203], 0
    s_waitcnt lgkmcnt(3)
    v_mfma_f32_32x32x16_bf16 v[132:147], v[220:223], v[204:207], v[132:147]
    ds_read_b64_tr_b16 v[212:213], v124 offset:40960
    ds_read_b64_tr_b16 v[214:215], v124 offset:41984
    buffer_load_dwordx4 v8, s[16:19], s42 offen offset:2048 lds
    s_waitcnt lgkmcnt(4)
    v_mfma_f32_32x32x16_bf16 v[148:163], v[220:223], v[208:211], v[148:163]
    ds_read_b128 v[196:199], v102 offset:0
    ds_read_b128 v[200:203], v106 offset:0
    v_mfma_f32_16x16x32_bf16 v[228:231], v[220:223], v[232:235], v[228:231]
    buffer_load_dwordx4 v9, s[16:19], s42 offen offset:3072 lds
    s_waitcnt lgkmcnt(4)
    v_mfma_f32_32x32x16_bf16 v[164:179], v[224:227], v[204:207], v[164:179]
    ds_read_b64_tr_b16 v[216:217], v125 offset:40960
    ds_read_b64_tr_b16 v[218:219], v125 offset:41984
    v_mfma_f32_32x32x16_bf16 v[180:195], v[224:227], v[208:211], v[180:195]
    s_waitcnt lgkmcnt(3)
    v_mfma_f32_32x32x16_bf16 v[132:147], v[212:215], v[196:199], v[132:147]
    ds_read_b64_tr_b16 v[220:221], v124 offset:45056
    ds_read_b64_tr_b16 v[222:223], v124 offset:46080
    s_add_u32 m0, s51, 98304
    s_mul_i32 s43, s52, 2
    buffer_load_dwordx4 v10, s[20:23], s43 offen offset:0 lds
    s_waitcnt lgkmcnt(4)
    v_mfma_f32_32x32x16_bf16 v[148:163], v[212:215], v[200:203], v[148:163]
    ds_read_b128 v[204:207], v103 offset:0
    ds_read_b128 v[208:211], v107 offset:0
    v_mfma_f32_16x16x32_bf16 v[228:231], v[212:215], v[232:235], v[228:231]
    buffer_load_dwordx4 v11, s[20:23], s43 offen offset:1024 lds
    s_waitcnt lgkmcnt(4)
    v_mfma_f32_32x32x16_bf16 v[164:179], v[216:219], v[196:199], v[164:179]
    ds_read_b64_tr_b16 v[224:225], v125 offset:45056
    ds_read_b64_tr_b16 v[226:227], v125 offset:46080
    v_mfma_f32_32x32x16_bf16 v[180:195], v[216:219], v[200:203], v[180:195]
    s_waitcnt vmcnt(14)
    s_barrier
    s_waitcnt lgkmcnt(3)
    v_mfma_f32_32x32x16_bf16 v[132:147], v[220:223], v[204:207], v[132:147]
    ds_read_b64_tr_b16 v[212:213], v126 offset:32768
    ds_read_b64_tr_b16 v[214:215], v126 offset:33792
    s_waitcnt lgkmcnt(4)
    v_mfma_f32_32x32x16_bf16 v[148:163], v[220:223], v[208:211], v[148:163]
    ds_read_b128 v[196:199], v108 offset:0
    ds_read_b128 v[200:203], v112 offset:0
    v_mfma_f32_16x16x32_bf16 v[228:231], v[220:223], v[232:235], v[228:231]
    s_waitcnt lgkmcnt(4)
    v_mfma_f32_32x32x16_bf16 v[164:179], v[224:227], v[204:207], v[164:179]
    ds_read_b64_tr_b16 v[216:217], v127 offset:32768
    ds_read_b64_tr_b16 v[218:219], v127 offset:33792
    v_mfma_f32_32x32x16_bf16 v[180:195], v[224:227], v[208:211], v[180:195]
    s_barrier
    s_waitcnt lgkmcnt(3)
    v_mfma_f32_32x32x16_bf16 v[132:147], v[212:215], v[196:199], v[132:147]
    ds_read_b64_tr_b16 v[220:221], v126 offset:36864
    ds_read_b64_tr_b16 v[222:223], v126 offset:37888
    s_add_u32 m0, s50, 0
    s_mov_b32 s42, 384
    buffer_load_dwordx4 v6, s[16:19], s42 offen offset:0 lds
    s_waitcnt lgkmcnt(4)
    v_mfma_f32_32x32x16_bf16 v[148:163], v[212:215], v[200:203], v[148:163]
    ds_read_b128 v[204:207], v109 offset:0
    ds_read_b128 v[208:211], v113 offset:0
    v_mfma_f32_16x16x32_bf16 v[228:231], v[212:215], v[232:235], v[228:231]
    buffer_load_dwordx4 v7, s[16:19], s42 offen offset:1024 lds
    s_waitcnt lgkmcnt(4)
    v_mfma_f32_32x32x16_bf16 v[164:179], v[216:219], v[196:199], v[164:179]
    ds_read_b64_tr_b16 v[224:225], v127 offset:36864
    ds_read_b64_tr_b16 v[226:227], v127 offset:37888
    v_mfma_f32_32x32x16_bf16 v[180:195], v[216:219], v[200:203], v[180:195]
    s_waitcnt lgkmcnt(3)
    v_mfma_f32_32x32x16_bf16 v[132:147], v[220:223], v[204:207], v[132:147]
    ds_read_b64_tr_b16 v[212:213], v126 offset:40960
    ds_read_b64_tr_b16 v[214:215], v126 offset:41984
    buffer_load_dwordx4 v8, s[16:19], s42 offen offset:2048 lds
    s_waitcnt lgkmcnt(4)
    v_mfma_f32_32x32x16_bf16 v[148:163], v[220:223], v[208:211], v[148:163]
    ds_read_b128 v[196:199], v110 offset:0
    ds_read_b128 v[200:203], v114 offset:0
    v_mfma_f32_16x16x32_bf16 v[228:231], v[220:223], v[232:235], v[228:231]
    buffer_load_dwordx4 v9, s[16:19], s42 offen offset:3072 lds
    s_waitcnt lgkmcnt(4)
    v_mfma_f32_32x32x16_bf16 v[164:179], v[224:227], v[204:207], v[164:179]
    ds_read_b64_tr_b16 v[216:217], v127 offset:40960
    ds_read_b64_tr_b16 v[218:219], v127 offset:41984
    v_mfma_f32_32x32x16_bf16 v[180:195], v[224:227], v[208:211], v[180:195]
    s_waitcnt lgkmcnt(3)
    v_mfma_f32_32x32x16_bf16 v[132:147], v[212:215], v[196:199], v[132:147]
    ds_read_b64_tr_b16 v[220:221], v126 offset:45056
    ds_read_b64_tr_b16 v[222:223], v126 offset:46080
    s_add_u32 m0, s51, 0
    s_mul_i32 s43, s52, 3
    buffer_load_dwordx4 v10, s[20:23], s43 offen offset:0 lds
    s_waitcnt lgkmcnt(4)
    v_mfma_f32_32x32x16_bf16 v[148:163], v[212:215], v[200:203], v[148:163]
    ds_read_b128 v[204:207], v111 offset:0
    ds_read_b128 v[208:211], v115 offset:0
    v_mfma_f32_16x16x32_bf16 v[228:231], v[212:215], v[232:235], v[228:231]
    buffer_load_dwordx4 v11, s[20:23], s43 offen offset:1024 lds
    s_waitcnt lgkmcnt(4)
    v_mfma_f32_32x32x16_bf16 v[164:179], v[216:219], v[196:199], v[164:179]
    ds_read_b64_tr_b16 v[224:225], v127 offset:45056
    ds_read_b64_tr_b16 v[226:227], v127 offset:46080
    v_mfma_f32_32x32x16_bf16 v[180:195], v[216:219], v[200:203], v[180:195]
    s_waitcnt vmcnt(6)
    s_barrier
    s_waitcnt lgkmcnt(3)
    v_mfma_f32_32x32x16_bf16 v[132:147], v[220:223], v[204:207], v[132:147]
    ds_read_b64_tr_b16 v[212:213], v128 offset:32768
    ds_read_b64_tr_b16 v[214:215], v128 offset:33792
    s_waitcnt lgkmcnt(4)
    v_mfma_f32_32x32x16_bf16 v[148:163], v[220:223], v[208:211], v[148:163]
    ds_read_b128 v[196:199], v116 offset:0
    ds_read_b128 v[200:203], v120 offset:0
    v_mfma_f32_16x16x32_bf16 v[228:231], v[220:223], v[232:235], v[228:231]
    s_waitcnt lgkmcnt(4)
    v_mfma_f32_32x32x16_bf16 v[164:179], v[224:227], v[204:207], v[164:179]
    ds_read_b64_tr_b16 v[216:217], v129 offset:32768
    ds_read_b64_tr_b16 v[218:219], v129 offset:33792
    v_mfma_f32_32x32x16_bf16 v[180:195], v[224:227], v[208:211], v[180:195]
    s_barrier
    s_waitcnt lgkmcnt(3)
    v_mfma_f32_32x32x16_bf16 v[132:147], v[212:215], v[196:199], v[132:147]
    ds_read_b64_tr_b16 v[220:221], v128 offset:36864
    ds_read_b64_tr_b16 v[222:223], v128 offset:37888
    s_add_u32 m0, s50, 49152
    s_mov_b32 s42, 512
    buffer_load_dwordx4 v6, s[16:19], s42 offen offset:0 lds
    s_waitcnt lgkmcnt(4)
    v_mfma_f32_32x32x16_bf16 v[148:163], v[212:215], v[200:203], v[148:163]
    ds_read_b128 v[204:207], v117 offset:0
    ds_read_b128 v[208:211], v121 offset:0
    v_mfma_f32_16x16x32_bf16 v[228:231], v[212:215], v[232:235], v[228:231]
    buffer_load_dwordx4 v7, s[16:19], s42 offen offset:1024 lds
    s_waitcnt lgkmcnt(4)
    v_mfma_f32_32x32x16_bf16 v[164:179], v[216:219], v[196:199], v[164:179]
    ds_read_b64_tr_b16 v[224:225], v129 offset:36864
    ds_read_b64_tr_b16 v[226:227], v129 offset:37888
    v_mfma_f32_32x32x16_bf16 v[180:195], v[216:219], v[200:203], v[180:195]
    s_waitcnt lgkmcnt(3)
    v_mfma_f32_32x32x16_bf16 v[132:147], v[220:223], v[204:207], v[132:147]
    ds_read_b64_tr_b16 v[212:213], v128 offset:40960
    ds_read_b64_tr_b16 v[214:215], v128 offset:41984
    buffer_load_dwordx4 v8, s[16:19], s42 offen offset:2048 lds
    s_waitcnt lgkmcnt(4)
    v_mfma_f32_32x32x16_bf16 v[148:163], v[220:223], v[208:211], v[148:163]
    ds_read_b128 v[196:199], v118 offset:0
    ds_read_b128 v[200:203], v122 offset:0
    v_mfma_f32_16x16x32_bf16 v[228:231], v[220:223], v[232:235], v[228:231]
    buffer_load_dwordx4 v9, s[16:19], s42 offen offset:3072 lds
    s_waitcnt lgkmcnt(4)
    v_mfma_f32_32x32x16_bf16 v[164:179], v[224:227], v[204:207], v[164:179]
    ds_read_b64_tr_b16 v[216:217], v129 offset:40960
    ds_read_b64_tr_b16 v[218:219], v129 offset:41984
    v_mfma_f32_32x32x16_bf16 v[180:195], v[224:227], v[208:211], v[180:195]
    s_waitcnt lgkmcnt(3)
    v_mfma_f32_32x32x16_bf16 v[132:147], v[212:215], v[196:199], v[132:147]
    ds_read_b64_tr_b16 v[220:221], v128 offset:45056
    ds_read_b64_tr_b16 v[222:223], v128 offset:46080
    s_add_u32 m0, s51, 49152
    s_mul_i32 s43, s52, 4
    buffer_load_dwordx4 v10, s[20:23], s43 offen offset:0 lds
    s_waitcnt lgkmcnt(4)
    v_mfma_f32_32x32x16_bf16 v[148:163], v[212:215], v[200:203], v[148:163]
    ds_read_b128 v[204:207], v119 offset:0
    ds_read_b128 v[208:211], v123 offset:0
    v_mfma_f32_16x16x32_bf16 v[228:231], v[212:215], v[232:235], v[228:231]
    buffer_load_dwordx4 v11, s[20:23], s43 offen offset:1024 lds
    s_waitcnt lgkmcnt(4)
    v_mfma_f32_32x32x16_bf16 v[164:179], v[216:219], v[196:199], v[164:179]
    ds_read_b64_tr_b16 v[224:225], v129 offset:45056
    ds_read_b64_tr_b16 v[226:227], v129 offset:46080
    v_mfma_f32_32x32x16_bf16 v[180:195], v[216:219], v[200:203], v[180:195]
    s_waitcnt vmcnt(6)
    s_barrier
    s_waitcnt lgkmcnt(3)
    v_mfma_f32_32x32x16_bf16 v[132:147], v[220:223], v[204:207], v[132:147]
    ds_read_b64_tr_b16 v[212:213], v124 offset:32768
    ds_read_b64_tr_b16 v[214:215], v124 offset:33792
    s_waitcnt lgkmcnt(4)
    v_mfma_f32_32x32x16_bf16 v[148:163], v[220:223], v[208:211], v[148:163]
    ds_read_b128 v[196:199], v100 offset:0
    ds_read_b128 v[200:203], v104 offset:0
    v_mfma_f32_16x16x32_bf16 v[228:231], v[220:223], v[232:235], v[228:231]
    s_waitcnt lgkmcnt(4)
    v_mfma_f32_32x32x16_bf16 v[164:179], v[224:227], v[204:207], v[164:179]
    ds_read_b64_tr_b16 v[216:217], v125 offset:32768
    ds_read_b64_tr_b16 v[218:219], v125 offset:33792
    v_mfma_f32_32x32x16_bf16 v[180:195], v[224:227], v[208:211], v[180:195]
    s_barrier
    s_waitcnt lgkmcnt(3)
    v_mfma_f32_32x32x16_bf16 v[132:147], v[212:215], v[196:199], v[132:147]
    ds_read_b64_tr_b16 v[220:221], v124 offset:36864
    ds_read_b64_tr_b16 v[222:223], v124 offset:37888
    s_add_u32 m0, s50, 98304
    s_mov_b32 s42, 640
    buffer_load_dwordx4 v6, s[16:19], s42 offen offset:0 lds
    s_waitcnt lgkmcnt(4)
    v_mfma_f32_32x32x16_bf16 v[148:163], v[212:215], v[200:203], v[148:163]
    ds_read_b128 v[204:207], v101 offset:0
    ds_read_b128 v[208:211], v105 offset:0
    v_mfma_f32_16x16x32_bf16 v[228:231], v[212:215], v[232:235], v[228:231]
    buffer_load_dwordx4 v7, s[16:19], s42 offen offset:1024 lds
    s_waitcnt lgkmcnt(4)
    v_mfma_f32_32x32x16_bf16 v[164:179], v[216:219], v[196:199], v[164:179]
    ds_read_b64_tr_b16 v[224:225], v125 offset:36864
    ds_read_b64_tr_b16 v[226:227], v125 offset:37888
    v_mfma_f32_32x32x16_bf16 v[180:195], v[216:219], v[200:203], v[180:195]
    s_waitcnt lgkmcnt(3)
    v_mfma_f32_32x32x16_bf16 v[132:147], v[220:223], v[204:207], v[132:147]
    ds_read_b64_tr_b16 v[212:213], v124 offset:40960
    ds_read_b64_tr_b16 v[214:215], v124 offset:41984
    buffer_load_dwordx4 v8, s[16:19], s42 offen offset:2048 lds
    s_waitcnt lgkmcnt(4)
    v_mfma_f32_32x32x16_bf16 v[148:163], v[220:223], v[208:211], v[148:163]
    ds_read_b128 v[196:199], v102 offset:0
    ds_read_b128 v[200:203], v106 offset:0
    v_mfma_f32_16x16x32_bf16 v[228:231], v[220:223], v[232:235], v[228:231]
    buffer_load_dwordx4 v9, s[16:19], s42 offen offset:3072 lds
    s_waitcnt lgkmcnt(4)
    v_mfma_f32_32x32x16_bf16 v[164:179], v[224:227], v[204:207], v[164:179]
    ds_read_b64_tr_b16 v[216:217], v125 offset:40960
    ds_read_b64_tr_b16 v[218:219], v125 offset:41984
    v_mfma_f32_32x32x16_bf16 v[180:195], v[224:227], v[208:211], v[180:195]
    s_waitcnt lgkmcnt(3)
    v_mfma_f32_32x32x16_bf16 v[132:147], v[212:215], v[196:199], v[132:147]
    ds_read_b64_tr_b16 v[220:221], v124 offset:45056
    ds_read_b64_tr_b16 v[222:223], v124 offset:46080
    s_add_u32 m0, s51, 98304
    s_mul_i32 s43, s52, 5
    buffer_load_dwordx4 v10, s[20:23], s43 offen offset:0 lds
    s_waitcnt lgkmcnt(4)
    v_mfma_f32_32x32x16_bf16 v[148:163], v[212:215], v[200:203], v[148:163]
    ds_read_b128 v[204:207], v103 offset:0
    ds_read_b128 v[208:211], v107 offset:0
    v_mfma_f32_16x16x32_bf16 v[228:231], v[212:215], v[232:235], v[228:231]
    buffer_load_dwordx4 v11, s[20:23], s43 offen offset:1024 lds
    s_waitcnt lgkmcnt(4)
    v_mfma_f32_32x32x16_bf16 v[164:179], v[216:219], v[196:199], v[164:179]
    ds_read_b64_tr_b16 v[224:225], v125 offset:45056
    ds_read_b64_tr_b16 v[226:227], v125 offset:46080
    v_mfma_f32_32x32x16_bf16 v[180:195], v[216:219], v[200:203], v[180:195]
    s_waitcnt vmcnt(6)
    s_barrier
    s_waitcnt lgkmcnt(3)
    v_mfma_f32_32x32x16_bf16 v[132:147], v[220:223], v[204:207], v[132:147]
    ds_read_b64_tr_b16 v[212:213], v126 offset:32768
    ds_read_b64_tr_b16 v[214:215], v126 offset:33792
    s_waitcnt lgkmcnt(4)
    v_mfma_f32_32x32x16_bf16 v[148:163], v[220:223], v[208:211], v[148:163]
    ds_read_b128 v[196:199], v108 offset:0
    ds_read_b128 v[200:203], v112 offset:0
    v_mfma_f32_16x16x32_bf16 v[228:231], v[220:223], v[232:235], v[228:231]
    s_waitcnt lgkmcnt(4)
    v_mfma_f32_32x32x16_bf16 v[164:179], v[224:227], v[204:207], v[164:179]
    ds_read_b64_tr_b16 v[216:217], v127 offset:32768
    ds_read_b64_tr_b16 v[218:219], v127 offset:33792
    v_mfma_f32_32x32x16_bf16 v[180:195], v[224:227], v[208:211], v[180:195]
    s_barrier
    s_waitcnt lgkmcnt(3)
    v_mfma_f32_32x32x16_bf16 v[132:147], v[212:215], v[196:199], v[132:147]
    ds_read_b64_tr_b16 v[220:221], v126 offset:36864
    ds_read_b64_tr_b16 v[222:223], v126 offset:37888
    s_add_u32 m0, s50, 0
    s_mov_b32 s42, 768
    buffer_load_dwordx4 v6, s[16:19], s42 offen offset:0 lds
    s_waitcnt lgkmcnt(4)
    v_mfma_f32_32x32x16_bf16 v[148:163], v[212:215], v[200:203], v[148:163]
    ds_read_b128 v[204:207], v109 offset:0
    ds_read_b128 v[208:211], v113 offset:0
    v_mfma_f32_16x16x32_bf16 v[228:231], v[212:215], v[232:235], v[228:231]
    buffer_load_dwordx4 v7, s[16:19], s42 offen offset:1024 lds
    s_waitcnt lgkmcnt(4)
    v_mfma_f32_32x32x16_bf16 v[164:179], v[216:219], v[196:199], v[164:179]
    ds_read_b64_tr_b16 v[224:225], v127 offset:36864
    ds_read_b64_tr_b16 v[226:227], v127 offset:37888
    v_mfma_f32_32x32x16_bf16 v[180:195], v[216:219], v[200:203], v[180:195]
    s_waitcnt lgkmcnt(3)
    v_mfma_f32_32x32x16_bf16 v[132:147], v[220:223], v[204:207], v[132:147]
    ds_read_b64_tr_b16 v[212:213], v126 offset:40960
    ds_read_b64_tr_b16 v[214:215], v126 offset:41984
    buffer_load_dwordx4 v8, s[16:19], s42 offen offset:2048 lds
    s_waitcnt lgkmcnt(4)
    v_mfma_f32_32x32x16_bf16 v[148:163], v[220:223], v[208:211], v[148:163]
    ds_read_b128 v[196:199], v110 offset:0
    ds_read_b128 v[200:203], v114 offset:0
    v_mfma_f32_16x16x32_bf16 v[228:231], v[220:223], v[232:235], v[228:231]
    buffer_load_dwordx4 v9, s[16:19], s42 offen offset:3072 lds
    s_waitcnt lgkmcnt(4)
    v_mfma_f32_32x32x16_bf16 v[164:179], v[224:227], v[204:207], v[164:179]
    ds_read_b64_tr_b16 v[216:217], v127 offset:40960
    ds_read_b64_tr_b16 v[218:219], v127 offset:41984
    v_mfma_f32_32x32x16_bf16 v[180:195], v[224:227], v[208:211], v[180:195]
    s_waitcnt lgkmcnt(3)
    v_mfma_f32_32x32x16_bf16 v[132:147], v[212:215], v[196:199], v[132:147]
    ds_read_b64_tr_b16 v[220:221], v126 offset:45056
    ds_read_b64_tr_b16 v[222:223], v126 offset:46080
    s_add_u32 m0, s51, 0
    s_mul_i32 s43, s52, 6
    buffer_load_dwordx4 v10, s[20:23], s43 offen offset:0 lds
    s_waitcnt lgkmcnt(4)
    v_mfma_f32_32x32x16_bf16 v[148:163], v[212:215], v[200:203], v[148:163]
    ds_read_b128 v[204:207], v111 offset:0
    ds_read_b128 v[208:211], v115 offset:0
    v_mfma_f32_16x16x32_bf16 v[228:231], v[212:215], v[232:235], v[228:231]
    buffer_load_dwordx4 v11, s[20:23], s43 offen offset:1024 lds
    s_waitcnt lgkmcnt(4)
    v_mfma_f32_32x32x16_bf16 v[164:179], v[216:219], v[196:199], v[164:179]
    ds_read_b64_tr_b16 v[224:225], v127 offset:45056
    ds_read_b64_tr_b16 v[226:227], v127 offset:46080
    v_mfma_f32_32x32x16_bf16 v[180:195], v[216:219], v[200:203], v[180:195]
    s_waitcnt vmcnt(6)
    s_barrier
    s_waitcnt lgkmcnt(3)
    v_mfma_f32_32x32x16_bf16 v[132:147], v[220:223], v[204:207], v[132:147]
    ds_read_b64_tr_b16 v[212:213], v128 offset:32768
    ds_read_b64_tr_b16 v[214:215], v128 offset:33792
    s_waitcnt lgkmcnt(4)
    v_mfma_f32_32x32x16_bf16 v[148:163], v[220:223], v[208:211], v[148:163]
    ds_read_b128 v[196:199], v116 offset:0
    ds_read_b128 v[200:203], v120 offset:0
    v_mfma_f32_16x16x32_bf16 v[228:231], v[220:223], v[232:235], v[228:231]
    s_waitcnt lgkmcnt(4)
    v_mfma_f32_32x32x16_bf16 v[164:179], v[224:227], v[204:207], v[164:179]
    ds_read_b64_tr_b16 v[216:217], v129 offset:32768
    ds_read_b64_tr_b16 v[218:219], v129 offset:33792
    v_mfma_f32_32x32x16_bf16 v[180:195], v[224:227], v[208:211], v[180:195]
    buffer_load_dword v85, v84, s[64:67], 0 offen sc1
    s_barrier
    s_waitcnt lgkmcnt(3)
    v_mfma_f32_32x32x16_bf16 v[132:147], v[212:215], v[196:199], v[132:147]
    ds_read_b64_tr_b16 v[220:221], v128 offset:36864
    ds_read_b64_tr_b16 v[222:223], v128 offset:37888
    s_add_u32 m0, s50, 49152
    s_mov_b32 s42, 896
    buffer_load_dwordx4 v6, s[16:19], s42 offen offset:0 lds
    s_waitcnt lgkmcnt(4)
    v_mfma_f32_32x32x16_bf16 v[148:163], v[212:215], v[200:203], v[148:163]
    ds_read_b128 v[204:207], v117 offset:0
    ds_read_b128 v[208:211], v121 offset:0
    v_mfma_f32_16x16x32_bf16 v[228:231], v[212:215], v[232:235], v[228:231]
    buffer_load_dwordx4 v7, s[16:19], s42 offen offset:1024 lds
    s_waitcnt lgkmcnt(4)
    v_mfma_f32_32x32x16_bf16 v[164:179], v[216:219], v[196:199], v[164:179]
    ds_read_b64_tr_b16 v[224:225], v129 offset:36864
    ds_read_b64_tr_b16 v[226:227], v129 offset:37888
    v_mfma_f32_32x32x16_bf16 v[180:195], v[216:219], v[200:203], v[180:195]
    s_waitcnt lgkmcnt(3)
    v_mfma_f32_32x32x16_bf16 v[132:147], v[220:223], v[204:207], v[132:147]
    ds_read_b64_tr_b16 v[212:213], v128 offset:40960
    ds_read_b64_tr_b16 v[214:215], v128 offset:41984
    buffer_load_dwordx4 v8, s[16:19], s42 offen offset:2048 lds
    s_waitcnt lgkmcnt(4)
    v_mfma_f32_32x32x16_bf16 v[148:163], v[220:223], v[208:211], v[148:163]
    ds_read_b128 v[196:199], v118 offset:0
    ds_read_b128 v[200:203], v122 offset:0
    v_mfma_f32_16x16x32_bf16 v[228:231], v[220:223], v[232:235], v[228:231]
    buffer_load_dwordx4 v9, s[16:19], s42 offen offset:3072 lds
    s_waitcnt lgkmcnt(4)
    v_mfma_f32_32x32x16_bf16 v[164:179], v[224:227], v[204:207], v[164:179]
    ds_read_b64_tr_b16 v[216:217], v129 offset:40960
    ds_read_b64_tr_b16 v[218:219], v129 offset:41984
    v_mfma_f32_32x32x16_bf16 v[180:195], v[224:227], v[208:211], v[180:195]
    s_waitcnt lgkmcnt(3)
    v_mfma_f32_32x32x16_bf16 v[132:147], v[212:215], v[196:199], v[132:147]
    ds_read_b64_tr_b16 v[220:221], v128 offset:45056
    ds_read_b64_tr_b16 v[222:223], v128 offset:46080
    s_add_u32 m0, s51, 49152
    s_mul_i32 s43, s52, 7
    buffer_load_dwordx4 v10, s[20:23], s43 offen offset:0 lds
    s_waitcnt lgkmcnt(4)
    v_mfma_f32_32x32x16_bf16 v[148:163], v[212:215], v[200:203], v[148:163]
    ds_read_b128 v[204:207], v119 offset:0
    ds_read_b128 v[208:211], v123 offset:0
    v_mfma_f32_16x16x32_bf16 v[228:231], v[212:215], v[232:235], v[228:231]
    buffer_load_dwordx4 v11, s[20:23], s43 offen offset:1024 lds
    s_waitcnt lgkmcnt(4)
    v_mfma_f32_32x32x16_bf16 v[164:179], v[216:219], v[196:199], v[164:179]
    ds_read_b64_tr_b16 v[224:225], v129 offset:45056
    ds_read_b64_tr_b16 v[226:227], v129 offset:46080
    v_mfma_f32_32x32x16_bf16 v[180:195], v[216:219], v[200:203], v[180:195]
    s_waitcnt vmcnt(7)
    s_barrier
    s_waitcnt lgkmcnt(3)
    v_mfma_f32_32x32x16_bf16 v[132:147], v[220:223], v[204:207], v[132:147]
    ds_read_b64_tr_b16 v[212:213], v124 offset:32768
    ds_read_b64_tr_b16 v[214:215], v124 offset:33792
    s_waitcnt lgkmcnt(4)
    v_mfma_f32_32x32x16_bf16 v[148:163], v[220:223], v[208:211], v[148:163]
    ds_read_b128 v[196:199], v100 offset:0
    ds_read_b128 v[200:203], v104 offset:0
    v_mfma_f32_16x16x32_bf16 v[228:231], v[220:223], v[232:235], v[228:231]
    s_waitcnt lgkmcnt(4)
    v_mfma_f32_32x32x16_bf16 v[164:179], v[224:227], v[204:207], v[164:179]
    ds_read_b64_tr_b16 v[216:217], v125 offset:32768
    ds_read_b64_tr_b16 v[218:219], v125 offset:33792
    v_mfma_f32_32x32x16_bf16 v[180:195], v[224:227], v[208:211], v[180:195]
    s_barrier
    s_waitcnt lgkmcnt(3)
    v_mfma_f32_32x32x16_bf16 v[132:147], v[212:215], v[196:199], v[132:147]
    ds_read_b64_tr_b16 v[220:221], v124 offset:36864
    ds_read_b64_tr_b16 v[222:223], v124 offset:37888
    s_add_u32 m0, s50, 98304
    s_mov_b32 s42, 1024
    buffer_load_dwordx4 v6, s[16:19], s42 offen offset:0 lds
    s_waitcnt lgkmcnt(4)
    v_mfma_f32_32x32x16_bf16 v[148:163], v[212:215], v[200:203], v[148:163]
    ds_read_b128 v[204:207], v101 offset:0
    ds_read_b128 v[208:211], v105 offset:0
    v_mfma_f32_16x16x32_bf16 v[228:231], v[212:215], v[232:235], v[228:231]
    buffer_load_dwordx4 v7, s[16:19], s42 offen offset:1024 lds
    s_waitcnt lgkmcnt(4)
    v_mfma_f32_32x32x16_bf16 v[164:179], v[216:219], v[196:199], v[164:179]
    ds_read_b64_tr_b16 v[224:225], v125 offset:36864
    ds_read_b64_tr_b16 v[226:227], v125 offset:37888
    v_mfma_f32_32x32x16_bf16 v[180:195], v[216:219], v[200:203], v[180:195]
    s_waitcnt lgkmcnt(3)
    v_mfma_f32_32x32x16_bf16 v[132:147], v[220:223], v[204:207], v[132:147]
    ds_read_b64_tr_b16 v[212:213], v124 offset:40960
    ds_read_b64_tr_b16 v[214:215], v124 offset:41984
    buffer_load_dwordx4 v8, s[16:19], s42 offen offset:2048 lds
    s_waitcnt lgkmcnt(4)
    v_mfma_f32_32x32x16_bf16 v[148:163], v[220:223], v[208:211], v[148:163]
    ds_read_b128 v[196:199], v102 offset:0
    ds_read_b128 v[200:203], v106 offset:0
    v_mfma_f32_16x16x32_bf16 v[228:231], v[220:223], v[232:235], v[228:231]
    buffer_load_dwordx4 v9, s[16:19], s42 offen offset:3072 lds
    s_waitcnt lgkmcnt(4)
    v_mfma_f32_32x32x16_bf16 v[164:179], v[224:227], v[204:207], v[164:179]
    ds_read_b64_tr_b16 v[216:217], v125 offset:40960
    ds_read_b64_tr_b16 v[218:219], v125 offset:41984
    v_mfma_f32_32x32x16_bf16 v[180:195], v[224:227], v[208:211], v[180:195]
    s_waitcnt lgkmcnt(3)
    v_mfma_f32_32x32x16_bf16 v[132:147], v[212:215], v[196:199], v[132:147]
    ds_read_b64_tr_b16 v[220:221], v124 offset:45056
    ds_read_b64_tr_b16 v[222:223], v124 offset:46080
    s_add_u32 m0, s51, 98304
    s_mul_i32 s43, s52, 8
    buffer_load_dwordx4 v10, s[20:23], s43 offen offset:0 lds
    s_waitcnt lgkmcnt(4)
    v_mfma_f32_32x32x16_bf16 v[148:163], v[212:215], v[200:203], v[148:163]
    ds_read_b128 v[204:207], v103 offset:0
    ds_read_b128 v[208:211], v107 offset:0
    v_mfma_f32_16x16x32_bf16 v[228:231], v[212:215], v[232:235], v[228:231]
    buffer_load_dwordx4 v11, s[20:23], s43 offen offset:1024 lds
    s_waitcnt lgkmcnt(4)
    v_mfma_f32_32x32x16_bf16 v[164:179], v[216:219], v[196:199], v[164:179]
    ds_read_b64_tr_b16 v[224:225], v125 offset:45056
    ds_read_b64_tr_b16 v[226:227], v125 offset:46080
    v_mfma_f32_32x32x16_bf16 v[180:195], v[216:219], v[200:203], v[180:195]
    s_waitcnt vmcnt(6)
    s_barrier
    s_waitcnt lgkmcnt(3)
    v_mfma_f32_32x32x16_bf16 v[132:147], v[220:223], v[204:207], v[132:147]
    ds_read_b64_tr_b16 v[212:213], v126 offset:32768
    ds_read_b64_tr_b16 v[214:215], v126 offset:33792
    s_waitcnt lgkmcnt(4)
    v_mfma_f32_32x32x16_bf16 v[148:163], v[220:223], v[208:211], v[148:163]
    ds_read_b128 v[196:199], v108 offset:0
    ds_read_b128 v[200:203], v112 offset:0
    v_mfma_f32_16x16x32_bf16 v[228:231], v[220:223], v[232:235], v[228:231]
    s_waitcnt lgkmcnt(4)
    v_mfma_f32_32x32x16_bf16 v[164:179], v[224:227], v[204:207], v[164:179]
    ds_read_b64_tr_b16 v[216:217], v127 offset:32768
    ds_read_b64_tr_b16 v[218:219], v127 offset:33792
    v_mfma_f32_32x32x16_bf16 v[180:195], v[224:227], v[208:211], v[180:195]
    s_barrier
    s_waitcnt lgkmcnt(3)
    v_mfma_f32_32x32x16_bf16 v[132:147], v[212:215], v[196:199], v[132:147]
    ds_read_b64_tr_b16 v[220:221], v126 offset:36864
    ds_read_b64_tr_b16 v[222:223], v126 offset:37888
    s_add_u32 m0, s50, 0
    s_mov_b32 s42, 1152
    buffer_load_dwordx4 v6, s[16:19], s42 offen offset:0 lds
    s_waitcnt lgkmcnt(4)
    v_mfma_f32_32x32x16_bf16 v[148:163], v[212:215], v[200:203], v[148:163]
    ds_read_b128 v[204:207], v109 offset:0
    ds_read_b128 v[208:211], v113 offset:0
    v_mfma_f32_16x16x32_bf16 v[228:231], v[212:215], v[232:235], v[228:231]
    buffer_load_dwordx4 v7, s[16:19], s42 offen offset:1024 lds
    s_waitcnt lgkmcnt(4)
    v_mfma_f32_32x32x16_bf16 v[164:179], v[216:219], v[196:199], v[164:179]
    ds_read_b64_tr_b16 v[224:225], v127 offset:36864
    ds_read_b64_tr_b16 v[226:227], v127 offset:37888
    v_mfma_f32_32x32x16_bf16 v[180:195], v[216:219], v[200:203], v[180:195]
    s_waitcnt lgkmcnt(3)
    v_mfma_f32_32x32x16_bf16 v[132:147], v[220:223], v[204:207], v[132:147]
    ds_read_b64_tr_b16 v[212:213], v126 offset:40960
    ds_read_b64_tr_b16 v[214:215], v126 offset:41984
    buffer_load_dwordx4 v8, s[16:19], s42 offen offset:2048 lds
    s_waitcnt lgkmcnt(4)
    v_mfma_f32_32x32x16_bf16 v[148:163], v[220:223], v[208:211], v[148:163]
    ds_read_b128 v[196:199], v110 offset:0
    ds_read_b128 v[200:203], v114 offset:0
    v_mfma_f32_16x16x32_bf16 v[228:231], v[220:223], v[232:235], v[228:231]
    buffer_load_dwordx4 v9, s[16:19], s42 offen offset:3072 lds
    s_waitcnt lgkmcnt(4)
    v_mfma_f32_32x32x16_bf16 v[164:179], v[224:227], v[204:207], v[164:179]
    ds_read_b64_tr_b16 v[216:217], v127 offset:40960
    ds_read_b64_tr_b16 v[218:219], v127 offset:41984
    v_mfma_f32_32x32x16_bf16 v[180:195], v[224:227], v[208:211], v[180:195]
    s_waitcnt lgkmcnt(3)
    v_mfma_f32_32x32x16_bf16 v[132:147], v[212:215], v[196:199], v[132:147]
    ds_read_b64_tr_b16 v[220:221], v126 offset:45056
    ds_read_b64_tr_b16 v[222:223], v126 offset:46080
    s_add_u32 m0, s51, 0
    s_mul_i32 s43, s52, 9
    buffer_load_dwordx4 v10, s[20:23], s43 offen offset:0 lds
    s_waitcnt lgkmcnt(4)
    v_mfma_f32_32x32x16_bf16 v[148:163], v[212:215], v[200:203], v[148:163]
    ds_read_b128 v[204:207], v111 offset:0
    ds_read_b128 v[208:211], v115 offset:0
    v_mfma_f32_16x16x32_bf16 v[228:231], v[212:215], v[232:235], v[228:231]
    buffer_load_dwordx4 v11, s[20:23], s43 offen offset:1024 lds
    s_waitcnt lgkmcnt(4)
    v_mfma_f32_32x32x16_bf16 v[164:179], v[216:219], v[196:199], v[164:179]
    ds_read_b64_tr_b16 v[224:225], v127 offset:45056
    ds_read_b64_tr_b16 v[226:227], v127 offset:46080
    v_mfma_f32_32x32x16_bf16 v[180:195], v[216:219], v[200:203], v[180:195]
    s_waitcnt vmcnt(6)
    s_barrier
    s_waitcnt lgkmcnt(3)
    v_mfma_f32_32x32x16_bf16 v[132:147], v[220:223], v[204:207], v[132:147]
    ds_read_b64_tr_b16 v[212:213], v128 offset:32768
    ds_read_b64_tr_b16 v[214:215], v128 offset:33792
    s_waitcnt lgkmcnt(4)
    v_mfma_f32_32x32x16_bf16 v[148:163], v[220:223], v[208:211], v[148:163]
    ds_read_b128 v[196:199], v116 offset:0
    ds_read_b128 v[200:203], v120 offset:0
    v_mfma_f32_16x16x32_bf16 v[228:231], v[220:223], v[232:235], v[228:231]
    s_waitcnt lgkmcnt(4)
    v_mfma_f32_32x32x16_bf16 v[164:179], v[224:227], v[204:207], v[164:179]
    ds_read_b64_tr_b16 v[216:217], v129 offset:32768
    ds_read_b64_tr_b16 v[218:219], v129 offset:33792
    v_mfma_f32_32x32x16_bf16 v[180:195], v[224:227], v[208:211], v[180:195]
    s_waitcnt vmcnt(18)
.fsp_16:
    v_readfirstlane_b32 s39, v85
    s_nop 3
    s_cmp_ge_u32 s39, 2
    s_cbranch_scc1 .fok_15
    s_sleep 2
    buffer_load_dword v85, v84, s[64:67], 0 offen sc1
    s_waitcnt vmcnt(0)
    s_branch .fsp_16
.fok_15:
    s_lshl_b32 s40, s53, 7
    s_add_u32 s41, s40, 8192
    buffer_load_dword v80, v86, s[60:63], s40 offen sc1
    buffer_load_dword v82, v86, s[60:63], s41 offen sc1
    s_lshl_b32 s40, s54, 7
    s_add_u32 s41, s40, 8192
    buffer_load_dword v81, v86, s[60:63], s40 offen sc1
    buffer_load_dword v83, v86, s[60:63], s41 offen sc1
    s_barrier
    s_waitcnt lgkmcnt(3)
    v_mfma_f32_32x32x16_bf16 v[132:147], v[212:215], v[196:199], v[132:147]
    ds_read_b64_tr_b16 v[220:221], v128 offset:36864
    ds_read_b64_tr_b16 v[222:223], v128 offset:37888
    s_waitcnt lgkmcnt(4)
    v_mfma_f32_32x32x16_bf16 v[148:163], v[212:215], v[200:203], v[148:163]
    ds_read_b128 v[204:207], v117 offset:0
    ds_read_b128 v[208:211], v121 offset:0
    v_mfma_f32_16x16x32_bf16 v[228:231], v[212:215], v[232:235], v[228:231]
    s_waitcnt lgkmcnt(4)
    v_mfma_f32_32x32x16_bf16 v[164:179], v[216:219], v[196:199], v[164:179]
    ds_read_b64_tr_b16 v[224:225], v129 offset:36864
    ds_read_b64_tr_b16 v[226:227], v129 offset:37888
    v_mfma_f32_32x32x16_bf16 v[180:195], v[216:219], v[200:203], v[180:195]
    s_waitcnt lgkmcnt(3)
    v_mfma_f32_32x32x16_bf16 v[132:147], v[220:223], v[204:207], v[132:147]
    ds_read_b64_tr_b16 v[212:213], v128 offset:40960
    ds_read_b64_tr_b16 v[214:215], v128 offset:41984
    s_waitcnt lgkmcnt(4)
    v_mfma_f32_32x32x16_bf16 v[148:163], v[220:223], v[208:211], v[148:163]
    ds_read_b128 v[196:199], v118 offset:0
    ds_read_b128 v[200:203], v122 offset:0
    v_mfma_f32_16x16x32_bf16 v[228:231], v[220:223], v[232:235], v[228:231]
    s_waitcnt lgkmcnt(4)
    v_mfma_f32_32x32x16_bf16 v[164:179], v[224:227], v[204:207], v[164:179]
    ds_read_b64_tr_b16 v[216:217], v129 offset:40960
    ds_read_b64_tr_b16 v[218:219], v129 offset:41984
    v_mfma_f32_32x32x16_bf16 v[180:195], v[224:227], v[208:211], v[180:195]
    s_waitcnt lgkmcnt(3)
    v_mfma_f32_32x32x16_bf16 v[132:147], v[212:215], v[196:199], v[132:147]
    ds_read_b64_tr_b16 v[220:221], v128 offset:45056
    ds_read_b64_tr_b16 v[222:223], v128 offset:46080
    s_waitcnt lgkmcnt(4)
    v_mfma_f32_32x32x16_bf16 v[148:163], v[212:215], v[200:203], v[148:163]
    ds_read_b128 v[204:207], v119 offset:0
    ds_read_b128 v[208:211], v123 offset:0
    v_mfma_f32_16x16x32_bf16 v[228:231], v[212:215], v[232:235], v[228:231]
    s_waitcnt lgkmcnt(4)
    v_mfma_f32_32x32x16_bf16 v[164:179], v[216:219], v[196:199], v[164:179]
    ds_read_b64_tr_b16 v[224:225], v129 offset:45056
    ds_read_b64_tr_b16 v[226:227], v129 offset:46080
    v_mfma_f32_32x32x16_bf16 v[180:195], v[216:219], v[200:203], v[180:195]
    s_waitcnt vmcnt(4)
    s_barrier
    s_waitcnt lgkmcnt(3)
    v_mfma_f32_32x32x16_bf16 v[132:147], v[220:223], v[204:207], v[132:147]
    ds_read_b64_tr_b16 v[212:213], v124 offset:32768
    ds_read_b64_tr_b16 v[214:215], v124 offset:33792
    s_waitcnt lgkmcnt(4)
    v_mfma_f32_32x32x16_bf16 v[148:163], v[220:223], v[208:211], v[148:163]
    ds_read_b128 v[196:199], v100 offset:0
    ds_read_b128 v[200:203], v104 offset:0
    v_mfma_f32_16x16x32_bf16 v[228:231], v[220:223], v[232:235], v[228:231]
    s_waitcnt lgkmcnt(4)
    v_mfma_f32_32x32x16_bf16 v[164:179], v[224:227], v[204:207], v[164:179]
    ds_read_b64_tr_b16 v[216:217], v125 offset:32768
    ds_read_b64_tr_b16 v[218:219], v125 offset:33792
    v_mfma_f32_32x32x16_bf16 v[180:195], v[224:227], v[208:211], v[180:195]
    s_barrier
    s_waitcnt lgkmcnt(3)
    v_mfma_f32_32x32x16_bf16 v[132:147], v[212:215], v[196:199], v[132:147]
    ds_read_b64_tr_b16 v[220:221], v124 offset:36864
    ds_read_b64_tr_b16 v[222:223], v124 offset:37888
    s_waitcnt lgkmcnt(4)
    v_mfma_f32_32x32x16_bf16 v[148:163], v[212:215], v[200:203], v[148:163]
    ds_read_b128 v[204:207], v101 offset:0
    ds_read_b128 v[208:211], v105 offset:0
    v_mfma_f32_16x16x32_bf16 v[228:231], v[212:215], v[232:235], v[228:231]
    s_waitcnt lgkmcnt(4)
    v_mfma_f32_32x32x16_bf16 v[164:179], v[216:219], v[196:199], v[164:179]
    ds_read_b64_tr_b16 v[224:225], v125 offset:36864
    ds_read_b64_tr_b16 v[226:227], v125 offset:37888
    v_mfma_f32_32x32x16_bf16 v[180:195], v[216:219], v[200:203], v[180:195]
    s_waitcnt lgkmcnt(3)
    v_mfma_f32_32x32x16_bf16 v[132:147], v[220:223], v[204:207], v[132:147]
    ds_read_b64_tr_b16 v[212:213], v124 offset:40960
    ds_read_b64_tr_b16 v[214:215], v124 offset:41984
    s_waitcnt lgkmcnt(4)
    v_mfma_f32_32x32x16_bf16 v[148:163], v[220:223], v[208:211], v[148:163]
    ds_read_b128 v[196:199], v102 offset:0
    ds_read_b128 v[200:203], v106 offset:0
    v_mfma_f32_16x16x32_bf16 v[228:231], v[220:223], v[232:235], v[228:231]
    s_waitcnt lgkmcnt(4)
    v_mfma_f32_32x32x16_bf16 v[164:179], v[224:227], v[204:207], v[164:179]
    ds_read_b64_tr_b16 v[216:217], v125 offset:40960
    ds_read_b64_tr_b16 v[218:219], v125 offset:41984
    v_mfma_f32_32x32x16_bf16 v[180:195], v[224:227], v[208:211], v[180:195]
    s_waitcnt lgkmcnt(3)
    v_mfma_f32_32x32x16_bf16 v[132:147], v[212:215], v[196:199], v[132:147]
    ds_read_b64_tr_b16 v[220:221], v124 offset:45056
    ds_read_b64_tr_b16 v[222:223], v124 offset:46080
    s_waitcnt lgkmcnt(4)
    v_mfma_f32_32x32x16_bf16 v[148:163], v[212:215], v[200:203], v[148:163]
    ds_read_b128 v[204:207], v103 offset:0
    ds_read_b128 v[208:211], v107 offset:0
    v_mfma_f32_16x16x32_bf16 v[228:231], v[212:215], v[232:235], v[228:231]
    s_waitcnt lgkmcnt(4)
    v_mfma_f32_32x32x16_bf16 v[164:179], v[216:219], v[196:199], v[164:179]
    ds_read_b64_tr_b16 v[224:225], v125 offset:45056
    ds_read_b64_tr_b16 v[226:227], v125 offset:46080
    v_mfma_f32_32x32x16_bf16 v[180:195], v[216:219], v[200:203], v[180:195]
    s_waitcnt lgkmcnt(3)
    v_mfma_f32_32x32x16_bf16 v[132:147], v[220:223], v[204:207], v[132:147]
    s_waitcnt lgkmcnt(2)
    v_mfma_f32_32x32x16_bf16 v[148:163], v[220:223], v[208:211], v[148:163]
    v_mfma_f32_16x16x32_bf16 v[228:231], v[220:223], v[232:235], v[228:231]
    s_waitcnt lgkmcnt(0)
    v_mfma_f32_32x32x16_bf16 v[164:179], v[224:227], v[204:207], v[164:179]
    v_mfma_f32_32x32x16_bf16 v[180:195], v[224:227], v[208:211], v[180:195]
    s_branch .e1epi_12
.nocs_14:
    s_waitcnt vmcnt(14)
    s_waitcnt lgkmcnt(0)
    s_barrier
    ds_read_b64_tr_b16 v[212:213], v124 offset:32768
    ds_read_b64_tr_b16 v[214:215], v124 offset:33792
    ds_read_b128 v[196:199], v100 offset:0
    ds_read_b128 v[200:203], v104 offset:0
    ds_read_b64_tr_b16 v[216:217], v125 offset:32768
    ds_read_b64_tr_b16 v[218:219], v125 offset:33792
    s_waitcnt lgkmcnt(3)
    v_mfma_f32_32x32x16_bf16 v[132:147], v[212:215], v[196:199], 0
    ds_read_b64_tr_b16 v[220:221], v124 offset:36864
    ds_read_b64_tr_b16 v[222:223], v124 offset:37888
    s_add_u32 m0, s50, 98304
    s_mov_b32 s42, 256
    buffer_load_dwordx4 v6, s[16:19], s42 offen offset:0 lds
    s_waitcnt lgkmcnt(4)
    v_mfma_f32_32x32x16_bf16 v[148:163], v[212:215], v[200:203], 0
    ds_read_b128 v[204:207], v101 offset:0
    ds_read_b128 v[208:211], v105 offset:0
    buffer_load_dwordx4 v7, s[16:19], s42 offen offset:1024 lds
    s_waitcnt lgkmcnt(4)
    v_mfma_f32_32x32x16_bf16 v[164:179], v[216:219], v[196:199], 0
    ds_read_b64_tr_b16 v[224:225], v125 offset:36864
    ds_read_b64_tr_b16 v[226:227], v125 offset:37888
    v_mfma_f32_32x32x16_bf16 v[180:195], v[216:219], v[200:203], 0
    s_waitcnt lgkmcnt(3)
    v_mfma_f32_32x32x16_bf16 v[132:147], v[220:223], v[204:207], v[132:147]
    ds_read_b64_tr_b16 v[212:213], v124 offset:40960
    ds_read_b64_tr_b16 v[214:215], v124 offset:41984
    buffer_load_dwordx4 v8, s[16:19], s42 offen offset:2048 lds
    s_waitcnt lgkmcnt(4)
    v_mfma_f32_32x32x16_bf16 v[148:163], v[220:223], v[208:211], v[148:163]
    ds_read_b128 v[196:199], v102 offset:0
    ds_read_b128 v[200:203], v106 offset:0
    buffer_load_dwordx4 v9, s[16:19], s42 offen offset:3072 lds
    s_waitcnt lgkmcnt(4)
    v_mfma_f32_32x32x16_bf16 v[164:179], v[224:227], v[204:207], v[164:179]
    ds_read_b64_tr_b16 v[216:217], v125 offset:40960
    ds_read_b64_tr_b16 v[218:219], v125 offset:41984
    v_mfma_f32_32x32x16_bf16 v[180:195], v[224:227], v[208:211], v[180:195]
    s_waitcnt lgkmcnt(3)
    v_mfma_f32_32x32x16_bf16 v[132:147], v[212:215], v[196:199], v[132:147]
    ds_read_b64_tr_b16 v[220:221], v124 offset:45056
    ds_read_b64_tr_b16 v[222:223], v124 offset:46080
    s_add_u32 m0, s51, 98304
    s_mul_i32 s43, s52, 2
    buffer_load_dwordx4 v10, s[20:23], s43 offen offset:0 lds
    s_waitcnt lgkmcnt(4)
    v_mfma_f32_32x32x16_bf16 v[148:163], v[212:215], v[200:203], v[148:163]
    ds_read_b128 v[204:207], v103 offset:0
    ds_read_b128 v[208:211], v107 offset:0
    buffer_load_dwordx4 v11, s[20:23], s43 offen offset:1024 lds
    s_waitcnt lgkmcnt(4)
    v_mfma_f32_32x32x16_bf16 v[164:179], v[216:219], v[196:199], v[164:179]
    ds_read_b64_tr_b16 v[224:225], v125 offset:45056
    ds_read_b64_tr_b16 v[226:227], v125 offset:46080
    v_mfma_f32_32x32x16_bf16 v[180:195], v[216:219], v[200:203], v[180:195]
    s_waitcnt vmcnt(14)
    s_barrier
    s_waitcnt lgkmcnt(3)
    v_mfma_f32_32x32x16_bf16 v[132:147], v[220:223], v[204:207], v[132:147]
    ds_read_b64_tr_b16 v[212:213], v126 offset:32768
    ds_read_b64_tr_b16 v[214:215], v126 offset:33792
    s_waitcnt lgkmcnt(4)
    v_mfma_f32_32x32x16_bf16 v[148:163], v[220:223], v[208:211], v[148:163]
    ds_read_b128 v[196:199], v108 offset:0
    ds_read_b128 v[200:203], v112 offset:0
    s_waitcnt lgkmcnt(4)
    v_mfma_f32_32x32x16_bf16 v[164:179], v[224:227], v[204:207], v[164:179]
    ds_read_b64_tr_b16 v[216:217], v127 offset:32768
    ds_read_b64_tr_b16 v[218:219], v127 offset:33792
    v_mfma_f32_32x32x16_bf16 v[180:195], v[224:227], v[208:211], v[180:195]
    s_barrier
    s_waitcnt lgkmcnt(3)
    v_mfma_f32_32x32x16_bf16 v[132:147], v[212:215], v[196:199], v[132:147]
    ds_read_b64_tr_b16 v[220:221], v126 offset:36864
    ds_read_b64_tr_b16 v[222:223], v126 offset:37888
    s_add_u32 m0, s50, 0
    s_mov_b32 s42, 384
    buffer_load_dwordx4 v6, s[16:19], s42 offen offset:0 lds
    s_waitcnt lgkmcnt(4)
    v_mfma_f32_32x32x16_bf16 v[148:163], v[212:215], v[200:203], v[148:163]
    ds_read_b128 v[204:207], v109 offset:0
    ds_read_b128 v[208:211], v113 offset:0
    buffer_load_dwordx4 v7, s[16:19], s42 offen offset:1024 lds
    s_waitcnt lgkmcnt(4)
    v_mfma_f32_32x32x16_bf16 v[164:179], v[216:219], v[196:199], v[164:179]
    ds_read_b64_tr_b16 v[224:225], v127 offset:36864
    ds_read_b64_tr_b16 v[226:227], v127 offset:37888
    v_mfma_f32_32x32x16_bf16 v[180:195], v[216:219], v[200:203], v[180:195]
    s_waitcnt lgkmcnt(3)
    v_mfma_f32_32x32x16_bf16 v[132:147], v[220:223], v[204:207], v[132:147]
    ds_read_b64_tr_b16 v[212:213], v126 offset:40960
    ds_read_b64_tr_b16 v[214:215], v126 offset:41984
    buffer_load_dwordx4 v8, s[16:19], s42 offen offset:2048 lds
    s_waitcnt lgkmcnt(4)
    v_mfma_f32_32x32x16_bf16 v[148:163], v[220:223], v[208:211], v[148:163]
    ds_read_b128 v[196:199], v110 offset:0
    ds_read_b128 v[200:203], v114 offset:0
    buffer_load_dwordx4 v9, s[16:19], s42 offen offset:3072 lds
    s_waitcnt lgkmcnt(4)
    v_mfma_f32_32x32x16_bf16 v[164:179], v[224:227], v[204:207], v[164:179]
    ds_read_b64_tr_b16 v[216:217], v127 offset:40960
    ds_read_b64_tr_b16 v[218:219], v127 offset:41984
    v_mfma_f32_32x32x16_bf16 v[180:195], v[224:227], v[208:211], v[180:195]
    s_waitcnt lgkmcnt(3)
    v_mfma_f32_32x32x16_bf16 v[132:147], v[212:215], v[196:199], v[132:147]
    ds_read_b64_tr_b16 v[220:221], v126 offset:45056
    ds_read_b64_tr_b16 v[222:223], v126 offset:46080
    s_add_u32 m0, s51, 0
    s_mul_i32 s43, s52, 3
    buffer_load_dwordx4 v10, s[20:23], s43 offen offset:0 lds
    s_waitcnt lgkmcnt(4)
    v_mfma_f32_32x32x16_bf16 v[148:163], v[212:215], v[200:203], v[148:163]
    ds_read_b128 v[204:207], v111 offset:0
    ds_read_b128 v[208:211], v115 offset:0
    buffer_load_dwordx4 v11, s[20:23], s43 offen offset:1024 lds
    s_waitcnt lgkmcnt(4)
    v_mfma_f32_32x32x16_bf16 v[164:179], v[216:219], v[196:199], v[164:179]
    ds_read_b64_tr_b16 v[224:225], v127 offset:45056
    ds_read_b64_tr_b16 v[226:227], v127 offset:46080
    v_mfma_f32_32x32x16_bf16 v[180:195], v[216:219], v[200:203], v[180:195]
    s_waitcnt vmcnt(6)
    s_barrier
    s_waitcnt lgkmcnt(3)
    v_mfma_f32_32x32x16_bf16 v[132:147], v[220:223], v[204:207], v[132:147]
    ds_read_b64_tr_b16 v[212:213], v128 offset:32768
    ds_read_b64_tr_b16 v[214:215], v128 offset:33792
    s_waitcnt lgkmcnt(4)
    v_mfma_f32_32x32x16_bf16 v[148:163], v[220:223], v[208:211], v[148:163]
    ds_read_b128 v[196:199], v116 offset:0
    ds_read_b128 v[200:203], v120 offset:0
    s_waitcnt lgkmcnt(4)
    v_mfma_f32_32x32x16_bf16 v[164:179], v[224:227], v[204:207], v[164:179]
    ds_read_b64_tr_b16 v[216:217], v129 offset:32768
    ds_read_b64_tr_b16 v[218:219], v129 offset:33792
    v_mfma_f32_32x32x16_bf16 v[180:195], v[224:227], v[208:211], v[180:195]
    s_barrier
    s_waitcnt lgkmcnt(3)
    v_mfma_f32_32x32x16_bf16 v[132:147], v[212:215], v[196:199], v[132:147]
    ds_read_b64_tr_b16 v[220:221], v128 offset:36864
    ds_read_b64_tr_b16 v[222:223], v128 offset:37888
    s_add_u32 m0, s50, 49152
    s_mov_b32 s42, 512
    buffer_load_dwordx4 v6, s[16:19], s42 offen offset:0 lds
    s_waitcnt lgkmcnt(4)
    v_mfma_f32_32x32x16_bf16 v[148:163], v[212:215], v[200:203], v[148:163]
    ds_read_b128 v[204:207], v117 offset:0
    ds_read_b128 v[208:211], v121 offset:0
    buffer_load_dwordx4 v7, s[16:19], s42 offen offset:1024 lds
    s_waitcnt lgkmcnt(4)
    v_mfma_f32_32x32x16_bf16 v[164:179], v[216:219], v[196:199], v[164:179]
    ds_read_b64_tr_b16 v[224:225], v129 offset:36864
    ds_read_b64_tr_b16 v[226:227], v129 offset:37888
    v_mfma_f32_32x32x16_bf16 v[180:195], v[216:219], v[200:203], v[180:195]
    s_waitcnt lgkmcnt(3)
    v_mfma_f32_32x32x16_bf16 v[132:147], v[220:223], v[204:207], v[132:147]
    ds_read_b64_tr_b16 v[212:213], v128 offset:40960
    ds_read_b64_tr_b16 v[214:215], v128 offset:41984
    buffer_load_dwordx4 v8, s[16:19], s42 offen offset:2048 lds
    s_waitcnt lgkmcnt(4)
    v_mfma_f32_32x32x16_bf16 v[148:163], v[220:223], v[208:211], v[148:163]
    ds_read_b128 v[196:199], v118 offset:0
    ds_read_b128 v[200:203], v122 offset:0
    buffer_load_dwordx4 v9, s[16:19], s42 offen offset:3072 lds
    s_waitcnt lgkmcnt(4)
    v_mfma_f32_32x32x16_bf16 v[164:179], v[224:227], v[204:207], v[164:179]
    ds_read_b64_tr_b16 v[216:217], v129 offset:40960
    ds_read_b64_tr_b16 v[218:219], v129 offset:41984
    v_mfma_f32_32x32x16_bf16 v[180:195], v[224:227], v[208:211], v[180:195]
    s_waitcnt lgkmcnt(3)
    v_mfma_f32_32x32x16_bf16 v[132:147], v[212:215], v[196:199], v[132:147]
    ds_read_b64_tr_b16 v[220:221], v128 offset:45056
    ds_read_b64_tr_b16 v[222:223], v128 offset:46080
    s_add_u32 m0, s51, 49152
    s_mul_i32 s43, s52, 4
    buffer_load_dwordx4 v10, s[20:23], s43 offen offset:0 lds
    s_waitcnt lgkmcnt(4)
    v_mfma_f32_32x32x16_bf16 v[148:163], v[212:215], v[200:203], v[148:163]
    ds_read_b128 v[204:207], v119 offset:0
    ds_read_b128 v[208:211], v123 offset:0
    buffer_load_dwordx4 v11, s[20:23], s43 offen offset:1024 lds
    s_waitcnt lgkmcnt(4)
    v_mfma_f32_32x32x16_bf16 v[164:179], v[216:219], v[196:199], v[164:179]
    ds_read_b64_tr_b16 v[224:225], v129 offset:45056
    ds_read_b64_tr_b16 v[226:227], v129 offset:46080
    v_mfma_f32_32x32x16_bf16 v[180:195], v[216:219], v[200:203], v[180:195]
    s_waitcnt vmcnt(6)
    s_barrier
    s_waitcnt lgkmcnt(3)
    v_mfma_f32_32x32x16_bf16 v[132:147], v[220:223], v[204:207], v[132:147]
    ds_read_b64_tr_b16 v[212:213], v124 offset:32768
    ds_read_b64_tr_b16 v[214:215], v124 offset:33792
    s_waitcnt lgkmcnt(4)
    v_mfma_f32_32x32x16_bf16 v[148:163], v[220:223], v[208:211], v[148:163]
    ds_read_b128 v[196:199], v100 offset:0
    ds_read_b128 v[200:203], v104 offset:0
    s_waitcnt lgkmcnt(4)
    v_mfma_f32_32x32x16_bf16 v[164:179], v[224:227], v[204:207], v[164:179]
    ds_read_b64_tr_b16 v[216:217], v125 offset:32768
    ds_read_b64_tr_b16 v[218:219], v125 offset:33792
    v_mfma_f32_32x32x16_bf16 v[180:195], v[224:227], v[208:211], v[180:195]
    s_barrier
    s_waitcnt lgkmcnt(3)
    v_mfma_f32_32x32x16_bf16 v[132:147], v[212:215], v[196:199], v[132:147]
    ds_read_b64_tr_b16 v[220:221], v124 offset:36864
    ds_read_b64_tr_b16 v[222:223], v124 offset:37888
    s_add_u32 m0, s50, 98304
    s_mov_b32 s42, 640
    buffer_load_dwordx4 v6, s[16:19], s42 offen offset:0 lds
    s_waitcnt lgkmcnt(4)
    v_mfma_f32_32x32x16_bf16 v[148:163], v[212:215], v[200:203], v[148:163]
    ds_read_b128 v[204:207], v101 offset:0
    ds_read_b128 v[208:211], v105 offset:0
    buffer_load_dwordx4 v7, s[16:19], s42 offen offset:1024 lds
    s_waitcnt lgkmcnt(4)
    v_mfma_f32_32x32x16_bf16 v[164:179], v[216:219], v[196:199], v[164:179]
    ds_read_b64_tr_b16 v[224:225], v125 offset:36864
    ds_read_b64_tr_b16 v[226:227], v125 offset:37888
    v_mfma_f32_32x32x16_bf16 v[180:195], v[216:219], v[200:203], v[180:195]
    s_waitcnt lgkmcnt(3)
    v_mfma_f32_32x32x16_bf16 v[132:147], v[220:223], v[204:207], v[132:147]
    ds_read_b64_tr_b16 v[212:213], v124 offset:40960
    ds_read_b64_tr_b16 v[214:215], v124 offset:41984
    buffer_load_dwordx4 v8, s[16:19], s42 offen offset:2048 lds
    s_waitcnt lgkmcnt(4)
    v_mfma_f32_32x32x16_bf16 v[148:163], v[220:223], v[208:211], v[148:163]
    ds_read_b128 v[196:199], v102 offset:0
    ds_read_b128 v[200:203], v106 offset:0
    buffer_load_dwordx4 v9, s[16:19], s42 offen offset:3072 lds
    s_waitcnt lgkmcnt(4)
    v_mfma_f32_32x32x16_bf16 v[164:179], v[224:227], v[204:207], v[164:179]
    ds_read_b64_tr_b16 v[216:217], v125 offset:40960
    ds_read_b64_tr_b16 v[218:219], v125 offset:41984
    v_mfma_f32_32x32x16_bf16 v[180:195], v[224:227], v[208:211], v[180:195]
    s_waitcnt lgkmcnt(3)
    v_mfma_f32_32x32x16_bf16 v[132:147], v[212:215], v[196:199], v[132:147]
    ds_read_b64_tr_b16 v[220:221], v124 offset:45056
    ds_read_b64_tr_b16 v[222:223], v124 offset:46080
    s_add_u32 m0, s51, 98304
    s_mul_i32 s43, s52, 5
    buffer_load_dwordx4 v10, s[20:23], s43 offen offset:0 lds
    s_waitcnt lgkmcnt(4)
    v_mfma_f32_32x32x16_bf16 v[148:163], v[212:215], v[200:203], v[148:163]
    ds_read_b128 v[204:207], v103 offset:0
    ds_read_b128 v[208:211], v107 offset:0
    buffer_load_dwordx4 v11, s[20:23], s43 offen offset:1024 lds
    s_waitcnt lgkmcnt(4)
    v_mfma_f32_32x32x16_bf16 v[164:179], v[216:219], v[196:199], v[164:179]
    ds_read_b64_tr_b16 v[224:225], v125 offset:45056
    ds_read_b64_tr_b16 v[226:227], v125 offset:46080
    v_mfma_f32_32x32x16_bf16 v[180:195], v[216:219], v[200:203], v[180:195]
    s_waitcnt vmcnt(6)
    s_barrier
    s_waitcnt lgkmcnt(3)
    v_mfma_f32_32x32x16_bf16 v[132:147], v[220:223], v[204:207], v[132:147]
    ds_read_b64_tr_b16 v[212:213], v126 offset:32768
    ds_read_b64_tr_b16 v[214:215], v126 offset:33792
    s_waitcnt lgkmcnt(4)
    v_mfma_f32_32x32x16_bf16 v[148:163], v[220:223], v[208:211], v[148:163]
    ds_read_b128 v[196:199], v108 offset:0
    ds_read_b128 v[200:203], v112 offset:0
    s_waitcnt lgkmcnt(4)
    v_mfma_f32_32x32x16_bf16 v[164:179], v[224:227], v[204:207], v[164:179]
    ds_read_b64_tr_b16 v[216:217], v127 offset:32768
    ds_read_b64_tr_b16 v[218:219], v127 offset:33792
    v_mfma_f32_32x32x16_bf16 v[180:195], v[224:227], v[208:211], v[180:195]
    s_barrier
    s_waitcnt lgkmcnt(3)
    v_mfma_f32_32x32x16_bf16 v[132:147], v[212:215], v[196:199], v[132:147]
    ds_read_b64_tr_b16 v[220:221], v126 offset:36864
    ds_read_b64_tr_b16 v[222:223], v126 offset:37888
    s_add_u32 m0, s50, 0
    s_mov_b32 s42, 768
    buffer_load_dwordx4 v6, s[16:19], s42 offen offset:0 lds
    s_waitcnt lgkmcnt(4)
    v_mfma_f32_32x32x16_bf16 v[148:163], v[212:215], v[200:203], v[148:163]
    ds_read_b128 v[204:207], v109 offset:0
    ds_read_b128 v[208:211], v113 offset:0
    buffer_load_dwordx4 v7, s[16:19], s42 offen offset:1024 lds
    s_waitcnt lgkmcnt(4)
    v_mfma_f32_32x32x16_bf16 v[164:179], v[216:219], v[196:199], v[164:179]
    ds_read_b64_tr_b16 v[224:225], v127 offset:36864
    ds_read_b64_tr_b16 v[226:227], v127 offset:37888
    v_mfma_f32_32x32x16_bf16 v[180:195], v[216:219], v[200:203], v[180:195]
    s_waitcnt lgkmcnt(3)
    v_mfma_f32_32x32x16_bf16 v[132:147], v[220:223], v[204:207], v[132:147]
    ds_read_b64_tr_b16 v[212:213], v126 offset:40960
    ds_read_b64_tr_b16 v[214:215], v126 offset:41984
    buffer_load_dwordx4 v8, s[16:19], s42 offen offset:2048 lds
    s_waitcnt lgkmcnt(4)
    v_mfma_f32_32x32x16_bf16 v[148:163], v[220:223], v[208:211], v[148:163]
    ds_read_b128 v[196:199], v110 offset:0
    ds_read_b128 v[200:203], v114 offset:0
    buffer_load_dwordx4 v9, s[16:19], s42 offen offset:3072 lds
    s_waitcnt lgkmcnt(4)
    v_mfma_f32_32x32x16_bf16 v[164:179], v[224:227], v[204:207], v[164:179]
    ds_read_b64_tr_b16 v[216:217], v127 offset:40960
    ds_read_b64_tr_b16 v[218:219], v127 offset:41984
    v_mfma_f32_32x32x16_bf16 v[180:195], v[224:227], v[208:211], v[180:195]
    s_waitcnt lgkmcnt(3)
    v_mfma_f32_32x32x16_bf16 v[132:147], v[212:215], v[196:199], v[132:147]
    ds_read_b64_tr_b16 v[220:221], v126 offset:45056
    ds_read_b64_tr_b16 v[222:223], v126 offset:46080
    s_add_u32 m0, s51, 0
    s_mul_i32 s43, s52, 6
    buffer_load_dwordx4 v10, s[20:23], s43 offen offset:0 lds
    s_waitcnt lgkmcnt(4)
    v_mfma_f32_32x32x16_bf16 v[148:163], v[212:215], v[200:203], v[148:163]
    ds_read_b128 v[204:207], v111 offset:0
    ds_read_b128 v[208:211], v115 offset:0
    buffer_load_dwordx4 v11, s[20:23], s43 offen offset:1024 lds
    s_waitcnt lgkmcnt(4)
    v_mfma_f32_32x32x16_bf16 v[164:179], v[216:219], v[196:199], v[164:179]
    ds_read_b64_tr_b16 v[224:225], v127 offset:45056
    ds_read_b64_tr_b16 v[226:227], v127 offset:46080
    v_mfma_f32_32x32x16_bf16 v[180:195], v[216:219], v[200:203], v[180:195]
    s_waitcnt vmcnt(6)
    s_barrier
    s_waitcnt lgkmcnt(3)
    v_mfma_f32_32x32x16_bf16 v[132:147], v[220:223], v[204:207], v[132:147]
    ds_read_b64_tr_b16 v[212:213], v128 offset:32768
    ds_read_b64_tr_b16 v[214:215], v128 offset:33792
    s_waitcnt lgkmcnt(4)
    v_mfma_f32_32x32x16_bf16 v[148:163], v[220:223], v[208:211], v[148:163]
    ds_read_b128 v[196:199], v116 offset:0
    ds_read_b128 v[200:203], v120 offset:0
    s_waitcnt lgkmcnt(4)
    v_mfma_f32_32x32x16_bf16 v[164:179], v[224:227], v[204:207], v[164:179]
    ds_read_b64_tr_b16 v[216:217], v129 offset:32768
    ds_read_b64_tr_b16 v[218:219], v129 offset:33792
    v_mfma_f32_32x32x16_bf16 v[180:195], v[224:227], v[208:211], v[180:195]
    buffer_load_dword v85, v84, s[64:67], 0 offen sc1
    s_barrier
    s_waitcnt lgkmcnt(3)
    v_mfma_f32_32x32x16_bf16 v[132:147], v[212:215], v[196:199], v[132:147]
    ds_read_b64_tr_b16 v[220:221], v128 offset:36864
    ds_read_b64_tr_b16 v[222:223], v128 offset:37888
    s_add_u32 m0, s50, 49152
    s_mov_b32 s42, 896
    buffer_load_dwordx4 v6, s[16:19], s42 offen offset:0 lds
    s_waitcnt lgkmcnt(4)
    v_mfma_f32_32x32x16_bf16 v[148:163], v[212:215], v[200:203], v[148:163]
    ds_read_b128 v[204:207], v117 offset:0
    ds_read_b128 v[208:211], v121 offset:0
    buffer_load_dwordx4 v7, s[16:19], s42 offen offset:1024 lds
    s_waitcnt lgkmcnt(4)
    v_mfma_f32_32x32x16_bf16 v[164:179], v[216:219], v[196:199], v[164:179]
    ds_read_b64_tr_b16 v[224:225], v129 offset:36864
    ds_read_b64_tr_b16 v[226:227], v129 offset:37888
    v_mfma_f32_32x32x16_bf16 v[180:195], v[216:219], v[200:203], v[180:195]
    s_waitcnt lgkmcnt(3)
    v_mfma_f32_32x32x16_bf16 v[132:147], v[220:223], v[204:207], v[132:147]
    ds_read_b64_tr_b16 v[212:213], v128 offset:40960
    ds_read_b64_tr_b16 v[214:215], v128 offset:41984
    buffer_load_dwordx4 v8, s[16:19], s42 offen offset:2048 lds
    s_waitcnt lgkmcnt(4)
    v_mfma_f32_32x32x16_bf16 v[148:163], v[220:223], v[208:211], v[148:163]
    ds_read_b128 v[196:199], v118 offset:0
    ds_read_b128 v[200:203], v122 offset:0
    buffer_load_dwordx4 v9, s[16:19], s42 offen offset:3072 lds
    s_waitcnt lgkmcnt(4)
    v_mfma_f32_32x32x16_bf16 v[164:179], v[224:227], v[204:207], v[164:179]
    ds_read_b64_tr_b16 v[216:217], v129 offset:40960
    ds_read_b64_tr_b16 v[218:219], v129 offset:41984
    v_mfma_f32_32x32x16_bf16 v[180:195], v[224:227], v[208:211], v[180:195]
    s_waitcnt lgkmcnt(3)
    v_mfma_f32_32x32x16_bf16 v[132:147], v[212:215], v[196:199], v[132:147]
    ds_read_b64_tr_b16 v[220:221], v128 offset:45056
    ds_read_b64_tr_b16 v[222:223], v128 offset:46080
    s_add_u32 m0, s51, 49152
    s_mul_i32 s43, s52, 7
    buffer_load_dwordx4 v10, s[20:23], s43 offen offset:0 lds
    s_waitcnt lgkmcnt(4)
    v_mfma_f32_32x32x16_bf16 v[148:163], v[212:215], v[200:203], v[148:163]
    ds_read_b128 v[204:207], v119 offset:0
    ds_read_b128 v[208:211], v123 offset:0
    buffer_load_dwordx4 v11, s[20:23], s43 offen offset:1024 lds
    s_waitcnt lgkmcnt(4)
    v_mfma_f32_32x32x16_bf16 v[164:179], v[216:219], v[196:199], v[164:179]
    ds_read_b64_tr_b16 v[224:225], v129 offset:45056
    ds_read_b64_tr_b16 v[226:227], v129 offset:46080
    v_mfma_f32_32x32x16_bf16 v[180:195], v[216:219], v[200:203], v[180:195]
    s_waitcnt vmcnt(7)
    s_barrier
    s_waitcnt lgkmcnt(3)
    v_mfma_f32_32x32x16_bf16 v[132:147], v[220:223], v[204:207], v[132:147]
    ds_read_b64_tr_b16 v[212:213], v124 offset:32768
    ds_read_b64_tr_b16 v[214:215], v124 offset:33792
    s_waitcnt lgkmcnt(4)
    v_mfma_f32_32x32x16_bf16 v[148:163], v[220:223], v[208:211], v[148:163]
    ds_read_b128 v[196:199], v100 offset:0
    ds_read_b128 v[200:203], v104 offset:0
    s_waitcnt lgkmcnt(4)
    v_mfma_f32_32x32x16_bf16 v[164:179], v[224:227], v[204:207], v[164:179]
    ds_read_b64_tr_b16 v[216:217], v125 offset:32768
    ds_read_b64_tr_b16 v[218:219], v125 offset:33792
    v_mfma_f32_32x32x16_bf16 v[180:195], v[224:227], v[208:211], v[180:195]
    s_barrier
    s_waitcnt lgkmcnt(3)
    v_mfma_f32_32x32x16_bf16 v[132:147], v[212:215], v[196:199], v[132:147]
    ds_read_b64_tr_b16 v[220:221], v124 offset:36864
    ds_read_b64_tr_b16 v[222:223], v124 offset:37888
    s_add_u32 m0, s50, 98304
    s_mov_b32 s42, 1024
    buffer_load_dwordx4 v6, s[16:19], s42 offen offset:0 lds
    s_waitcnt lgkmcnt(4)
    v_mfma_f32_32x32x16_bf16 v[148:163], v[212:215], v[200:203], v[148:163]
    ds_read_b128 v[204:207], v101 offset:0
    ds_read_b128 v[208:211], v105 offset:0
    buffer_load_dwordx4 v7, s[16:19], s42 offen offset:1024 lds
    s_waitcnt lgkmcnt(4)
    v_mfma_f32_32x32x16_bf16 v[164:179], v[216:219], v[196:199], v[164:179]
    ds_read_b64_tr_b16 v[224:225], v125 offset:36864
    ds_read_b64_tr_b16 v[226:227], v125 offset:37888
    v_mfma_f32_32x32x16_bf16 v[180:195], v[216:219], v[200:203], v[180:195]
    s_waitcnt lgkmcnt(3)
    v_mfma_f32_32x32x16_bf16 v[132:147], v[220:223], v[204:207], v[132:147]
    ds_read_b64_tr_b16 v[212:213], v124 offset:40960
    ds_read_b64_tr_b16 v[214:215], v124 offset:41984
    buffer_load_dwordx4 v8, s[16:19], s42 offen offset:2048 lds
    s_waitcnt lgkmcnt(4)
    v_mfma_f32_32x32x16_bf16 v[148:163], v[220:223], v[208:211], v[148:163]
    ds_read_b128 v[196:199], v102 offset:0
    ds_read_b128 v[200:203], v106 offset:0
    buffer_load_dwordx4 v9, s[16:19], s42 offen offset:3072 lds
    s_waitcnt lgkmcnt(4)
    v_mfma_f32_32x32x16_bf16 v[164:179], v[224:227], v[204:207], v[164:179]
    ds_read_b64_tr_b16 v[216:217], v125 offset:40960
    ds_read_b64_tr_b16 v[218:219], v125 offset:41984
    v_mfma_f32_32x32x16_bf16 v[180:195], v[224:227], v[208:211], v[180:195]
    s_waitcnt lgkmcnt(3)
    v_mfma_f32_32x32x16_bf16 v[132:147], v[212:215], v[196:199], v[132:147]
    ds_read_b64_tr_b16 v[220:221], v124 offset:45056
    ds_read_b64_tr_b16 v[222:223], v124 offset:46080
    s_add_u32 m0, s51, 98304
    s_mul_i32 s43, s52, 8
    buffer_load_dwordx4 v10, s[20:23], s43 offen offset:0 lds
    s_waitcnt lgkmcnt(4)
    v_mfma_f32_32x32x16_bf16 v[148:163], v[212:215], v[200:203], v[148:163]
    ds_read_b128 v[204:207], v103 offset:0
    ds_read_b128 v[208:211], v107 offset:0
    buffer_load_dwordx4 v11, s[20:23], s43 offen offset:1024 lds
    s_waitcnt lgkmcnt(4)
    v_mfma_f32_32x32x16_bf16 v[164:179], v[216:219], v[196:199], v[164:179]
    ds_read_b64_tr_b16 v[224:225], v125 offset:45056
    ds_read_b64_tr_b16 v[226:227], v125 offset:46080
    v_mfma_f32_32x32x16_bf16 v[180:195], v[216:219], v[200:203], v[180:195]
    s_waitcnt vmcnt(6)
    s_barrier
    s_waitcnt lgkmcnt(3)
    v_mfma_f32_32x32x16_bf16 v[132:147], v[220:223], v[204:207], v[132:147]
    ds_read_b64_tr_b16 v[212:213], v126 offset:32768
    ds_read_b64_tr_b16 v[214:215], v126 offset:33792
    s_waitcnt lgkmcnt(4)
    v_mfma_f32_32x32x16_bf16 v[148:163], v[220:223], v[208:211], v[148:163]
    ds_read_b128 v[196:199], v108 offset:0
    ds_read_b128 v[200:203], v112 offset:0
    s_waitcnt lgkmcnt(4)
    v_mfma_f32_32x32x16_bf16 v[164:179], v[224:227], v[204:207], v[164:179]
    ds_read_b64_tr_b16 v[216:217], v127 offset:32768
    ds_read_b64_tr_b16 v[218:219], v127 offset:33792
    v_mfma_f32_32x32x16_bf16 v[180:195], v[224:227], v[208:211], v[180:195]
    s_barrier
    s_waitcnt lgkmcnt(3)
    v_mfma_f32_32x32x16_bf16 v[132:147], v[212:215], v[196:199], v[132:147]
    ds_read_b64_tr_b16 v[220:221], v126 offset:36864
    ds_read_b64_tr_b16 v[222:223], v126 offset:37888
    s_add_u32 m0, s50, 0
    s_mov_b32 s42, 1152
    buffer_load_dwordx4 v6, s[16:19], s42 offen offset:0 lds
    s_waitcnt lgkmcnt(4)
    v_mfma_f32_32x32x16_bf16 v[148:163], v[212:215], v[200:203], v[148:163]
    ds_read_b128 v[204:207], v109 offset:0
    ds_read_b128 v[208:211], v113 offset:0
    buffer_load_dwordx4 v7, s[16:19], s42 offen offset:1024 lds
    s_waitcnt lgkmcnt(4)
    v_mfma_f32_32x32x16_bf16 v[164:179], v[216:219], v[196:199], v[164:179]
    ds_read_b64_tr_b16 v[224:225], v127 offset:36864
    ds_read_b64_tr_b16 v[226:227], v127 offset:37888
    v_mfma_f32_32x32x16_bf16 v[180:195], v[216:219], v[200:203], v[180:195]
    s_waitcnt lgkmcnt(3)
    v_mfma_f32_32x32x16_bf16 v[132:147], v[220:223], v[204:207], v[132:147]
    ds_read_b64_tr_b16 v[212:213], v126 offset:40960
    ds_read_b64_tr_b16 v[214:215], v126 offset:41984
    buffer_load_dwordx4 v8, s[16:19], s42 offen offset:2048 lds
    s_waitcnt lgkmcnt(4)
    v_mfma_f32_32x32x16_bf16 v[148:163], v[220:223], v[208:211], v[148:163]
    ds_read_b128 v[196:199], v110 offset:0
    ds_read_b128 v[200:203], v114 offset:0
    buffer_load_dwordx4 v9, s[16:19], s42 offen offset:3072 lds
    s_waitcnt lgkmcnt(4)
    v_mfma_f32_32x32x16_bf16 v[164:179], v[224:227], v[204:207], v[164:179]
    ds_read_b64_tr_b16 v[216:217], v127 offset:40960
    ds_read_b64_tr_b16 v[218:219], v127 offset:41984
    v_mfma_f32_32x32x16_bf16 v[180:195], v[224:227], v[208:211], v[180:195]
    s_waitcnt lgkmcnt(3)
    v_mfma_f32_32x32x16_bf16 v[132:147], v[212:215], v[196:199], v[132:147]
    ds_read_b64_tr_b16 v[220:221], v126 offset:45056
    ds_read_b64_tr_b16 v[222:223], v126 offset:46080
    s_add_u32 m0, s51, 0
    s_mul_i32 s43, s52, 9
    buffer_load_dwordx4 v10, s[20:23], s43 offen offset:0 lds
    s_waitcnt lgkmcnt(4)
    v_mfma_f32_32x32x16_bf16 v[148:163], v[212:215], v[200:203], v[148:163]
    ds_read_b128 v[204:207], v111 offset:0
    ds_read_b128 v[208:211], v115 offset:0
    buffer_load_dwordx4 v11, s[20:23], s43 offen offset:1024 lds
    s_waitcnt lgkmcnt(4)
    v_mfma_f32_32x32x16_bf16 v[164:179], v[216:219], v[196:199], v[164:179]
    ds_read_b64_tr_b16 v[224:225], v127 offset:45056
    ds_read_b64_tr_b16 v[226:227], v127 offset:46080
    v_mfma_f32_32x32x16_bf16 v[180:195], v[216:219], v[200:203], v[180:195]
    s_waitcnt vmcnt(6)
    s_barrier
    s_waitcnt lgkmcnt(3)
    v_mfma_f32_32x32x16_bf16 v[132:147], v[220:223], v[204:207], v[132:147]
    ds_read_b64_tr_b16 v[212:213], v128 offset:32768
    ds_read_b64_tr_b16 v[214:215], v128 offset:33792
    s_waitcnt lgkmcnt(4)
    v_mfma_f32_32x32x16_bf16 v[148:163], v[220:223], v[208:211], v[148:163]
    ds_read_b128 v[196:199], v116 offset:0
    ds_read_b128 v[200:203], v120 offset:0
    s_waitcnt lgkmcnt(4)
    v_mfma_f32_32x32x16_bf16 v[164:179], v[224:227], v[204:207], v[164:179]
    ds_read_b64_tr_b16 v[216:217], v129 offset:32768
    ds_read_b64_tr_b16 v[218:219], v129 offset:33792
    v_mfma_f32_32x32x16_bf16 v[180:195], v[224:227], v[208:211], v[180:195]
    s_waitcnt vmcnt(18)
.fsp_18:
    v_readfirstlane_b32 s39, v85
    s_nop 3
    s_cmp_ge_u32 s39, 2
    s_cbranch_scc1 .fok_17
    s_sleep 2
    buffer_load_dword v85, v84, s[64:67], 0 offen sc1
    s_waitcnt vmcnt(0)
    s_branch .fsp_18
.fok_17:
    s_lshl_b32 s40, s53, 7
    s_add_u32 s41, s40, 8192
    buffer_load_dword v80, v86, s[60:63], s40 offen sc1
    buffer_load_dword v82, v86, s[60:63], s41 offen sc1
    s_lshl_b32 s40, s54, 7
    s_add_u32 s41, s40, 8192
    buffer_load_dword v81, v86, s[60:63], s40 offen sc1
    buffer_load_dword v83, v86, s[60:63], s41 offen sc1
    s_barrier
    s_waitcnt lgkmcnt(3)
    v_mfma_f32_32x32x16_bf16 v[132:147], v[212:215], v[196:199], v[132:147]
    ds_read_b64_tr_b16 v[220:221], v128 offset:36864
    ds_read_b64_tr_b16 v[222:223], v128 offset:37888
    s_waitcnt lgkmcnt(4)
    v_mfma_f32_32x32x16_bf16 v[148:163], v[212:215], v[200:203], v[148:163]
    ds_read_b128 v[204:207], v117 offset:0
    ds_read_b128 v[208:211], v121 offset:0
    s_waitcnt lgkmcnt(4)
    v_mfma_f32_32x32x16_bf16 v[164:179], v[216:219], v[196:199], v[164:179]
    ds_read_b64_tr_b16 v[224:225], v129 offset:36864
    ds_read_b64_tr_b16 v[226:227], v129 offset:37888
    v_mfma_f32_32x32x16_bf16 v[180:195], v[216:219], v[200:203], v[180:195]
    s_waitcnt lgkmcnt(3)
    v_mfma_f32_32x32x16_bf16 v[132:147], v[220:223], v[204:207], v[132:147]
    ds_read_b64_tr_b16 v[212:213], v128 offset:40960
    ds_read_b64_tr_b16 v[214:215], v128 offset:41984
    s_waitcnt lgkmcnt(4)
    v_mfma_f32_32x32x16_bf16 v[148:163], v[220:223], v[208:211], v[148:163]
    ds_read_b128 v[196:199], v118 offset:0
    ds_read_b128 v[200:203], v122 offset:0
    s_waitcnt lgkmcnt(4)
    v_mfma_f32_32x32x16_bf16 v[164:179], v[224:227], v[204:207], v[164:179]
    ds_read_b64_tr_b16 v[216:217], v129 offset:40960
    ds_read_b64_tr_b16 v[218:219], v129 offset:41984
    v_mfma_f32_32x32x16_bf16 v[180:195], v[224:227], v[208:211], v[180:195]
    s_waitcnt lgkmcnt(3)
    v_mfma_f32_32x32x16_bf16 v[132:147], v[212:215], v[196:199], v[132:147]
    ds_read_b64_tr_b16 v[220:221], v128 offset:45056
    ds_read_b64_tr_b16 v[222:223], v128 offset:46080
    s_waitcnt lgkmcnt(4)
    v_mfma_f32_32x32x16_bf16 v[148:163], v[212:215], v[200:203], v[148:163]
    ds_read_b128 v[204:207], v119 offset:0
    ds_read_b128 v[208:211], v123 offset:0
    s_waitcnt lgkmcnt(4)
    v_mfma_f32_32x32x16_bf16 v[164:179], v[216:219], v[196:199], v[164:179]
    ds_read_b64_tr_b16 v[224:225], v129 offset:45056
    ds_read_b64_tr_b16 v[226:227], v129 offset:46080
    v_mfma_f32_32x32x16_bf16 v[180:195], v[216:219], v[200:203], v[180:195]
    s_waitcnt vmcnt(4)
    s_barrier
    s_waitcnt lgkmcnt(3)
    v_mfma_f32_32x32x16_bf16 v[132:147], v[220:223], v[204:207], v[132:147]
    ds_read_b64_tr_b16 v[212:213], v124 offset:32768
    ds_read_b64_tr_b16 v[214:215], v124 offset:33792
    s_waitcnt lgkmcnt(4)
    v_mfma_f32_32x32x16_bf16 v[148:163], v[220:223], v[208:211], v[148:163]
    ds_read_b128 v[196:199], v100 offset:0
    ds_read_b128 v[200:203], v104 offset:0
    s_waitcnt lgkmcnt(4)
    v_mfma_f32_32x32x16_bf16 v[164:179], v[224:227], v[204:207], v[164:179]
    ds_read_b64_tr_b16 v[216:217], v125 offset:32768
    ds_read_b64_tr_b16 v[218:219], v125 offset:33792
    v_mfma_f32_32x32x16_bf16 v[180:195], v[224:227], v[208:211], v[180:195]
    s_barrier
    s_waitcnt lgkmcnt(3)
    v_mfma_f32_32x32x16_bf16 v[132:147], v[212:215], v[196:199], v[132:147]
    ds_read_b64_tr_b16 v[220:221], v124 offset:36864
    ds_read_b64_tr_b16 v[222:223], v124 offset:37888
    s_waitcnt lgkmcnt(4)
    v_mfma_f32_32x32x16_bf16 v[148:163], v[212:215], v[200:203], v[148:163]
    ds_read_b128 v[204:207], v101 offset:0
    ds_read_b128 v[208:211], v105 offset:0
    s_waitcnt lgkmcnt(4)
    v_mfma_f32_32x32x16_bf16 v[164:179], v[216:219], v[196:199], v[164:179]
    ds_read_b64_tr_b16 v[224:225], v125 offset:36864
    ds_read_b64_tr_b16 v[226:227], v125 offset:37888
    v_mfma_f32_32x32x16_bf16 v[180:195], v[216:219], v[200:203], v[180:195]
    s_waitcnt lgkmcnt(3)
    v_mfma_f32_32x32x16_bf16 v[132:147], v[220:223], v[204:207], v[132:147]
    ds_read_b64_tr_b16 v[212:213], v124 offset:40960
    ds_read_b64_tr_b16 v[214:215], v124 offset:41984
    s_waitcnt lgkmcnt(4)
    v_mfma_f32_32x32x16_bf16 v[148:163], v[220:223], v[208:211], v[148:163]
    ds_read_b128 v[196:199], v102 offset:0
    ds_read_b128 v[200:203], v106 offset:0
    s_waitcnt lgkmcnt(4)
    v_mfma_f32_32x32x16_bf16 v[164:179], v[224:227], v[204:207], v[164:179]
    ds_read_b64_tr_b16 v[216:217], v125 offset:40960
    ds_read_b64_tr_b16 v[218:219], v125 offset:41984
    v_mfma_f32_32x32x16_bf16 v[180:195], v[224:227], v[208:211], v[180:195]
    s_waitcnt lgkmcnt(3)
    v_mfma_f32_32x32x16_bf16 v[132:147], v[212:215], v[196:199], v[132:147]
    ds_read_b64_tr_b16 v[220:221], v124 offset:45056
    ds_read_b64_tr_b16 v[222:223], v124 offset:46080
    s_waitcnt lgkmcnt(4)
    v_mfma_f32_32x32x16_bf16 v[148:163], v[212:215], v[200:203], v[148:163]
    ds_read_b128 v[204:207], v103 offset:0
    ds_read_b128 v[208:211], v107 offset:0
    s_waitcnt lgkmcnt(4)
    v_mfma_f32_32x32x16_bf16 v[164:179], v[216:219], v[196:199], v[164:179]
    ds_read_b64_tr_b16 v[224:225], v125 offset:45056
    ds_read_b64_tr_b16 v[226:227], v125 offset:46080
    v_mfma_f32_32x32x16_bf16 v[180:195], v[216:219], v[200:203], v[180:195]
    s_waitcnt lgkmcnt(3)
    v_mfma_f32_32x32x16_bf16 v[132:147], v[220:223], v[204:207], v[132:147]
    s_waitcnt lgkmcnt(2)
    v_mfma_f32_32x32x16_bf16 v[148:163], v[220:223], v[208:211], v[148:163]
    s_waitcnt lgkmcnt(0)
    v_mfma_f32_32x32x16_bf16 v[164:179], v[224:227], v[204:207], v[164:179]
    v_mfma_f32_32x32x16_bf16 v[180:195], v[224:227], v[208:211], v[180:195]
    s_branch .e1epi_12
.e1v_11:
    s_cmp_ge_u32 s35, 2
    s_cbranch_scc1 .nocs_19
    s_waitcnt vmcnt(14)
    s_waitcnt lgkmcnt(0)
    s_barrier
    ds_read_b64_tr_b16 v[212:213], v124 offset:32768
    ds_read_b64_tr_b16 v[214:215], v124 offset:33792
    ds_read_b128 v[196:199], v100 offset:0
    ds_read_b128 v[200:203], v104 offset:0
    ds_read_b64_tr_b16 v[216:217], v125 offset:32768
    ds_read_b64_tr_b16 v[218:219], v125 offset:33792
    s_waitcnt lgkmcnt(3)
    v_mfma_f32_32x32x16_bf16 v[132:147], v[196:199], v[212:215], 0
    ds_read_b64_tr_b16 v[220:221], v124 offset:36864
    ds_read_b64_tr_b16 v[222:223], v124 offset:37888
    s_add_u32 m0, s50, 98304
    s_mov_b32 s42, 256
    buffer_load_dwordx4 v6, s[16:19], s42 offen offset:0 lds
    s_waitcnt lgkmcnt(4)
    v_mfma_f32_32x32x16_bf16 v[148:163], v[200:203], v[212:215], 0
    ds_read_b128 v[204:207], v101 offset:0
    ds_read_b128 v[208:211], v105 offset:0
    v_mfma_f32_16x16x32_bf16 v[228:231], v[212:215], v[232:235], 0
    buffer_load_dwordx4 v7, s[16:19], s42 offen offset:1024 lds
    s_waitcnt lgkmcnt(4)
    v_mfma_f32_32x32x16_bf16 v[164:179], v[196:199], v[216:219], 0
    ds_read_b64_tr_b16 v[224:225], v125 offset:36864
    ds_read_b64_tr_b16 v[226:227], v125 offset:37888
    v_mfma_f32_32x32x16_bf16 v[180:195], v[200:203], v[216:219], 0
    s_waitcnt lgkmcnt(3)
    v_mfma_f32_32x32x16_bf16 v[132:147], v[204:207], v[220:223], v[132:147]
    ds_read_b64_tr_b16 v[212:213], v124 offset:40960
    ds_read_b64_tr_b16 v[214:215], v124 offset:41984
    buffer_load_dwordx4 v8, s[16:19], s42 offen offset:2048 lds
    s_waitcnt lgkmcnt(4)
    v_mfma_f32_32x32x16_bf16 v[148:163], v[208:211], v[220:223], v[148:163]
    ds_read_b128 v[196:199], v102 offset:0
    ds_read_b128 v[200:203], v106 offset:0
    v_mfma_f32_16x16x32_bf16 v[228:231], v[220:223], v[232:235], v[228:231]
    buffer_load_dwordx4 v9, s[16:19], s42 offen offset:3072 lds
    s_waitcnt lgkmcnt(4)
    v_mfma_f32_32x32x16_bf16 v[164:179], v[204:207], v[224:227], v[164:179]
    ds_read_b64_tr_b16 v[216:217], v125 offset:40960
    ds_read_b64_tr_b16 v[218:219], v125 offset:41984
    v_mfma_f32_32x32x16_bf16 v[180:195], v[208:211], v[224:227], v[180:195]
    s_waitcnt lgkmcnt(3)
    v_mfma_f32_32x32x16_bf16 v[132:147], v[196:199], v[212:215], v[132:147]
    ds_read_b64_tr_b16 v[220:221], v124 offset:45056
    ds_read_b64_tr_b16 v[222:223], v124 offset:46080
    s_add_u32 m0, s51, 98304
    s_mul_i32 s43, s52, 2
    buffer_load_dwordx4 v10, s[20:23], s43 offen offset:0 lds
    s_waitcnt lgkmcnt(4)
    v_mfma_f32_32x32x16_bf16 v[148:163], v[200:203], v[212:215], v[148:163]
    ds_read_b128 v[204:207], v103 offset:0
    ds_read_b128 v[208:211], v107 offset:0
    v_mfma_f32_16x16x32_bf16 v[228:231], v[212:215], v[232:235], v[228:231]
    buffer_load_dwordx4 v11, s[20:23], s43 offen offset:1024 lds
    s_waitcnt lgkmcnt(4)
    v_mfma_f32_32x32x16_bf16 v[164:179], v[196:199], v[216:219], v[164:179]
    ds_read_b64_tr_b16 v[224:225], v125 offset:45056
    ds_read_b64_tr_b16 v[226:227], v125 offset:46080
    v_mfma_f32_32x32x16_bf16 v[180:195], v[200:203], v[216:219], v[180:195]
    s_waitcnt vmcnt(14)
    s_barrier
    s_waitcnt lgkmcnt(3)
    v_mfma_f32_32x32x16_bf16 v[132:147], v[204:207], v[220:223], v[132:147]
    ds_read_b64_tr_b16 v[212:213], v126 offset:32768
    ds_read_b64_tr_b16 v[214:215], v126 offset:33792
    s_waitcnt lgkmcnt(4)
    v_mfma_f32_32x32x16_bf16 v[148:163], v[208:211], v[220:223], v[148:163]
    ds_read_b128 v[196:199], v108 offset:0
    ds_read_b128 v[200:203], v112 offset:0
    v_mfma_f32_16x16x32_bf16 v[228:231], v[220:223], v[232:235], v[228:231]
    s_waitcnt lgkmcnt(4)
    v_mfma_f32_32x32x16_bf16 v[164:179], v[204:207], v[224:227], v[164:179]
    ds_read_b64_tr_b16 v[216:217], v127 offset:32768
    ds_read_b64_tr_b16 v[218:219], v127 offset:33792
    v_mfma_f32_32x32x16_bf16 v[180:195], v[208:211], v[224:227], v[180:195]
    s_barrier
    s_waitcnt lgkmcnt(3)
    v_mfma_f32_32x32x16_bf16 v[132:147], v[196:199], v[212:215], v[132:147]
    ds_read_b64_tr_b16 v[220:221], v126 offset:36864
    ds_read_b64_tr_b16 v[222:223], v126 offset:37888
    s_add_u32 m0, s50, 0
    s_mov_b32 s42, 384
    buffer_load_dwordx4 v6, s[16:19], s42 offen offset:0 lds
    s_waitcnt lgkmcnt(4)
    v_mfma_f32_32x32x16_bf16 v[148:163], v[200:203], v[212:215], v[148:163]
    ds_read_b128 v[204:207], v109 offset:0
    ds_read_b128 v[208:211], v113 offset:0
    v_mfma_f32_16x16x32_bf16 v[228:231], v[212:215], v[232:235], v[228:231]
    buffer_load_dwordx4 v7, s[16:19], s42 offen offset:1024 lds
    s_waitcnt lgkmcnt(4)
    v_mfma_f32_32x32x16_bf16 v[164:179], v[196:199], v[216:219], v[164:179]
    ds_read_b64_tr_b16 v[224:225], v127 offset:36864
    ds_read_b64_tr_b16 v[226:227], v127 offset:37888
    v_mfma_f32_32x32x16_bf16 v[180:195], v[200:203], v[216:219], v[180:195]
    s_waitcnt lgkmcnt(3)
    v_mfma_f32_32x32x16_bf16 v[132:147], v[204:207], v[220:223], v[132:147]
    ds_read_b64_tr_b16 v[212:213], v126 offset:40960
    ds_read_b64_tr_b16 v[214:215], v126 offset:41984
    buffer_load_dwordx4 v8, s[16:19], s42 offen offset:2048 lds
    s_waitcnt lgkmcnt(4)
    v_mfma_f32_32x32x16_bf16 v[148:163], v[208:211], v[220:223], v[148:163]
    ds_read_b128 v[196:199], v110 offset:0
    ds_read_b128 v[200:203], v114 offset:0
    v_mfma_f32_16x16x32_bf16 v[228:231], v[220:223], v[232:235], v[228:231]
    buffer_load_dwordx4 v9, s[16:19], s42 offen offset:3072 lds
    s_waitcnt lgkmcnt(4)
    v_mfma_f32_32x32x16_bf16 v[164:179], v[204:207], v[224:227], v[164:179]
    ds_read_b64_tr_b16 v[216:217], v127 offset:40960
    ds_read_b64_tr_b16 v[218:219], v127 offset:41984
    v_mfma_f32_32x32x16_bf16 v[180:195], v[208:211], v[224:227], v[180:195]
    s_waitcnt lgkmcnt(3)
    v_mfma_f32_32x32x16_bf16 v[132:147], v[196:199], v[212:215], v[132:147]
    ds_read_b64_tr_b16 v[220:221], v126 offset:45056
    ds_read_b64_tr_b16 v[222:223], v126 offset:46080
    s_add_u32 m0, s51, 0
    s_mul_i32 s43, s52, 3
    buffer_load_dwordx4 v10, s[20:23], s43 offen offset:0 lds
    s_waitcnt lgkmcnt(4)
    v_mfma_f32_32x32x16_bf16 v[148:163], v[200:203], v[212:215], v[148:163]
    ds_read_b128 v[204:207], v111 offset:0
    ds_read_b128 v[208:211], v115 offset:0
    v_mfma_f32_16x16x32_bf16 v[228:231], v[212:215], v[232:235], v[228:231]
    buffer_load_dwordx4 v11, s[20:23], s43 offen offset:1024 lds
    s_waitcnt lgkmcnt(4)
    v_mfma_f32_32x32x16_bf16 v[164:179], v[196:199], v[216:219], v[164:179]
    ds_read_b64_tr_b16 v[224:225], v127 offset:45056
    ds_read_b64_tr_b16 v[226:227], v127 offset:46080
    v_mfma_f32_32x32x16_bf16 v[180:195], v[200:203], v[216:219], v[180:195]
    s_waitcnt vmcnt(6)
    s_barrier
    s_waitcnt lgkmcnt(3)
    v_mfma_f32_32x32x16_bf16 v[132:147], v[204:207], v[220:223], v[132:147]
    ds_read_b64_tr_b16 v[212:213], v128 offset:32768
    ds_read_b64_tr_b16 v[214:215], v128 offset:33792
    s_waitcnt lgkmcnt(4)
    v_mfma_f32_32x32x16_bf16 v[148:163], v[208:211], v[220:223], v[148:163]
    ds_read_b128 v[196:199], v116 offset:0
    ds_read_b128 v[200:203], v120 offset:0
    v_mfma_f32_16x16x32_bf16 v[228:231], v[220:223], v[232:235], v[228:231]
    s_waitcnt lgkmcnt(4)
    v_mfma_f32_32x32x16_bf16 v[164:179], v[204:207], v[224:227], v[164:179]
    ds_read_b64_tr_b16 v[216:217], v129 offset:32768
    ds_read_b64_tr_b16 v[218:219], v129 offset:33792
    v_mfma_f32_32x32x16_bf16 v[180:195], v[208:211], v[224:227], v[180:195]
    s_barrier
    s_waitcnt lgkmcnt(3)
    v_mfma_f32_32x32x16_bf16 v[132:147], v[196:199], v[212:215], v[132:147]
    ds_read_b64_tr_b16 v[220:221], v128 offset:36864
    ds_read_b64_tr_b16 v[222:223], v128 offset:37888
    s_add_u32 m0, s50, 49152
    s_mov_b32 s42, 512
    buffer_load_dwordx4 v6, s[16:19], s42 offen offset:0 lds
    s_waitcnt lgkmcnt(4)
    v_mfma_f32_32x32x16_bf16 v[148:163], v[200:203], v[212:215], v[148:163]
    ds_read_b128 v[204:207], v117 offset:0
    ds_read_b128 v[208:211], v121 offset:0
    v_mfma_f32_16x16x32_bf16 v[228:231], v[212:215], v[232:235], v[228:231]
    buffer_load_dwordx4 v7, s[16:19], s42 offen offset:1024 lds
    s_waitcnt lgkmcnt(4)
    v_mfma_f32_32x32x16_bf16 v[164:179], v[196:199], v[216:219], v[164:179]
    ds_read_b64_tr_b16 v[224:225], v129 offset:36864
    ds_read_b64_tr_b16 v[226:227], v129 offset:37888
    v_mfma_f32_32x32x16_bf16 v[180:195], v[200:203], v[216:219], v[180:195]
    s_waitcnt lgkmcnt(3)
    v_mfma_f32_32x32x16_bf16 v[132:147], v[204:207], v[220:223], v[132:147]
    ds_read_b64_tr_b16 v[212:213], v128 offset:40960
    ds_read_b64_tr_b16 v[214:215], v128 offset:41984
    buffer_load_dwordx4 v8, s[16:19], s42 offen offset:2048 lds
    s_waitcnt lgkmcnt(4)
    v_mfma_f32_32x32x16_bf16 v[148:163], v[208:211], v[220:223], v[148:163]
    ds_read_b128 v[196:199], v118 offset:0
    ds_read_b128 v[200:203], v122 offset:0
    v_mfma_f32_16x16x32_bf16 v[228:231], v[220:223], v[232:235], v[228:231]
    buffer_load_dwordx4 v9, s[16:19], s42 offen offset:3072 lds
    s_waitcnt lgkmcnt(4)
    v_mfma_f32_32x32x16_bf16 v[164:179], v[204:207], v[224:227], v[164:179]
    ds_read_b64_tr_b16 v[216:217], v129 offset:40960
    ds_read_b64_tr_b16 v[218:219], v129 offset:41984
    v_mfma_f32_32x32x16_bf16 v[180:195], v[208:211], v[224:227], v[180:195]
    s_waitcnt lgkmcnt(3)
    v_mfma_f32_32x32x16_bf16 v[132:147], v[196:199], v[212:215], v[132:147]
    ds_read_b64_tr_b16 v[220:221], v128 offset:45056
    ds_read_b64_tr_b16 v[222:223], v128 offset:46080
    s_add_u32 m0, s51, 49152
    s_mul_i32 s43, s52, 4
    buffer_load_dwordx4 v10, s[20:23], s43 offen offset:0 lds
    s_waitcnt lgkmcnt(4)
    v_mfma_f32_32x32x16_bf16 v[148:163], v[200:203], v[212:215], v[148:163]
    ds_read_b128 v[204:207], v119 offset:0
    ds_read_b128 v[208:211], v123 offset:0
    v_mfma_f32_16x16x32_bf16 v[228:231], v[212:215], v[232:235], v[228:231]
    buffer_load_dwordx4 v11, s[20:23], s43 offen offset:1024 lds
    s_waitcnt lgkmcnt(4)
    v_mfma_f32_32x32x16_bf16 v[164:179], v[196:199], v[216:219], v[164:179]
    ds_read_b64_tr_b16 v[224:225], v129 offset:45056
    ds_read_b64_tr_b16 v[226:227], v129 offset:46080
    v_mfma_f32_32x32x16_bf16 v[180:195], v[200:203], v[216:219], v[180:195]
    s_waitcnt vmcnt(6)
    s_barrier
    s_waitcnt lgkmcnt(3)
    v_mfma_f32_32x32x16_bf16 v[132:147], v[204:207], v[220:223], v[132:147]
    ds_read_b64_tr_b16 v[212:213], v124 offset:32768
    ds_read_b64_tr_b16 v[214:215], v124 offset:33792
    s_waitcnt lgkmcnt(4)
    v_mfma_f32_32x32x16_bf16 v[148:163], v[208:211], v[220:223], v[148:163]
    ds_read_b128 v[196:199], v100 offset:0
    ds_read_b128 v[200:203], v104 offset:0
    v_mfma_f32_16x16x32_bf16 v[228:231], v[220:223], v[232:235], v[228:231]
    s_waitcnt lgkmcnt(4)
    v_mfma_f32_32x32x16_bf16 v[164:179], v[204:207], v[224:227], v[164:179]
    ds_read_b64_tr_b16 v[216:217], v125 offset:32768
    ds_read_b64_tr_b16 v[218:219], v125 offset:33792
    v_mfma_f32_32x32x16_bf16 v[180:195], v[208:211], v[224:227], v[180:195]
    s_barrier
    s_waitcnt lgkmcnt(3)
    v_mfma_f32_32x32x16_bf16 v[132:147], v[196:199], v[212:215], v[132:147]
    ds_read_b64_tr_b16 v[220:221], v124 offset:36864
    ds_read_b64_tr_b16 v[222:223], v124 offset:37888
    s_add_u32 m0, s50, 98304
    s_mov_b32 s42, 640
    buffer_load_dwordx4 v6, s[16:19], s42 offen offset:0 lds
    s_waitcnt lgkmcnt(4)
    v_mfma_f32_32x32x16_bf16 v[148:163], v[200:203], v[212:215], v[148:163]
    ds_read_b128 v[204:207], v101 offset:0
    ds_read_b128 v[208:211], v105 offset:0
    v_mfma_f32_16x16x32_bf16 v[228:231], v[212:215], v[232:235], v[228:231]
    buffer_load_dwordx4 v7, s[16:19], s42 offen offset:1024 lds
    s_waitcnt lgkmcnt(4)
    v_mfma_f32_32x32x16_bf16 v[164:179], v[196:199], v[216:219], v[164:179]
    ds_read_b64_tr_b16 v[224:225], v125 offset:36864
    ds_read_b64_tr_b16 v[226:227], v125 offset:37888
    v_mfma_f32_32x32x16_bf16 v[180:195], v[200:203], v[216:219], v[180:195]
    s_waitcnt lgkmcnt(3)
    v_mfma_f32_32x32x16_bf16 v[132:147], v[204:207], v[220:223], v[132:147]
    ds_read_b64_tr_b16 v[212:213], v124 offset:40960
    ds_read_b64_tr_b16 v[214:215], v124 offset:41984
    buffer_load_dwordx4 v8, s[16:19], s42 offen offset:2048 lds
    s_waitcnt lgkmcnt(4)
    v_mfma_f32_32x32x16_bf16 v[148:163], v[208:211], v[220:223], v[148:163]
    ds_read_b128 v[196:199], v102 offset:0
    ds_read_b128 v[200:203], v106 offset:0
    v_mfma_f32_16x16x32_bf16 v[228:231], v[220:223], v[232:235], v[228:231]
    buffer_load_dwordx4 v9, s[16:19], s42 offen offset:3072 lds
    s_waitcnt lgkmcnt(4)
    v_mfma_f32_32x32x16_bf16 v[164:179], v[204:207], v[224:227], v[164:179]
    ds_read_b64_tr_b16 v[216:217], v125 offset:40960
    ds_read_b64_tr_b16 v[218:219], v125 offset:41984
    v_mfma_f32_32x32x16_bf16 v[180:195], v[208:211], v[224:227], v[180:195]
    s_waitcnt lgkmcnt(3)
    v_mfma_f32_32x32x16_bf16 v[132:147], v[196:199], v[212:215], v[132:147]
    ds_read_b64_tr_b16 v[220:221], v124 offset:45056
    ds_read_b64_tr_b16 v[222:223], v124 offset:46080
    s_add_u32 m0, s51, 98304
    s_mul_i32 s43, s52, 5
    buffer_load_dwordx4 v10, s[20:23], s43 offen offset:0 lds
    s_waitcnt lgkmcnt(4)
    v_mfma_f32_32x32x16_bf16 v[148:163], v[200:203], v[212:215], v[148:163]
    ds_read_b128 v[204:207], v103 offset:0
    ds_read_b128 v[208:211], v107 offset:0
    v_mfma_f32_16x16x32_bf16 v[228:231], v[212:215], v[232:235], v[228:231]
    buffer_load_dwordx4 v11, s[20:23], s43 offen offset:1024 lds
    s_waitcnt lgkmcnt(4)
    v_mfma_f32_32x32x16_bf16 v[164:179], v[196:199], v[216:219], v[164:179]
    ds_read_b64_tr_b16 v[224:225], v125 offset:45056
    ds_read_b64_tr_b16 v[226:227], v125 offset:46080
    v_mfma_f32_32x32x16_bf16 v[180:195], v[200:203], v[216:219], v[180:195]
    s_waitcnt vmcnt(6)
    s_barrier
    s_waitcnt lgkmcnt(3)
    v_mfma_f32_32x32x16_bf16 v[132:147], v[204:207], v[220:223], v[132:147]
    ds_read_b64_tr_b16 v[212:213], v126 offset:32768
    ds_read_b64_tr_b16 v[214:215], v126 offset:33792
    s_waitcnt lgkmcnt(4)
    v_mfma_f32_32x32x16_bf16 v[148:163], v[208:211], v[220:223], v[148:163]
    ds_read_b128 v[196:199], v108 offset:0
    ds_read_b128 v[200:203], v112 offset:0
    v_mfma_f32_16x16x32_bf16 v[228:231], v[220:223], v[232:235], v[228:231]
    s_waitcnt lgkmcnt(4)
    v_mfma_f32_32x32x16_bf16 v[164:179], v[204:207], v[224:227], v[164:179]
    ds_read_b64_tr_b16 v[216:217], v127 offset:32768
    ds_read_b64_tr_b16 v[218:219], v127 offset:33792
    v_mfma_f32_32x32x16_bf16 v[180:195], v[208:211], v[224:227], v[180:195]
    s_barrier
    s_waitcnt lgkmcnt(3)
    v_mfma_f32_32x32x16_bf16 v[132:147], v[196:199], v[212:215], v[132:147]
    ds_read_b64_tr_b16 v[220:221], v126 offset:36864
    ds_read_b64_tr_b16 v[222:223], v126 offset:37888
    s_add_u32 m0, s50, 0
    s_mov_b32 s42, 768
    buffer_load_dwordx4 v6, s[16:19], s42 offen offset:0 lds
    s_waitcnt lgkmcnt(4)
    v_mfma_f32_32x32x16_bf16 v[148:163], v[200:203], v[212:215], v[148:163]
    ds_read_b128 v[204:207], v109 offset:0
    ds_read_b128 v[208:211], v113 offset:0
    v_mfma_f32_16x16x32_bf16 v[228:231], v[212:215], v[232:235], v[228:231]
    buffer_load_dwordx4 v7, s[16:19], s42 offen offset:1024 lds
    s_waitcnt lgkmcnt(4)
    v_mfma_f32_32x32x16_bf16 v[164:179], v[196:199], v[216:219], v[164:179]
    ds_read_b64_tr_b16 v[224:225], v127 offset:36864
    ds_read_b64_tr_b16 v[226:227], v127 offset:37888
    v_mfma_f32_32x32x16_bf16 v[180:195], v[200:203], v[216:219], v[180:195]
    s_waitcnt lgkmcnt(3)
    v_mfma_f32_32x32x16_bf16 v[132:147], v[204:207], v[220:223], v[132:147]
    ds_read_b64_tr_b16 v[212:213], v126 offset:40960
    ds_read_b64_tr_b16 v[214:215], v126 offset:41984
    buffer_load_dwordx4 v8, s[16:19], s42 offen offset:2048 lds
    s_waitcnt lgkmcnt(4)
    v_mfma_f32_32x32x16_bf16 v[148:163], v[208:211], v[220:223], v[148:163]
    ds_read_b128 v[196:199], v110 offset:0
    ds_read_b128 v[200:203], v114 offset:0
    v_mfma_f32_16x16x32_bf16 v[228:231], v[220:223], v[232:235], v[228:231]
    buffer_load_dwordx4 v9, s[16:19], s42 offen offset:3072 lds
    s_waitcnt lgkmcnt(4)
    v_mfma_f32_32x32x16_bf16 v[164:179], v[204:207], v[224:227], v[164:179]
    ds_read_b64_tr_b16 v[216:217], v127 offset:40960
    ds_read_b64_tr_b16 v[218:219], v127 offset:41984
    v_mfma_f32_32x32x16_bf16 v[180:195], v[208:211], v[224:227], v[180:195]
    s_waitcnt lgkmcnt(3)
    v_mfma_f32_32x32x16_bf16 v[132:147], v[196:199], v[212:215], v[132:147]
    ds_read_b64_tr_b16 v[220:221], v126 offset:45056
    ds_read_b64_tr_b16 v[222:223], v126 offset:46080
    s_add_u32 m0, s51, 0
    s_mul_i32 s43, s52, 6
    buffer_load_dwordx4 v10, s[20:23], s43 offen offset:0 lds
    s_waitcnt lgkmcnt(4)
    v_mfma_f32_32x32x16_bf16 v[148:163], v[200:203], v[212:215], v[148:163]
    ds_read_b128 v[204:207], v111 offset:0
    ds_read_b128 v[208:211], v115 offset:0
    v_mfma_f32_16x16x32_bf16 v[228:231], v[212:215], v[232:235], v[228:231]
    buffer_load_dwordx4 v11, s[20:23], s43 offen offset:1024 lds
    s_waitcnt lgkmcnt(4)
    v_mfma_f32_32x32x16_bf16 v[164:179], v[196:199], v[216:219], v[164:179]
    ds_read_b64_tr_b16 v[224:225], v127 offset:45056
    ds_read_b64_tr_b16 v[226:227], v127 offset:46080
    v_mfma_f32_32x32x16_bf16 v[180:195], v[200:203], v[216:219], v[180:195]
    s_waitcnt vmcnt(6)
    s_barrier
    s_waitcnt lgkmcnt(3)
    v_mfma_f32_32x32x16_bf16 v[132:147], v[204:207], v[220:223], v[132:147]
    ds_read_b64_tr_b16 v[212:213], v128 offset:32768
    ds_read_b64_tr_b16 v[214:215], v128 offset:33792
    s_waitcnt lgkmcnt(4)
    v_mfma_f32_32x32x16_bf16 v[148:163], v[208:211], v[220:223], v[148:163]
    ds_read_b128 v[196:199], v116 offset:0
    ds_read_b128 v[200:203], v120 offset:0
    v_mfma_f32_16x16x32_bf16 v[228:231], v[220:223], v[232:235], v[228:231]
    s_waitcnt lgkmcnt(4)
    v_mfma_f32_32x32x16_bf16 v[164:179], v[204:207], v[224:227], v[164:179]
    ds_read_b64_tr_b16 v[216:217], v129 offset:32768
    ds_read_b64_tr_b16 v[218:219], v129 offset:33792
    v_mfma_f32_32x32x16_bf16 v[180:195], v[208:211], v[224:227], v[180:195]
    buffer_load_dword v85, v84, s[64:67], 0 offen sc1
    s_barrier
    s_waitcnt lgkmcnt(3)
    v_mfma_f32_32x32x16_bf16 v[132:147], v[196:199], v[212:215], v[132:147]
    ds_read_b64_tr_b16 v[220:221], v128 offset:36864
    ds_read_b64_tr_b16 v[222:223], v128 offset:37888
    s_add_u32 m0, s50, 49152
    s_mov_b32 s42, 896
    buffer_load_dwordx4 v6, s[16:19], s42 offen offset:0 lds
    s_waitcnt lgkmcnt(4)
    v_mfma_f32_32x32x16_bf16 v[148:163], v[200:203], v[212:215], v[148:163]
    ds_read_b128 v[204:207], v117 offset:0
    ds_read_b128 v[208:211], v121 offset:0
    v_mfma_f32_16x16x32_bf16 v[228:231], v[212:215], v[232:235], v[228:231]
    buffer_load_dwordx4 v7, s[16:19], s42 offen offset:1024 lds
    s_waitcnt lgkmcnt(4)
    v_mfma_f32_32x32x16_bf16 v[164:179], v[196:199], v[216:219], v[164:179]
    ds_read_b64_tr_b16 v[224:225], v129 offset:36864
    ds_read_b64_tr_b16 v[226:227], v129 offset:37888
    v_mfma_f32_32x32x16_bf16 v[180:195], v[200:203], v[216:219], v[180:195]
    s_waitcnt lgkmcnt(3)
    v_mfma_f32_32x32x16_bf16 v[132:147], v[204:207], v[220:223], v[132:147]
    ds_read_b64_tr_b16 v[212:213], v128 offset:40960
    ds_read_b64_tr_b16 v[214:215], v128 offset:41984
    buffer_load_dwordx4 v8, s[16:19], s42 offen offset:2048 lds
    s_waitcnt lgkmcnt(4)
    v_mfma_f32_32x32x16_bf16 v[148:163], v[208:211], v[220:223], v[148:163]
    ds_read_b128 v[196:199], v118 offset:0
    ds_read_b128 v[200:203], v122 offset:0
    v_mfma_f32_16x16x32_bf16 v[228:231], v[220:223], v[232:235], v[228:231]
    buffer_load_dwordx4 v9, s[16:19], s42 offen offset:3072 lds
    s_waitcnt lgkmcnt(4)
    v_mfma_f32_32x32x16_bf16 v[164:179], v[204:207], v[224:227], v[164:179]
    ds_read_b64_tr_b16 v[216:217], v129 offset:40960
    ds_read_b64_tr_b16 v[218:219], v129 offset:41984
    v_mfma_f32_32x32x16_bf16 v[180:195], v[208:211], v[224:227], v[180:195]
    s_waitcnt lgkmcnt(3)
    v_mfma_f32_32x32x16_bf16 v[132:147], v[196:199], v[212:215], v[132:147]
    ds_read_b64_tr_b16 v[220:221], v128 offset:45056
    ds_read_b64_tr_b16 v[222:223], v128 offset:46080
    s_add_u32 m0, s51, 49152
    s_mul_i32 s43, s52, 7
    buffer_load_dwordx4 v10, s[20:23], s43 offen offset:0 lds
    s_waitcnt lgkmcnt(4)
    v_mfma_f32_32x32x16_bf16 v[148:163], v[200:203], v[212:215], v[148:163]
    ds_read_b128 v[204:207], v119 offset:0
    ds_read_b128 v[208:211], v123 offset:0
    v_mfma_f32_16x16x32_bf16 v[228:231], v[212:215], v[232:235], v[228:231]
    buffer_load_dwordx4 v11, s[20:23], s43 offen offset:1024 lds
    s_waitcnt lgkmcnt(4)
    v_mfma_f32_32x32x16_bf16 v[164:179], v[196:199], v[216:219], v[164:179]
    ds_read_b64_tr_b16 v[224:225], v129 offset:45056
    ds_read_b64_tr_b16 v[226:227], v129 offset:46080
    v_mfma_f32_32x32x16_bf16 v[180:195], v[200:203], v[216:219], v[180:195]
    s_waitcnt vmcnt(7)
    s_barrier
    s_waitcnt lgkmcnt(3)
    v_mfma_f32_32x32x16_bf16 v[132:147], v[204:207], v[220:223], v[132:147]
    ds_read_b64_tr_b16 v[212:213], v124 offset:32768
    ds_read_b64_tr_b16 v[214:215], v124 offset:33792
    s_waitcnt lgkmcnt(4)
    v_mfma_f32_32x32x16_bf16 v[148:163], v[208:211], v[220:223], v[148:163]
    ds_read_b128 v[196:199], v100 offset:0
    ds_read_b128 v[200:203], v104 offset:0
    v_mfma_f32_16x16x32_bf16 v[228:231], v[220:223], v[232:235], v[228:231]
    s_waitcnt lgkmcnt(4)
    v_mfma_f32_32x32x16_bf16 v[164:179], v[204:207], v[224:227], v[164:179]
    ds_read_b64_tr_b16 v[216:217], v125 offset:32768
    ds_read_b64_tr_b16 v[218:219], v125 offset:33792
    v_mfma_f32_32x32x16_bf16 v[180:195], v[208:211], v[224:227], v[180:195]
    s_barrier
    s_waitcnt lgkmcnt(3)
    v_mfma_f32_32x32x16_bf16 v[132:147], v[196:199], v[212:215], v[132:147]
    ds_read_b64_tr_b16 v[220:221], v124 offset:36864
    ds_read_b64_tr_b16 v[222:223], v124 offset:37888
    s_add_u32 m0, s50, 98304
    s_mov_b32 s42, 1024
    buffer_load_dwordx4 v6, s[16:19], s42 offen offset:0 lds
    s_waitcnt lgkmcnt(4)
    v_mfma_f32_32x32x16_bf16 v[148:163], v[200:203], v[212:215], v[148:163]
    ds_read_b128 v[204:207], v101 offset:0
    ds_read_b128 v[208:211], v105 offset:0
    v_mfma_f32_16x16x32_bf16 v[228:231], v[212:215], v[232:235], v[228:231]
    buffer_load_dwordx4 v7, s[16:19], s42 offen offset:1024 lds
    s_waitcnt lgkmcnt(4)
    v_mfma_f32_32x32x16_bf16 v[164:179], v[196:199], v[216:219], v[164:179]
    ds_read_b64_tr_b16 v[224:225], v125 offset:36864
    ds_read_b64_tr_b16 v[226:227], v125 offset:37888
    v_mfma_f32_32x32x16_bf16 v[180:195], v[200:203], v[216:219], v[180:195]
    s_waitcnt lgkmcnt(3)
    v_mfma_f32_32x32x16_bf16 v[132:147], v[204:207], v[220:223], v[132:147]
    ds_read_b64_tr_b16 v[212:213], v124 offset:40960
    ds_read_b64_tr_b16 v[214:215], v124 offset:41984
    buffer_load_dwordx4 v8, s[16:19], s42 offen offset:2048 lds
    s_waitcnt lgkmcnt(4)
    v_mfma_f32_32x32x16_bf16 v[148:163], v[208:211], v[220:223], v[148:163]
    ds_read_b128 v[196:199], v102 offset:0
    ds_read_b128 v[200:203], v106 offset:0
    v_mfma_f32_16x16x32_bf16 v[228:231], v[220:223], v[232:235], v[228:231]
    buffer_load_dwordx4 v9, s[16:19], s42 offen offset:3072 lds
    s_waitcnt lgkmcnt(4)
    v_mfma_f32_32x32x16_bf16 v[164:179], v[204:207], v[224:227], v[164:179]
    ds_read_b64_tr_b16 v[216:217], v125 offset:40960
    ds_read_b64_tr_b16 v[218:219], v125 offset:41984
    v_mfma_f32_32x32x16_bf16 v[180:195], v[208:211], v[224:227], v[180:195]
    s_waitcnt lgkmcnt(3)
    v_mfma_f32_32x32x16_bf16 v[132:147], v[196:199], v[212:215], v[132:147]
    ds_read_b64_tr_b16 v[220:221], v124 offset:45056
    ds_read_b64_tr_b16 v[222:223], v124 offset:46080
    s_add_u32 m0, s51, 98304
    s_mul_i32 s43, s52, 8
    buffer_load_dwordx4 v10, s[20:23], s43 offen offset:0 lds
    s_waitcnt lgkmcnt(4)
    v_mfma_f32_32x32x16_bf16 v[148:163], v[200:203], v[212:215], v[148:163]
    ds_read_b128 v[204:207], v103 offset:0
    ds_read_b128 v[208:211], v107 offset:0
    v_mfma_f32_16x16x32_bf16 v[228:231], v[212:215], v[232:235], v[228:231]
    buffer_load_dwordx4 v11, s[20:23], s43 offen offset:1024 lds
    s_waitcnt lgkmcnt(4)
    v_mfma_f32_32x32x16_bf16 v[164:179], v[196:199], v[216:219], v[164:179]
    ds_read_b64_tr_b16 v[224:225], v125 offset:45056
    ds_read_b64_tr_b16 v[226:227], v125 offset:46080
    v_mfma_f32_32x32x16_bf16 v[180:195], v[200:203], v[216:219], v[180:195]
    s_waitcnt vmcnt(6)
    s_barrier
    s_waitcnt lgkmcnt(3)
    v_mfma_f32_32x32x16_bf16 v[132:147], v[204:207], v[220:223], v[132:147]
    ds_read_b64_tr_b16 v[212:213], v126 offset:32768
    ds_read_b64_tr_b16 v[214:215], v126 offset:33792
    s_waitcnt lgkmcnt(4)
    v_mfma_f32_32x32x16_bf16 v[148:163], v[208:211], v[220:223], v[148:163]
    ds_read_b128 v[196:199], v108 offset:0
    ds_read_b128 v[200:203], v112 offset:0
    v_mfma_f32_16x16x32_bf16 v[228:231], v[220:223], v[232:235], v[228:231]
    s_waitcnt lgkmcnt(4)
    v_mfma_f32_32x32x16_bf16 v[164:179], v[204:207], v[224:227], v[164:179]
    ds_read_b64_tr_b16 v[216:217], v127 offset:32768
    ds_read_b64_tr_b16 v[218:219], v127 offset:33792
    v_mfma_f32_32x32x16_bf16 v[180:195], v[208:211], v[224:227], v[180:195]
    s_barrier
    s_waitcnt lgkmcnt(3)
    v_mfma_f32_32x32x16_bf16 v[132:147], v[196:199], v[212:215], v[132:147]
    ds_read_b64_tr_b16 v[220:221], v126 offset:36864
    ds_read_b64_tr_b16 v[222:223], v126 offset:37888
    s_add_u32 m0, s50, 0
    s_mov_b32 s42, 1152
    buffer_load_dwordx4 v6, s[16:19], s42 offen offset:0 lds
    s_waitcnt lgkmcnt(4)
    v_mfma_f32_32x32x16_bf16 v[148:163], v[200:203], v[212:215], v[148:163]
    ds_read_b128 v[204:207], v109 offset:0
    ds_read_b128 v[208:211], v113 offset:0
    v_mfma_f32_16x16x32_bf16 v[228:231], v[212:215], v[232:235], v[228:231]
    buffer_load_dwordx4 v7, s[16:19], s42 offen offset:1024 lds
    s_waitcnt lgkmcnt(4)
    v_mfma_f32_32x32x16_bf16 v[164:179], v[196:199], v[216:219], v[164:179]
    ds_read_b64_tr_b16 v[224:225], v127 offset:36864
    ds_read_b64_tr_b16 v[226:227], v127 offset:37888
    v_mfma_f32_32x32x16_bf16 v[180:195], v[200:203], v[216:219], v[180:195]
    s_waitcnt lgkmcnt(3)
    v_mfma_f32_32x32x16_bf16 v[132:147], v[204:207], v[220:223], v[132:147]
    ds_read_b64_tr_b16 v[212:213], v126 offset:40960
    ds_read_b64_tr_b16 v[214:215], v126 offset:41984
    buffer_load_dwordx4 v8, s[16:19], s42 offen offset:2048 lds
    s_waitcnt lgkmcnt(4)
    v_mfma_f32_32x32x16_bf16 v[148:163], v[208:211], v[220:223], v[148:163]
    ds_read_b128 v[196:199], v110 offset:0
    ds_read_b128 v[200:203], v114 offset:0
    v_mfma_f32_16x16x32_bf16 v[228:231], v[220:223], v[232:235], v[228:231]
    buffer_load_dwordx4 v9, s[16:19], s42 offen offset:3072 lds
    s_waitcnt lgkmcnt(4)
    v_mfma_f32_32x32x16_bf16 v[164:179], v[204:207], v[224:227], v[164:179]
    ds_read_b64_tr_b16 v[216:217], v127 offset:40960
    ds_read_b64_tr_b16 v[218:219], v127 offset:41984
    v_mfma_f32_32x32x16_bf16 v[180:195], v[208:211], v[224:227], v[180:195]
    s_waitcnt lgkmcnt(3)
    v_mfma_f32_32x32x16_bf16 v[132:147], v[196:199], v[212:215], v[132:147]
    ds_read_b64_tr_b16 v[220:221], v126 offset:45056
    ds_read_b64_tr_b16 v[222:223], v126 offset:46080
    s_add_u32 m0, s51, 0
    s_mul_i32 s43, s52, 9
    buffer_load_dwordx4 v10, s[20:23], s43 offen offset:0 lds
    s_waitcnt lgkmcnt(4)
    v_mfma_f32_32x32x16_bf16 v[148:163], v[200:203], v[212:215], v[148:163]
    ds_read_b128 v[204:207], v111 offset:0
    ds_read_b128 v[208:211], v115 offset:0
    v_mfma_f32_16x16x32_bf16 v[228:231], v[212:215], v[232:235], v[228:231]
    buffer_load_dwordx4 v11, s[20:23], s43 offen offset:1024 lds
    s_waitcnt lgkmcnt(4)
    v_mfma_f32_32x32x16_bf16 v[164:179], v[196:199], v[216:219], v[164:179]
    ds_read_b64_tr_b16 v[224:225], v127 offset:45056
    ds_read_b64_tr_b16 v[226:227], v127 offset:46080
    v_mfma_f32_32x32x16_bf16 v[180:195], v[200:203], v[216:219], v[180:195]
    s_waitcnt vmcnt(6)
    s_barrier
    s_waitcnt lgkmcnt(3)
    v_mfma_f32_32x32x16_bf16 v[132:147], v[204:207], v[220:223], v[132:147]
    ds_read_b64_tr_b16 v[212:213], v128 offset:32768
    ds_read_b64_tr_b16 v[214:215], v128 offset:33792
    s_waitcnt lgkmcnt(4)
    v_mfma_f32_32x32x16_bf16 v[148:163], v[208:211], v[220:223], v[148:163]
    ds_read_b128 v[196:199], v116 offset:0
    ds_read_b128 v[200:203], v120 offset:0
    v_mfma_f32_16x16x32_bf16 v[228:231], v[220:223], v[232:235], v[228:231]
    s_waitcnt lgkmcnt(4)
    v_mfma_f32_32x32x16_bf16 v[164:179], v[204:207], v[224:227], v[164:179]
    ds_read_b64_tr_b16 v[216:217], v129 offset:32768
    ds_read_b64_tr_b16 v[218:219], v129 offset:33792
    v_mfma_f32_32x32x16_bf16 v[180:195], v[208:211], v[224:227], v[180:195]
    s_waitcnt vmcnt(18)
.fsp_21:
    v_readfirstlane_b32 s39, v85
    s_nop 3
    s_cmp_ge_u32 s39, 2
    s_cbranch_scc1 .fok_20
    s_sleep 2
    buffer_load_dword v85, v84, s[64:67], 0 offen sc1
    s_waitcnt vmcnt(0)
    s_branch .fsp_21
.fok_20:
    s_lshl_b32 s40, s53, 7
    s_add_u32 s41, s40, 8192
    buffer_load_dwordx4 v[16:19], v87, s[60:63], s40 offen offset:0 sc1
    buffer_load_dwordx4 v[48:51], v87, s[60:63], s41 offen offset:0 sc1
    buffer_load_dwordx4 v[20:23], v87, s[60:63], s40 offen offset:32 sc1
    buffer_load_dwordx4 v[52:55], v87, s[60:63], s41 offen offset:32 sc1
    buffer_load_dwordx4 v[24:27], v87, s[60:63], s40 offen offset:64 sc1
    buffer_load_dwordx4 v[56:59], v87, s[60:63], s41 offen offset:64 sc1
    buffer_load_dwordx4 v[28:31], v87, s[60:63], s40 offen offset:96 sc1
    buffer_load_dwordx4 v[60:63], v87, s[60:63], s41 offen offset:96 sc1
    s_lshl_b32 s40, s54, 7
    s_add_u32 s41, s40, 8192
    buffer_load_dwordx4 v[32:35], v87, s[60:63], s40 offen offset:0 sc1
    buffer_load_dwordx4 v[64:67], v87, s[60:63], s41 offen offset:0 sc1
    buffer_load_dwordx4 v[36:39], v87, s[60:63], s40 offen offset:32 sc1
    buffer_load_dwordx4 v[68:71], v87, s[60:63], s41 offen offset:32 sc1
    buffer_load_dwordx4 v[40:43], v87, s[60:63], s40 offen offset:64 sc1
    buffer_load_dwordx4 v[72:75], v87, s[60:63], s41 offen offset:64 sc1
    buffer_load_dwordx4 v[44:47], v87, s[60:63], s40 offen offset:96 sc1
    buffer_load_dwordx4 v[76:79], v87, s[60:63], s41 offen offset:96 sc1
    s_barrier
    s_waitcnt lgkmcnt(3)
    v_mfma_f32_32x32x16_bf16 v[132:147], v[196:199], v[212:215], v[132:147]
    ds_read_b64_tr_b16 v[220:221], v128 offset:36864
    ds_read_b64_tr_b16 v[222:223], v128 offset:37888
    s_waitcnt lgkmcnt(4)
    v_mfma_f32_32x32x16_bf16 v[148:163], v[200:203], v[212:215], v[148:163]
    ds_read_b128 v[204:207], v117 offset:0
    ds_read_b128 v[208:211], v121 offset:0
    v_mfma_f32_16x16x32_bf16 v[228:231], v[212:215], v[232:235], v[228:231]
    s_waitcnt lgkmcnt(4)
    v_mfma_f32_32x32x16_bf16 v[164:179], v[196:199], v[216:219], v[164:179]
    ds_read_b64_tr_b16 v[224:225], v129 offset:36864
    ds_read_b64_tr_b16 v[226:227], v129 offset:37888
    v_mfma_f32_32x32x16_bf16 v[180:195], v[200:203], v[216:219], v[180:195]
    s_waitcnt lgkmcnt(3)
    v_mfma_f32_32x32x16_bf16 v[132:147], v[204:207], v[220:223], v[132:147]
    ds_read_b64_tr_b16 v[212:213], v128 offset:40960
    ds_read_b64_tr_b16 v[214:215], v128 offset:41984
    s_waitcnt lgkmcnt(4)
    v_mfma_f32_32x32x16_bf16 v[148:163], v[208:211], v[220:223], v[148:163]
    ds_read_b128 v[196:199], v118 offset:0
    ds_read_b128 v[200:203], v122 offset:0
    v_mfma_f32_16x16x32_bf16 v[228:231], v[220:223], v[232:235], v[228:231]
    s_waitcnt lgkmcnt(4)
    v_mfma_f32_32x32x16_bf16 v[164:179], v[204:207], v[224:227], v[164:179]
    ds_read_b64_tr_b16 v[216:217], v129 offset:40960
    ds_read_b64_tr_b16 v[218:219], v129 offset:41984
    v_mfma_f32_32x32x16_bf16 v[180:195], v[208:211], v[224:227], v[180:195]
    s_waitcnt lgkmcnt(3)
    v_mfma_f32_32x32x16_bf16 v[132:147], v[196:199], v[212:215], v[132:147]
    ds_read_b64_tr_b16 v[220:221], v128 offset:45056
    ds_read_b64_tr_b16 v[222:223], v128 offset:46080
    s_waitcnt lgkmcnt(4)
    v_mfma_f32_32x32x16_bf16 v[148:163], v[200:203], v[212:215], v[148:163]
    ds_read_b128 v[204:207], v119 offset:0
    ds_read_b128 v[208:211], v123 offset:0
    v_mfma_f32_16x16x32_bf16 v[228:231], v[212:215], v[232:235], v[228:231]
    s_waitcnt lgkmcnt(4)
    v_mfma_f32_32x32x16_bf16 v[164:179], v[196:199], v[216:219], v[164:179]
    ds_read_b64_tr_b16 v[224:225], v129 offset:45056
    ds_read_b64_tr_b16 v[226:227], v129 offset:46080
    v_mfma_f32_32x32x16_bf16 v[180:195], v[200:203], v[216:219], v[180:195]
    s_waitcnt vmcnt(16)
    s_barrier
    s_waitcnt lgkmcnt(3)
    v_mfma_f32_32x32x16_bf16 v[132:147], v[204:207], v[220:223], v[132:147]
    ds_read_b64_tr_b16 v[212:213], v124 offset:32768
    ds_read_b64_tr_b16 v[214:215], v124 offset:33792
    s_waitcnt lgkmcnt(4)
    v_mfma_f32_32x32x16_bf16 v[148:163], v[208:211], v[220:223], v[148:163]
    ds_read_b128 v[196:199], v100 offset:0
    ds_read_b128 v[200:203], v104 offset:0
    v_mfma_f32_16x16x32_bf16 v[228:231], v[220:223], v[232:235], v[228:231]
    s_waitcnt lgkmcnt(4)
    v_mfma_f32_32x32x16_bf16 v[164:179], v[204:207], v[224:227], v[164:179]
    ds_read_b64_tr_b16 v[216:217], v125 offset:32768
    ds_read_b64_tr_b16 v[218:219], v125 offset:33792
    v_mfma_f32_32x32x16_bf16 v[180:195], v[208:211], v[224:227], v[180:195]
    s_barrier
    s_waitcnt lgkmcnt(3)
    v_mfma_f32_32x32x16_bf16 v[132:147], v[196:199], v[212:215], v[132:147]
    ds_read_b64_tr_b16 v[220:221], v124 offset:36864
    ds_read_b64_tr_b16 v[222:223], v124 offset:37888
    s_waitcnt lgkmcnt(4)
    v_mfma_f32_32x32x16_bf16 v[148:163], v[200:203], v[212:215], v[148:163]
    ds_read_b128 v[204:207], v101 offset:0
    ds_read_b128 v[208:211], v105 offset:0
    v_mfma_f32_16x16x32_bf16 v[228:231], v[212:215], v[232:235], v[228:231]
    s_waitcnt lgkmcnt(4)
    v_mfma_f32_32x32x16_bf16 v[164:179], v[196:199], v[216:219], v[164:179]
    ds_read_b64_tr_b16 v[224:225], v125 offset:36864
    ds_read_b64_tr_b16 v[226:227], v125 offset:37888
    v_mfma_f32_32x32x16_bf16 v[180:195], v[200:203], v[216:219], v[180:195]
    s_waitcnt lgkmcnt(3)
    v_mfma_f32_32x32x16_bf16 v[132:147], v[204:207], v[220:223], v[132:147]
    ds_read_b64_tr_b16 v[212:213], v124 offset:40960
    ds_read_b64_tr_b16 v[214:215], v124 offset:41984
    s_waitcnt lgkmcnt(4)
    v_mfma_f32_32x32x16_bf16 v[148:163], v[208:211], v[220:223], v[148:163]
    ds_read_b128 v[196:199], v102 offset:0
    ds_read_b128 v[200:203], v106 offset:0
    v_mfma_f32_16x16x32_bf16 v[228:231], v[220:223], v[232:235], v[228:231]
    s_waitcnt lgkmcnt(4)
    v_mfma_f32_32x32x16_bf16 v[164:179], v[204:207], v[224:227], v[164:179]
    ds_read_b64_tr_b16 v[216:217], v125 offset:40960
    ds_read_b64_tr_b16 v[218:219], v125 offset:41984
    v_mfma_f32_32x32x16_bf16 v[180:195], v[208:211], v[224:227], v[180:195]
    s_waitcnt lgkmcnt(3)
    v_mfma_f32_32x32x16_bf16 v[132:147], v[196:199], v[212:215], v[132:147]
    ds_read_b64_tr_b16 v[220:221], v124 offset:45056
    ds_read_b64_tr_b16 v[222:223], v124 offset:46080
    s_waitcnt lgkmcnt(4)
    v_mfma_f32_32x32x16_bf16 v[148:163], v[200:203], v[212:215], v[148:163]
    ds_read_b128 v[204:207], v103 offset:0
    ds_read_b128 v[208:211], v107 offset:0
    v_mfma_f32_16x16x32_bf16 v[228:231], v[212:215], v[232:235], v[228:231]
    s_waitcnt lgkmcnt(4)
    v_mfma_f32_32x32x16_bf16 v[164:179], v[196:199], v[216:219], v[164:179]
    ds_read_b64_tr_b16 v[224:225], v125 offset:45056
    ds_read_b64_tr_b16 v[226:227], v125 offset:46080
    v_mfma_f32_32x32x16_bf16 v[180:195], v[200:203], v[216:219], v[180:195]
    s_waitcnt lgkmcnt(3)
    v_mfma_f32_32x32x16_bf16 v[132:147], v[204:207], v[220:223], v[132:147]
    s_waitcnt lgkmcnt(2)
    v_mfma_f32_32x32x16_bf16 v[148:163], v[208:211], v[220:223], v[148:163]
    v_mfma_f32_16x16x32_bf16 v[228:231], v[220:223], v[232:235], v[228:231]
    s_waitcnt lgkmcnt(0)
    v_mfma_f32_32x32x16_bf16 v[164:179], v[204:207], v[224:227], v[164:179]
    v_mfma_f32_32x32x16_bf16 v[180:195], v[208:211], v[224:227], v[180:195]
    s_branch .e1epi_12
.nocs_19:
    s_waitcnt vmcnt(14)
    s_waitcnt lgkmcnt(0)
    s_barrier
    ds_read_b64_tr_b16 v[212:213], v124 offset:32768
    ds_read_b64_tr_b16 v[214:215], v124 offset:33792
    ds_read_b128 v[196:199], v100 offset:0
    ds_read_b128 v[200:203], v104 offset:0
    ds_read_b64_tr_b16 v[216:217], v125 offset:32768
    ds_read_b64_tr_b16 v[218:219], v125 offset:33792
    s_waitcnt lgkmcnt(3)
    v_mfma_f32_32x32x16_bf16 v[132:147], v[196:199], v[212:215], 0
    ds_read_b64_tr_b16 v[220:221], v124 offset:36864
    ds_read_b64_tr_b16 v[222:223], v124 offset:37888
    s_add_u32 m0, s50, 98304
    s_mov_b32 s42, 256
    buffer_load_dwordx4 v6, s[16:19], s42 offen offset:0 lds
    s_waitcnt lgkmcnt(4)
    v_mfma_f32_32x32x16_bf16 v[148:163], v[200:203], v[212:215], 0
    ds_read_b128 v[204:207], v101 offset:0
    ds_read_b128 v[208:211], v105 offset:0
    buffer_load_dwordx4 v7, s[16:19], s42 offen offset:1024 lds
    s_waitcnt lgkmcnt(4)
    v_mfma_f32_32x32x16_bf16 v[164:179], v[196:199], v[216:219], 0
    ds_read_b64_tr_b16 v[224:225], v125 offset:36864
    ds_read_b64_tr_b16 v[226:227], v125 offset:37888
    v_mfma_f32_32x32x16_bf16 v[180:195], v[200:203], v[216:219], 0
    s_waitcnt lgkmcnt(3)
    v_mfma_f32_32x32x16_bf16 v[132:147], v[204:207], v[220:223], v[132:147]
    ds_read_b64_tr_b16 v[212:213], v124 offset:40960
    ds_read_b64_tr_b16 v[214:215], v124 offset:41984
    buffer_load_dwordx4 v8, s[16:19], s42 offen offset:2048 lds
    s_waitcnt lgkmcnt(4)
    v_mfma_f32_32x32x16_bf16 v[148:163], v[208:211], v[220:223], v[148:163]
    ds_read_b128 v[196:199], v102 offset:0
    ds_read_b128 v[200:203], v106 offset:0
    buffer_load_dwordx4 v9, s[16:19], s42 offen offset:3072 lds
    s_waitcnt lgkmcnt(4)
    v_mfma_f32_32x32x16_bf16 v[164:179], v[204:207], v[224:227], v[164:179]
    ds_read_b64_tr_b16 v[216:217], v125 offset:40960
    ds_read_b64_tr_b16 v[218:219], v125 offset:41984
    v_mfma_f32_32x32x16_bf16 v[180:195], v[208:211], v[224:227], v[180:195]
    s_waitcnt lgkmcnt(3)
    v_mfma_f32_32x32x16_bf16 v[132:147], v[196:199], v[212:215], v[132:147]
    ds_read_b64_tr_b16 v[220:221], v124 offset:45056
    ds_read_b64_tr_b16 v[222:223], v124 offset:46080
    s_add_u32 m0, s51, 98304
    s_mul_i32 s43, s52, 2
    buffer_load_dwordx4 v10, s[20:23], s43 offen offset:0 lds
    s_waitcnt lgkmcnt(4)
    v_mfma_f32_32x32x16_bf16 v[148:163], v[200:203], v[212:215], v[148:163]
    ds_read_b128 v[204:207], v103 offset:0
    ds_read_b128 v[208:211], v107 offset:0
    buffer_load_dwordx4 v11, s[20:23], s43 offen offset:1024 lds
    s_waitcnt lgkmcnt(4)
    v_mfma_f32_32x32x16_bf16 v[164:179], v[196:199], v[216:219], v[164:179]
    ds_read_b64_tr_b16 v[224:225], v125 offset:45056
    ds_read_b64_tr_b16 v[226:227], v125 offset:46080
    v_mfma_f32_32x32x16_bf16 v[180:195], v[200:203], v[216:219], v[180:195]
    s_waitcnt vmcnt(14)
    s_barrier
    s_waitcnt lgkmcnt(3)
    v_mfma_f32_32x32x16_bf16 v[132:147], v[204:207], v[220:223], v[132:147]
    ds_read_b64_tr_b16 v[212:213], v126 offset:32768
    ds_read_b64_tr_b16 v[214:215], v126 offset:33792
    s_waitcnt lgkmcnt(4)
    v_mfma_f32_32x32x16_bf16 v[148:163], v[208:211], v[220:223], v[148:163]
    ds_read_b128 v[196:199], v108 offset:0
    ds_read_b128 v[200:203], v112 offset:0
    s_waitcnt lgkmcnt(4)
    v_mfma_f32_32x32x16_bf16 v[164:179], v[204:207], v[224:227], v[164:179]
    ds_read_b64_tr_b16 v[216:217], v127 offset:32768
    ds_read_b64_tr_b16 v[218:219], v127 offset:33792
    v_mfma_f32_32x32x16_bf16 v[180:195], v[208:211], v[224:227], v[180:195]
    s_barrier
    s_waitcnt lgkmcnt(3)
    v_mfma_f32_32x32x16_bf16 v[132:147], v[196:199], v[212:215], v[132:147]
    ds_read_b64_tr_b16 v[220:221], v126 offset:36864
    ds_read_b64_tr_b16 v[222:223], v126 offset:37888
    s_add_u32 m0, s50, 0
    s_mov_b32 s42, 384
    buffer_load_dwordx4 v6, s[16:19], s42 offen offset:0 lds
    s_waitcnt lgkmcnt(4)
    v_mfma_f32_32x32x16_bf16 v[148:163], v[200:203], v[212:215], v[148:163]
    ds_read_b128 v[204:207], v109 offset:0
    ds_read_b128 v[208:211], v113 offset:0
    buffer_load_dwordx4 v7, s[16:19], s42 offen offset:1024 lds
    s_waitcnt lgkmcnt(4)
    v_mfma_f32_32x32x16_bf16 v[164:179], v[196:199], v[216:219], v[164:179]
    ds_read_b64_tr_b16 v[224:225], v127 offset:36864
    ds_read_b64_tr_b16 v[226:227], v127 offset:37888
    v_mfma_f32_32x32x16_bf16 v[180:195], v[200:203], v[216:219], v[180:195]
    s_waitcnt lgkmcnt(3)
    v_mfma_f32_32x32x16_bf16 v[132:147], v[204:207], v[220:223], v[132:147]
    ds_read_b64_tr_b16 v[212:213], v126 offset:40960
    ds_read_b64_tr_b16 v[214:215], v126 offset:41984
    buffer_load_dwordx4 v8, s[16:19], s42 offen offset:2048 lds
    s_waitcnt lgkmcnt(4)
    v_mfma_f32_32x32x16_bf16 v[148:163], v[208:211], v[220:223], v[148:163]
    ds_read_b128 v[196:199], v110 offset:0
    ds_read_b128 v[200:203], v114 offset:0
    buffer_load_dwordx4 v9, s[16:19], s42 offen offset:3072 lds
    s_waitcnt lgkmcnt(4)
    v_mfma_f32_32x32x16_bf16 v[164:179], v[204:207], v[224:227], v[164:179]
    ds_read_b64_tr_b16 v[216:217], v127 offset:40960
    ds_read_b64_tr_b16 v[218:219], v127 offset:41984
    v_mfma_f32_32x32x16_bf16 v[180:195], v[208:211], v[224:227], v[180:195]
    s_waitcnt lgkmcnt(3)
    v_mfma_f32_32x32x16_bf16 v[132:147], v[196:199], v[212:215], v[132:147]
    ds_read_b64_tr_b16 v[220:221], v126 offset:45056
    ds_read_b64_tr_b16 v[222:223], v126 offset:46080
    s_add_u32 m0, s51, 0
    s_mul_i32 s43, s52, 3
    buffer_load_dwordx4 v10, s[20:23], s43 offen offset:0 lds
    s_waitcnt lgkmcnt(4)
    v_mfma_f32_32x32x16_bf16 v[148:163], v[200:203], v[212:215], v[148:163]
    ds_read_b128 v[204:207], v111 offset:0
    ds_read_b128 v[208:211], v115 offset:0
    buffer_load_dwordx4 v11, s[20:23], s43 offen offset:1024 lds
    s_waitcnt lgkmcnt(4)
    v_mfma_f32_32x32x16_bf16 v[164:179], v[196:199], v[216:219], v[164:179]
    ds_read_b64_tr_b16 v[224:225], v127 offset:45056
    ds_read_b64_tr_b16 v[226:227], v127 offset:46080
    v_mfma_f32_32x32x16_bf16 v[180:195], v[200:203], v[216:219], v[180:195]
    s_waitcnt vmcnt(6)
    s_barrier
    s_waitcnt lgkmcnt(3)
    v_mfma_f32_32x32x16_bf16 v[132:147], v[204:207], v[220:223], v[132:147]
    ds_read_b64_tr_b16 v[212:213], v128 offset:32768
    ds_read_b64_tr_b16 v[214:215], v128 offset:33792
    s_waitcnt lgkmcnt(4)
    v_mfma_f32_32x32x16_bf16 v[148:163], v[208:211], v[220:223], v[148:163]
    ds_read_b128 v[196:199], v116 offset:0
    ds_read_b128 v[200:203], v120 offset:0
    s_waitcnt lgkmcnt(4)
    v_mfma_f32_32x32x16_bf16 v[164:179], v[204:207], v[224:227], v[164:179]
    ds_read_b64_tr_b16 v[216:217], v129 offset:32768
    ds_read_b64_tr_b16 v[218:219], v129 offset:33792
    v_mfma_f32_32x32x16_bf16 v[180:195], v[208:211], v[224:227], v[180:195]
    s_barrier
    s_waitcnt lgkmcnt(3)
    v_mfma_f32_32x32x16_bf16 v[132:147], v[196:199], v[212:215], v[132:147]
    ds_read_b64_tr_b16 v[220:221], v128 offset:36864
    ds_read_b64_tr_b16 v[222:223], v128 offset:37888
    s_add_u32 m0, s50, 49152
    s_mov_b32 s42, 512
    buffer_load_dwordx4 v6, s[16:19], s42 offen offset:0 lds
    s_waitcnt lgkmcnt(4)
    v_mfma_f32_32x32x16_bf16 v[148:163], v[200:203], v[212:215], v[148:163]
    ds_read_b128 v[204:207], v117 offset:0
    ds_read_b128 v[208:211], v121 offset:0
    buffer_load_dwordx4 v7, s[16:19], s42 offen offset:1024 lds
    s_waitcnt lgkmcnt(4)
    v_mfma_f32_32x32x16_bf16 v[164:179], v[196:199], v[216:219], v[164:179]
    ds_read_b64_tr_b16 v[224:225], v129 offset:36864
    ds_read_b64_tr_b16 v[226:227], v129 offset:37888
    v_mfma_f32_32x32x16_bf16 v[180:195], v[200:203], v[216:219], v[180:195]
    s_waitcnt lgkmcnt(3)
    v_mfma_f32_32x32x16_bf16 v[132:147], v[204:207], v[220:223], v[132:147]
    ds_read_b64_tr_b16 v[212:213], v128 offset:40960
    ds_read_b64_tr_b16 v[214:215], v128 offset:41984
    buffer_load_dwordx4 v8, s[16:19], s42 offen offset:2048 lds
    s_waitcnt lgkmcnt(4)
    v_mfma_f32_32x32x16_bf16 v[148:163], v[208:211], v[220:223], v[148:163]
    ds_read_b128 v[196:199], v118 offset:0
    ds_read_b128 v[200:203], v122 offset:0
    buffer_load_dwordx4 v9, s[16:19], s42 offen offset:3072 lds
    s_waitcnt lgkmcnt(4)
    v_mfma_f32_32x32x16_bf16 v[164:179], v[204:207], v[224:227], v[164:179]
    ds_read_b64_tr_b16 v[216:217], v129 offset:40960
    ds_read_b64_tr_b16 v[218:219], v129 offset:41984
    v_mfma_f32_32x32x16_bf16 v[180:195], v[208:211], v[224:227], v[180:195]
    s_waitcnt lgkmcnt(3)
    v_mfma_f32_32x32x16_bf16 v[132:147], v[196:199], v[212:215], v[132:147]
    ds_read_b64_tr_b16 v[220:221], v128 offset:45056
    ds_read_b64_tr_b16 v[222:223], v128 offset:46080
    s_add_u32 m0, s51, 49152
    s_mul_i32 s43, s52, 4
    buffer_load_dwordx4 v10, s[20:23], s43 offen offset:0 lds
    s_waitcnt lgkmcnt(4)
    v_mfma_f32_32x32x16_bf16 v[148:163], v[200:203], v[212:215], v[148:163]
    ds_read_b128 v[204:207], v119 offset:0
    ds_read_b128 v[208:211], v123 offset:0
    buffer_load_dwordx4 v11, s[20:23], s43 offen offset:1024 lds
    s_waitcnt lgkmcnt(4)
    v_mfma_f32_32x32x16_bf16 v[164:179], v[196:199], v[216:219], v[164:179]
    ds_read_b64_tr_b16 v[224:225], v129 offset:45056
    ds_read_b64_tr_b16 v[226:227], v129 offset:46080
    v_mfma_f32_32x32x16_bf16 v[180:195], v[200:203], v[216:219], v[180:195]
    s_waitcnt vmcnt(6)
    s_barrier
    s_waitcnt lgkmcnt(3)
    v_mfma_f32_32x32x16_bf16 v[132:147], v[204:207], v[220:223], v[132:147]
    ds_read_b64_tr_b16 v[212:213], v124 offset:32768
    ds_read_b64_tr_b16 v[214:215], v124 offset:33792
    s_waitcnt lgkmcnt(4)
    v_mfma_f32_32x32x16_bf16 v[148:163], v[208:211], v[220:223], v[148:163]
    ds_read_b128 v[196:199], v100 offset:0
    ds_read_b128 v[200:203], v104 offset:0
    s_waitcnt lgkmcnt(4)
    v_mfma_f32_32x32x16_bf16 v[164:179], v[204:207], v[224:227], v[164:179]
    ds_read_b64_tr_b16 v[216:217], v125 offset:32768
    ds_read_b64_tr_b16 v[218:219], v125 offset:33792
    v_mfma_f32_32x32x16_bf16 v[180:195], v[208:211], v[224:227], v[180:195]
    s_barrier
    s_waitcnt lgkmcnt(3)
    v_mfma_f32_32x32x16_bf16 v[132:147], v[196:199], v[212:215], v[132:147]
    ds_read_b64_tr_b16 v[220:221], v124 offset:36864
    ds_read_b64_tr_b16 v[222:223], v124 offset:37888
    s_add_u32 m0, s50, 98304
    s_mov_b32 s42, 640
    buffer_load_dwordx4 v6, s[16:19], s42 offen offset:0 lds
    s_waitcnt lgkmcnt(4)
    v_mfma_f32_32x32x16_bf16 v[148:163], v[200:203], v[212:215], v[148:163]
    ds_read_b128 v[204:207], v101 offset:0
    ds_read_b128 v[208:211], v105 offset:0
    buffer_load_dwordx4 v7, s[16:19], s42 offen offset:1024 lds
    s_waitcnt lgkmcnt(4)
    v_mfma_f32_32x32x16_bf16 v[164:179], v[196:199], v[216:219], v[164:179]
    ds_read_b64_tr_b16 v[224:225], v125 offset:36864
    ds_read_b64_tr_b16 v[226:227], v125 offset:37888
    v_mfma_f32_32x32x16_bf16 v[180:195], v[200:203], v[216:219], v[180:195]
    s_waitcnt lgkmcnt(3)
    v_mfma_f32_32x32x16_bf16 v[132:147], v[204:207], v[220:223], v[132:147]
    ds_read_b64_tr_b16 v[212:213], v124 offset:40960
    ds_read_b64_tr_b16 v[214:215], v124 offset:41984
    buffer_load_dwordx4 v8, s[16:19], s42 offen offset:2048 lds
    s_waitcnt lgkmcnt(4)
    v_mfma_f32_32x32x16_bf16 v[148:163], v[208:211], v[220:223], v[148:163]
    ds_read_b128 v[196:199], v102 offset:0
    ds_read_b128 v[200:203], v106 offset:0
    buffer_load_dwordx4 v9, s[16:19], s42 offen offset:3072 lds
    s_waitcnt lgkmcnt(4)
    v_mfma_f32_32x32x16_bf16 v[164:179], v[204:207], v[224:227], v[164:179]
    ds_read_b64_tr_b16 v[216:217], v125 offset:40960
    ds_read_b64_tr_b16 v[218:219], v125 offset:41984
    v_mfma_f32_32x32x16_bf16 v[180:195], v[208:211], v[224:227], v[180:195]
    s_waitcnt lgkmcnt(3)
    v_mfma_f32_32x32x16_bf16 v[132:147], v[196:199], v[212:215], v[132:147]
    ds_read_b64_tr_b16 v[220:221], v124 offset:45056
    ds_read_b64_tr_b16 v[222:223], v124 offset:46080
    s_add_u32 m0, s51, 98304
    s_mul_i32 s43, s52, 5
    buffer_load_dwordx4 v10, s[20:23], s43 offen offset:0 lds
    s_waitcnt lgkmcnt(4)
    v_mfma_f32_32x32x16_bf16 v[148:163], v[200:203], v[212:215], v[148:163]
    ds_read_b128 v[204:207], v103 offset:0
    ds_read_b128 v[208:211], v107 offset:0
    buffer_load_dwordx4 v11, s[20:23], s43 offen offset:1024 lds
    s_waitcnt lgkmcnt(4)
    v_mfma_f32_32x32x16_bf16 v[164:179], v[196:199], v[216:219], v[164:179]
    ds_read_b64_tr_b16 v[224:225], v125 offset:45056
    ds_read_b64_tr_b16 v[226:227], v125 offset:46080
    v_mfma_f32_32x32x16_bf16 v[180:195], v[200:203], v[216:219], v[180:195]
    s_waitcnt vmcnt(6)
    s_barrier
    s_waitcnt lgkmcnt(3)
    v_mfma_f32_32x32x16_bf16 v[132:147], v[204:207], v[220:223], v[132:147]
    ds_read_b64_tr_b16 v[212:213], v126 offset:32768
    ds_read_b64_tr_b16 v[214:215], v126 offset:33792
    s_waitcnt lgkmcnt(4)
    v_mfma_f32_32x32x16_bf16 v[148:163], v[208:211], v[220:223], v[148:163]
    ds_read_b128 v[196:199], v108 offset:0
    ds_read_b128 v[200:203], v112 offset:0
    s_waitcnt lgkmcnt(4)
    v_mfma_f32_32x32x16_bf16 v[164:179], v[204:207], v[224:227], v[164:179]
    ds_read_b64_tr_b16 v[216:217], v127 offset:32768
    ds_read_b64_tr_b16 v[218:219], v127 offset:33792
    v_mfma_f32_32x32x16_bf16 v[180:195], v[208:211], v[224:227], v[180:195]
    s_barrier
    s_waitcnt lgkmcnt(3)
    v_mfma_f32_32x32x16_bf16 v[132:147], v[196:199], v[212:215], v[132:147]
    ds_read_b64_tr_b16 v[220:221], v126 offset:36864
    ds_read_b64_tr_b16 v[222:223], v126 offset:37888
    s_add_u32 m0, s50, 0
    s_mov_b32 s42, 768
    buffer_load_dwordx4 v6, s[16:19], s42 offen offset:0 lds
    s_waitcnt lgkmcnt(4)
    v_mfma_f32_32x32x16_bf16 v[148:163], v[200:203], v[212:215], v[148:163]
    ds_read_b128 v[204:207], v109 offset:0
    ds_read_b128 v[208:211], v113 offset:0
    buffer_load_dwordx4 v7, s[16:19], s42 offen offset:1024 lds
    s_waitcnt lgkmcnt(4)
    v_mfma_f32_32x32x16_bf16 v[164:179], v[196:199], v[216:219], v[164:179]
    ds_read_b64_tr_b16 v[224:225], v127 offset:36864
    ds_read_b64_tr_b16 v[226:227], v127 offset:37888
    v_mfma_f32_32x32x16_bf16 v[180:195], v[200:203], v[216:219], v[180:195]
    s_waitcnt lgkmcnt(3)
    v_mfma_f32_32x32x16_bf16 v[132:147], v[204:207], v[220:223], v[132:147]
    ds_read_b64_tr_b16 v[212:213], v126 offset:40960
    ds_read_b64_tr_b16 v[214:215], v126 offset:41984
    buffer_load_dwordx4 v8, s[16:19], s42 offen offset:2048 lds
    s_waitcnt lgkmcnt(4)
    v_mfma_f32_32x32x16_bf16 v[148:163], v[208:211], v[220:223], v[148:163]
    ds_read_b128 v[196:199], v110 offset:0
    ds_read_b128 v[200:203], v114 offset:0
    buffer_load_dwordx4 v9, s[16:19], s42 offen offset:3072 lds
    s_waitcnt lgkmcnt(4)
    v_mfma_f32_32x32x16_bf16 v[164:179], v[204:207], v[224:227], v[164:179]
    ds_read_b64_tr_b16 v[216:217], v127 offset:40960
    ds_read_b64_tr_b16 v[218:219], v127 offset:41984
    v_mfma_f32_32x32x16_bf16 v[180:195], v[208:211], v[224:227], v[180:195]
    s_waitcnt lgkmcnt(3)
    v_mfma_f32_32x32x16_bf16 v[132:147], v[196:199], v[212:215], v[132:147]
    ds_read_b64_tr_b16 v[220:221], v126 offset:45056
    ds_read_b64_tr_b16 v[222:223], v126 offset:46080
    s_add_u32 m0, s51, 0
    s_mul_i32 s43, s52, 6
    buffer_load_dwordx4 v10, s[20:23], s43 offen offset:0 lds
    s_waitcnt lgkmcnt(4)
    v_mfma_f32_32x32x16_bf16 v[148:163], v[200:203], v[212:215], v[148:163]
    ds_read_b128 v[204:207], v111 offset:0
    ds_read_b128 v[208:211], v115 offset:0
    buffer_load_dwordx4 v11, s[20:23], s43 offen offset:1024 lds
    s_waitcnt lgkmcnt(4)
    v_mfma_f32_32x32x16_bf16 v[164:179], v[196:199], v[216:219], v[164:179]
    ds_read_b64_tr_b16 v[224:225], v127 offset:45056
    ds_read_b64_tr_b16 v[226:227], v127 offset:46080
    v_mfma_f32_32x32x16_bf16 v[180:195], v[200:203], v[216:219], v[180:195]
    s_waitcnt vmcnt(6)
    s_barrier
    s_waitcnt lgkmcnt(3)
    v_mfma_f32_32x32x16_bf16 v[132:147], v[204:207], v[220:223], v[132:147]
    ds_read_b64_tr_b16 v[212:213], v128 offset:32768
    ds_read_b64_tr_b16 v[214:215], v128 offset:33792
    s_waitcnt lgkmcnt(4)
    v_mfma_f32_32x32x16_bf16 v[148:163], v[208:211], v[220:223], v[148:163]
    ds_read_b128 v[196:199], v116 offset:0
    ds_read_b128 v[200:203], v120 offset:0
    s_waitcnt lgkmcnt(4)
    v_mfma_f32_32x32x16_bf16 v[164:179], v[204:207], v[224:227], v[164:179]
    ds_read_b64_tr_b16 v[216:217], v129 offset:32768
    ds_read_b64_tr_b16 v[218:219], v129 offset:33792
    v_mfma_f32_32x32x16_bf16 v[180:195], v[208:211], v[224:227], v[180:195]
    buffer_load_dword v85, v84, s[64:67], 0 offen sc1
    s_barrier
    s_waitcnt lgkmcnt(3)
    v_mfma_f32_32x32x16_bf16 v[132:147], v[196:199], v[212:215], v[132:147]
    ds_read_b64_tr_b16 v[220:221], v128 offset:36864
    ds_read_b64_tr_b16 v[222:223], v128 offset:37888
    s_add_u32 m0, s50, 49152
    s_mov_b32 s42, 896
    buffer_load_dwordx4 v6, s[16:19], s42 offen offset:0 lds
    s_waitcnt lgkmcnt(4)
    v_mfma_f32_32x32x16_bf16 v[148:163], v[200:203], v[212:215], v[148:163]
    ds_read_b128 v[204:207], v117 offset:0
    ds_read_b128 v[208:211], v121 offset:0
    buffer_load_dwordx4 v7, s[16:19], s42 offen offset:1024 lds
    s_waitcnt lgkmcnt(4)
    v_mfma_f32_32x32x16_bf16 v[164:179], v[196:199], v[216:219], v[164:179]
    ds_read_b64_tr_b16 v[224:225], v129 offset:36864
    ds_read_b64_tr_b16 v[226:227], v129 offset:37888
    v_mfma_f32_32x32x16_bf16 v[180:195], v[200:203], v[216:219], v[180:195]
    s_waitcnt lgkmcnt(3)
    v_mfma_f32_32x32x16_bf16 v[132:147], v[204:207], v[220:223], v[132:147]
    ds_read_b64_tr_b16 v[212:213], v128 offset:40960
    ds_read_b64_tr_b16 v[214:215], v128 offset:41984
    buffer_load_dwordx4 v8, s[16:19], s42 offen offset:2048 lds
    s_waitcnt lgkmcnt(4)
    v_mfma_f32_32x32x16_bf16 v[148:163], v[208:211], v[220:223], v[148:163]
    ds_read_b128 v[196:199], v118 offset:0
    ds_read_b128 v[200:203], v122 offset:0
    buffer_load_dwordx4 v9, s[16:19], s42 offen offset:3072 lds
    s_waitcnt lgkmcnt(4)
    v_mfma_f32_32x32x16_bf16 v[164:179], v[204:207], v[224:227], v[164:179]
    ds_read_b64_tr_b16 v[216:217], v129 offset:40960
    ds_read_b64_tr_b16 v[218:219], v129 offset:41984
    v_mfma_f32_32x32x16_bf16 v[180:195], v[208:211], v[224:227], v[180:195]
    s_waitcnt lgkmcnt(3)
    v_mfma_f32_32x32x16_bf16 v[132:147], v[196:199], v[212:215], v[132:147]
    ds_read_b64_tr_b16 v[220:221], v128 offset:45056
    ds_read_b64_tr_b16 v[222:223], v128 offset:46080
    s_add_u32 m0, s51, 49152
    s_mul_i32 s43, s52, 7
    buffer_load_dwordx4 v10, s[20:23], s43 offen offset:0 lds
    s_waitcnt lgkmcnt(4)
    v_mfma_f32_32x32x16_bf16 v[148:163], v[200:203], v[212:215], v[148:163]
    ds_read_b128 v[204:207], v119 offset:0
    ds_read_b128 v[208:211], v123 offset:0
    buffer_load_dwordx4 v11, s[20:23], s43 offen offset:1024 lds
    s_waitcnt lgkmcnt(4)
    v_mfma_f32_32x32x16_bf16 v[164:179], v[196:199], v[216:219], v[164:179]
    ds_read_b64_tr_b16 v[224:225], v129 offset:45056
    ds_read_b64_tr_b16 v[226:227], v129 offset:46080
    v_mfma_f32_32x32x16_bf16 v[180:195], v[200:203], v[216:219], v[180:195]
    s_waitcnt vmcnt(7)
    s_barrier
    s_waitcnt lgkmcnt(3)
    v_mfma_f32_32x32x16_bf16 v[132:147], v[204:207], v[220:223], v[132:147]
    ds_read_b64_tr_b16 v[212:213], v124 offset:32768
    ds_read_b64_tr_b16 v[214:215], v124 offset:33792
    s_waitcnt lgkmcnt(4)
    v_mfma_f32_32x32x16_bf16 v[148:163], v[208:211], v[220:223], v[148:163]
    ds_read_b128 v[196:199], v100 offset:0
    ds_read_b128 v[200:203], v104 offset:0
    s_waitcnt lgkmcnt(4)
    v_mfma_f32_32x32x16_bf16 v[164:179], v[204:207], v[224:227], v[164:179]
    ds_read_b64_tr_b16 v[216:217], v125 offset:32768
    ds_read_b64_tr_b16 v[218:219], v125 offset:33792
    v_mfma_f32_32x32x16_bf16 v[180:195], v[208:211], v[224:227], v[180:195]
    s_barrier
    s_waitcnt lgkmcnt(3)
    v_mfma_f32_32x32x16_bf16 v[132:147], v[196:199], v[212:215], v[132:147]
    ds_read_b64_tr_b16 v[220:221], v124 offset:36864
    ds_read_b64_tr_b16 v[222:223], v124 offset:37888
    s_add_u32 m0, s50, 98304
    s_mov_b32 s42, 1024
    buffer_load_dwordx4 v6, s[16:19], s42 offen offset:0 lds
    s_waitcnt lgkmcnt(4)
    v_mfma_f32_32x32x16_bf16 v[148:163], v[200:203], v[212:215], v[148:163]
    ds_read_b128 v[204:207], v101 offset:0
    ds_read_b128 v[208:211], v105 offset:0
    buffer_load_dwordx4 v7, s[16:19], s42 offen offset:1024 lds
    s_waitcnt lgkmcnt(4)
    v_mfma_f32_32x32x16_bf16 v[164:179], v[196:199], v[216:219], v[164:179]
    ds_read_b64_tr_b16 v[224:225], v125 offset:36864
    ds_read_b64_tr_b16 v[226:227], v125 offset:37888
    v_mfma_f32_32x32x16_bf16 v[180:195], v[200:203], v[216:219], v[180:195]
    s_waitcnt lgkmcnt(3)
    v_mfma_f32_32x32x16_bf16 v[132:147], v[204:207], v[220:223], v[132:147]
    ds_read_b64_tr_b16 v[212:213], v124 offset:40960
    ds_read_b64_tr_b16 v[214:215], v124 offset:41984
    buffer_load_dwordx4 v8, s[16:19], s42 offen offset:2048 lds
    s_waitcnt lgkmcnt(4)
    v_mfma_f32_32x32x16_bf16 v[148:163], v[208:211], v[220:223], v[148:163]
    ds_read_b128 v[196:199], v102 offset:0
    ds_read_b128 v[200:203], v106 offset:0
    buffer_load_dwordx4 v9, s[16:19], s42 offen offset:3072 lds
    s_waitcnt lgkmcnt(4)
    v_mfma_f32_32x32x16_bf16 v[164:179], v[204:207], v[224:227], v[164:179]
    ds_read_b64_tr_b16 v[216:217], v125 offset:40960
    ds_read_b64_tr_b16 v[218:219], v125 offset:41984
    v_mfma_f32_32x32x16_bf16 v[180:195], v[208:211], v[224:227], v[180:195]
    s_waitcnt lgkmcnt(3)
    v_mfma_f32_32x32x16_bf16 v[132:147], v[196:199], v[212:215], v[132:147]
    ds_read_b64_tr_b16 v[220:221], v124 offset:45056
    ds_read_b64_tr_b16 v[222:223], v124 offset:46080
    s_add_u32 m0, s51, 98304
    s_mul_i32 s43, s52, 8
    buffer_load_dwordx4 v10, s[20:23], s43 offen offset:0 lds
    s_waitcnt lgkmcnt(4)
    v_mfma_f32_32x32x16_bf16 v[148:163], v[200:203], v[212:215], v[148:163]
    ds_read_b128 v[204:207], v103 offset:0
    ds_read_b128 v[208:211], v107 offset:0
    buffer_load_dwordx4 v11, s[20:23], s43 offen offset:1024 lds
    s_waitcnt lgkmcnt(4)
    v_mfma_f32_32x32x16_bf16 v[164:179], v[196:199], v[216:219], v[164:179]
    ds_read_b64_tr_b16 v[224:225], v125 offset:45056
    ds_read_b64_tr_b16 v[226:227], v125 offset:46080
    v_mfma_f32_32x32x16_bf16 v[180:195], v[200:203], v[216:219], v[180:195]
    s_waitcnt vmcnt(6)
    s_barrier
    s_waitcnt lgkmcnt(3)
    v_mfma_f32_32x32x16_bf16 v[132:147], v[204:207], v[220:223], v[132:147]
    ds_read_b64_tr_b16 v[212:213], v126 offset:32768
    ds_read_b64_tr_b16 v[214:215], v126 offset:33792
    s_waitcnt lgkmcnt(4)
    v_mfma_f32_32x32x16_bf16 v[148:163], v[208:211], v[220:223], v[148:163]
    ds_read_b128 v[196:199], v108 offset:0
    ds_read_b128 v[200:203], v112 offset:0
    s_waitcnt lgkmcnt(4)
    v_mfma_f32_32x32x16_bf16 v[164:179], v[204:207], v[224:227], v[164:179]
    ds_read_b64_tr_b16 v[216:217], v127 offset:32768
    ds_read_b64_tr_b16 v[218:219], v127 offset:33792
    v_mfma_f32_32x32x16_bf16 v[180:195], v[208:211], v[224:227], v[180:195]
    s_barrier
    s_waitcnt lgkmcnt(3)
    v_mfma_f32_32x32x16_bf16 v[132:147], v[196:199], v[212:215], v[132:147]
    ds_read_b64_tr_b16 v[220:221], v126 offset:36864
    ds_read_b64_tr_b16 v[222:223], v126 offset:37888
    s_add_u32 m0, s50, 0
    s_mov_b32 s42, 1152
    buffer_load_dwordx4 v6, s[16:19], s42 offen offset:0 lds
    s_waitcnt lgkmcnt(4)
    v_mfma_f32_32x32x16_bf16 v[148:163], v[200:203], v[212:215], v[148:163]
    ds_read_b128 v[204:207], v109 offset:0
    ds_read_b128 v[208:211], v113 offset:0
    buffer_load_dwordx4 v7, s[16:19], s42 offen offset:1024 lds
    s_waitcnt lgkmcnt(4)
    v_mfma_f32_32x32x16_bf16 v[164:179], v[196:199], v[216:219], v[164:179]
    ds_read_b64_tr_b16 v[224:225], v127 offset:36864
    ds_read_b64_tr_b16 v[226:227], v127 offset:37888
    v_mfma_f32_32x32x16_bf16 v[180:195], v[200:203], v[216:219], v[180:195]
    s_waitcnt lgkmcnt(3)
    v_mfma_f32_32x32x16_bf16 v[132:147], v[204:207], v[220:223], v[132:147]
    ds_read_b64_tr_b16 v[212:213], v126 offset:40960
    ds_read_b64_tr_b16 v[214:215], v126 offset:41984
    buffer_load_dwordx4 v8, s[16:19], s42 offen offset:2048 lds
    s_waitcnt lgkmcnt(4)
    v_mfma_f32_32x32x16_bf16 v[148:163], v[208:211], v[220:223], v[148:163]
    ds_read_b128 v[196:199], v110 offset:0
    ds_read_b128 v[200:203], v114 offset:0
    buffer_load_dwordx4 v9, s[16:19], s42 offen offset:3072 lds
    s_waitcnt lgkmcnt(4)
    v_mfma_f32_32x32x16_bf16 v[164:179], v[204:207], v[224:227], v[164:179]
    ds_read_b64_tr_b16 v[216:217], v127 offset:40960
    ds_read_b64_tr_b16 v[218:219], v127 offset:41984
    v_mfma_f32_32x32x16_bf16 v[180:195], v[208:211], v[224:227], v[180:195]
    s_waitcnt lgkmcnt(3)
    v_mfma_f32_32x32x16_bf16 v[132:147], v[196:199], v[212:215], v[132:147]
    ds_read_b64_tr_b16 v[220:221], v126 offset:45056
    ds_read_b64_tr_b16 v[222:223], v126 offset:46080
    s_add_u32 m0, s51, 0
    s_mul_i32 s43, s52, 9
    buffer_load_dwordx4 v10, s[20:23], s43 offen offset:0 lds
    s_waitcnt lgkmcnt(4)
    v_mfma_f32_32x32x16_bf16 v[148:163], v[200:203], v[212:215], v[148:163]
    ds_read_b128 v[204:207], v111 offset:0
    ds_read_b128 v[208:211], v115 offset:0
    buffer_load_dwordx4 v11, s[20:23], s43 offen offset:1024 lds
    s_waitcnt lgkmcnt(4)
    v_mfma_f32_32x32x16_bf16 v[164:179], v[196:199], v[216:219], v[164:179]
    ds_read_b64_tr_b16 v[224:225], v127 offset:45056
    ds_read_b64_tr_b16 v[226:227], v127 offset:46080
    v_mfma_f32_32x32x16_bf16 v[180:195], v[200:203], v[216:219], v[180:195]
    s_waitcnt vmcnt(6)
    s_barrier
    s_waitcnt lgkmcnt(3)
    v_mfma_f32_32x32x16_bf16 v[132:147], v[204:207], v[220:223], v[132:147]
    ds_read_b64_tr_b16 v[212:213], v128 offset:32768
    ds_read_b64_tr_b16 v[214:215], v128 offset:33792
    s_waitcnt lgkmcnt(4)
    v_mfma_f32_32x32x16_bf16 v[148:163], v[208:211], v[220:223], v[148:163]
    ds_read_b128 v[196:199], v116 offset:0
    ds_read_b128 v[200:203], v120 offset:0
    s_waitcnt lgkmcnt(4)
    v_mfma_f32_32x32x16_bf16 v[164:179], v[204:207], v[224:227], v[164:179]
    ds_read_b64_tr_b16 v[216:217], v129 offset:32768
    ds_read_b64_tr_b16 v[218:219], v129 offset:33792
    v_mfma_f32_32x32x16_bf16 v[180:195], v[208:211], v[224:227], v[180:195]
    s_waitcnt vmcnt(18)
.fsp_23:
    v_readfirstlane_b32 s39, v85
    s_nop 3
    s_cmp_ge_u32 s39, 2
    s_cbranch_scc1 .fok_22
    s_sleep 2
    buffer_load_dword v85, v84, s[64:67], 0 offen sc1
    s_waitcnt vmcnt(0)
    s_branch .fsp_23
.fok_22:
    s_lshl_b32 s40, s53, 7
    s_add_u32 s41, s40, 8192
    buffer_load_dwordx4 v[16:19], v87, s[60:63], s40 offen offset:0 sc1
    buffer_load_dwordx4 v[48:51], v87, s[60:63], s41 offen offset:0 sc1
    buffer_load_dwordx4 v[20:23], v87, s[60:63], s40 offen offset:32 sc1
    buffer_load_dwordx4 v[52:55], v87, s[60:63], s41 offen offset:32 sc1
    buffer_load_dwordx4 v[24:27], v87, s[60:63], s40 offen offset:64 sc1
    buffer_load_dwordx4 v[56:59], v87, s[60:63], s41 offen offset:64 sc1
    buffer_load_dwordx4 v[28:31], v87, s[60:63], s40 offen offset:96 sc1
    buffer_load_dwordx4 v[60:63], v87, s[60:63], s41 offen offset:96 sc1
    s_lshl_b32 s40, s54, 7
    s_add_u32 s41, s40, 8192
    buffer_load_dwordx4 v[32:35], v87, s[60:63], s40 offen offset:0 sc1
    buffer_load_dwordx4 v[64:67], v87, s[60:63], s41 offen offset:0 sc1
    buffer_load_dwordx4 v[36:39], v87, s[60:63], s40 offen offset:32 sc1
    buffer_load_dwordx4 v[68:71], v87, s[60:63], s41 offen offset:32 sc1
    buffer_load_dwordx4 v[40:43], v87, s[60:63], s40 offen offset:64 sc1
    buffer_load_dwordx4 v[72:75], v87, s[60:63], s41 offen offset:64 sc1
    buffer_load_dwordx4 v[44:47], v87, s[60:63], s40 offen offset:96 sc1
    buffer_load_dwordx4 v[76:79], v87, s[60:63], s41 offen offset:96 sc1
    s_barrier
    s_waitcnt lgkmcnt(3)
    v_mfma_f32_32x32x16_bf16 v[132:147], v[196:199], v[212:215], v[132:147]
    ds_read_b64_tr_b16 v[220:221], v128 offset:36864
    ds_read_b64_tr_b16 v[222:223], v128 offset:37888
    s_waitcnt lgkmcnt(4)
    v_mfma_f32_32x32x16_bf16 v[148:163], v[200:203], v[212:215], v[148:163]
    ds_read_b128 v[204:207], v117 offset:0
    ds_read_b128 v[208:211], v121 offset:0
    s_waitcnt lgkmcnt(4)
    v_mfma_f32_32x32x16_bf16 v[164:179], v[196:199], v[216:219], v[164:179]
    ds_read_b64_tr_b16 v[224:225], v129 offset:36864
    ds_read_b64_tr_b16 v[226:227], v129 offset:37888
    v_mfma_f32_32x32x16_bf16 v[180:195], v[200:203], v[216:219], v[180:195]
    s_waitcnt lgkmcnt(3)
    v_mfma_f32_32x32x16_bf16 v[132:147], v[204:207], v[220:223], v[132:147]
    ds_read_b64_tr_b16 v[212:213], v128 offset:40960
    ds_read_b64_tr_b16 v[214:215], v128 offset:41984
    s_waitcnt lgkmcnt(4)
    v_mfma_f32_32x32x16_bf16 v[148:163], v[208:211], v[220:223], v[148:163]
    ds_read_b128 v[196:199], v118 offset:0
    ds_read_b128 v[200:203], v122 offset:0
    s_waitcnt lgkmcnt(4)
    v_mfma_f32_32x32x16_bf16 v[164:179], v[204:207], v[224:227], v[164:179]
    ds_read_b64_tr_b16 v[216:217], v129 offset:40960
    ds_read_b64_tr_b16 v[218:219], v129 offset:41984
    v_mfma_f32_32x32x16_bf16 v[180:195], v[208:211], v[224:227], v[180:195]
    s_waitcnt lgkmcnt(3)
    v_mfma_f32_32x32x16_bf16 v[132:147], v[196:199], v[212:215], v[132:147]
    ds_read_b64_tr_b16 v[220:221], v128 offset:45056
    ds_read_b64_tr_b16 v[222:223], v128 offset:46080
    s_waitcnt lgkmcnt(4)
    v_mfma_f32_32x32x16_bf16 v[148:163], v[200:203], v[212:215], v[148:163]
    ds_read_b128 v[204:207], v119 offset:0
    ds_read_b128 v[208:211], v123 offset:0
    s_waitcnt lgkmcnt(4)
    v_mfma_f32_32x32x16_bf16 v[164:179], v[196:199], v[216:219], v[164:179]
    ds_read_b64_tr_b16 v[224:225], v129 offset:45056
    ds_read_b64_tr_b16 v[226:227], v129 offset:46080
    v_mfma_f32_32x32x16_bf16 v[180:195], v[200:203], v[216:219], v[180:195]
    s_waitcnt vmcnt(16)
    s_barrier
    s_waitcnt lgkmcnt(3)
    v_mfma_f32_32x32x16_bf16 v[132:147], v[204:207], v[220:223], v[132:147]
    ds_read_b64_tr_b16 v[212:213], v124 offset:32768
    ds_read_b64_tr_b16 v[214:215], v124 offset:33792
    s_waitcnt lgkmcnt(4)
    v_mfma_f32_32x32x16_bf16 v[148:163], v[208:211], v[220:223], v[148:163]
    ds_read_b128 v[196:199], v100 offset:0
    ds_read_b128 v[200:203], v104 offset:0
    s_waitcnt lgkmcnt(4)
    v_mfma_f32_32x32x16_bf16 v[164:179], v[204:207], v[224:227], v[164:179]
    ds_read_b64_tr_b16 v[216:217], v125 offset:32768
    ds_read_b64_tr_b16 v[218:219], v125 offset:33792
    v_mfma_f32_32x32x16_bf16 v[180:195], v[208:211], v[224:227], v[180:195]
    s_barrier
    s_waitcnt lgkmcnt(3)
    v_mfma_f32_32x32x16_bf16 v[132:147], v[196:199], v[212:215], v[132:147]
    ds_read_b64_tr_b16 v[220:221], v124 offset:36864
    ds_read_b64_tr_b16 v[222:223], v124 offset:37888
    s_waitcnt lgkmcnt(4)
    v_mfma_f32_32x32x16_bf16 v[148:163], v[200:203], v[212:215], v[148:163]
    ds_read_b128 v[204:207], v101 offset:0
    ds_read_b128 v[208:211], v105 offset:0
    s_waitcnt lgkmcnt(4)
    v_mfma_f32_32x32x16_bf16 v[164:179], v[196:199], v[216:219], v[164:179]
    ds_read_b64_tr_b16 v[224:225], v125 offset:36864
    ds_read_b64_tr_b16 v[226:227], v125 offset:37888
    v_mfma_f32_32x32x16_bf16 v[180:195], v[200:203], v[216:219], v[180:195]
    s_waitcnt lgkmcnt(3)
    v_mfma_f32_32x32x16_bf16 v[132:147], v[204:207], v[220:223], v[132:147]
    ds_read_b64_tr_b16 v[212:213], v124 offset:40960
    ds_read_b64_tr_b16 v[214:215], v124 offset:41984
    s_waitcnt lgkmcnt(4)
    v_mfma_f32_32x32x16_bf16 v[148:163], v[208:211], v[220:223], v[148:163]
    ds_read_b128 v[196:199], v102 offset:0
    ds_read_b128 v[200:203], v106 offset:0
    s_waitcnt lgkmcnt(4)
    v_mfma_f32_32x32x16_bf16 v[164:179], v[204:207], v[224:227], v[164:179]
    ds_read_b64_tr_b16 v[216:217], v125 offset:40960
    ds_read_b64_tr_b16 v[218:219], v125 offset:41984
    v_mfma_f32_32x32x16_bf16 v[180:195], v[208:211], v[224:227], v[180:195]
    s_waitcnt lgkmcnt(3)
    v_mfma_f32_32x32x16_bf16 v[132:147], v[196:199], v[212:215], v[132:147]
    ds_read_b64_tr_b16 v[220:221], v124 offset:45056
    ds_read_b64_tr_b16 v[222:223], v124 offset:46080
    s_waitcnt lgkmcnt(4)
    v_mfma_f32_32x32x16_bf16 v[148:163], v[200:203], v[212:215], v[148:163]
    ds_read_b128 v[204:207], v103 offset:0
    ds_read_b128 v[208:211], v107 offset:0
    s_waitcnt lgkmcnt(4)
    v_mfma_f32_32x32x16_bf16 v[164:179], v[196:199], v[216:219], v[164:179]
    ds_read_b64_tr_b16 v[224:225], v125 offset:45056
    ds_read_b64_tr_b16 v[226:227], v125 offset:46080
    v_mfma_f32_32x32x16_bf16 v[180:195], v[200:203], v[216:219], v[180:195]
    s_waitcnt lgkmcnt(3)
    v_mfma_f32_32x32x16_bf16 v[132:147], v[204:207], v[220:223], v[132:147]
    s_waitcnt lgkmcnt(2)
    v_mfma_f32_32x32x16_bf16 v[148:163], v[208:211], v[220:223], v[148:163]
    s_waitcnt lgkmcnt(0)
    v_mfma_f32_32x32x16_bf16 v[164:179], v[204:207], v[224:227], v[164:179]
    v_mfma_f32_32x32x16_bf16 v[180:195], v[208:211], v[224:227], v[180:195]
.e1epi_12:
    s_lshl_b32 s39, s36, 8
    s_lshl_b32 s40, s55, 7
    s_add_u32 s39, s39, s40
    s_add_u32 s39, s39, 148480
    v_and_b32 v2, 15, v1
    v_lshlrev_b32 v3, 6, v2
    v_lshrrev_b32 v4, 4, v1
    v_lshlrev_b32 v4, 4, v4
    v_add3_u32 v3, v3, v4, s39
    s_cmp_ge_u32 s35, 2
    s_cbranch_scc1 .ncw_24
    v_cmp_gt_u32 vcc, 2, v2
    s_and_saveexec_b64 s[58:59], vcc
    ds_write_b128 v3, v[228:231]
    s_mov_b64 exec, s[58:59]
.ncw_24:
    s_mov_b32 s48, 1.0
    s_cmp_lt_u32 s33, 5
    s_cselect_b32 s48, 0x3ea52b5c, s48
    s_waitcnt vmcnt(0) lgkmcnt(0)
    s_barrier
    s_cmp_eq_u32 s49, 1
    s_cbranch_scc1 .e1epiV_13
    v_mul_f32 v80, s48, v80
    v_mul_f32 v82, s48, v82
    v_mul_f32 v81, s48, v81
    v_mul_f32 v83, s48, v83
    s_lshl_b32 s39, s36, 8
    s_lshl_b32 s40, s55, 7
    s_add_u32 s39, s39, s40
    s_add_u32 s39, s39, 148480
    v_add_u32 v4, s39, v89
    ds_read_b128 v[196:199], v4 offset:0
    ds_read_b128 v[200:203], v4 offset:32
    ds_read_b128 v[204:207], v4 offset:64
    ds_read_b128 v[208:211], v4 offset:96
    s_lshl_b32 s39, s36, 8
    s_lshl_b32 s40, s56, 7
    s_add_u32 s39, s39, s40
    s_add_u32 s39, s39, 148480
    v_add_u32 v4, s39, v89
    ds_read_b128 v[212:215], v4 offset:0
    ds_read_b128 v[216:219], v4 offset:32
    ds_read_b128 v[220:223], v4 offset:64
    ds_read_b128 v[224:227], v4 offset:96
    s_cmp_ge_u32 s33, 15
    s_cbranch_scc1 .e1epiF_25
    s_waitcnt lgkmcnt(0)
    v_pk_mul_f32 v[246:247], v[196:197], v[82:83] op_sel:[0,0] op_sel_hi:[1,0]
    v_pk_fma_f32 v[132:133], v[132:133], v[80:81], v[246:247] op_sel:[0,0,0] op_sel_hi:[1,0,1] neg_lo:[0,0,1] neg_hi:[0,0,1]
    v_pk_mul_f32 v[248:249], v[198:199], v[82:83] op_sel:[0,0] op_sel_hi:[1,0]
    v_pk_fma_f32 v[134:135], v[134:135], v[80:81], v[248:249] op_sel:[0,0,0] op_sel_hi:[1,0,1] neg_lo:[0,0,1] neg_hi:[0,0,1]
    v_pk_mul_f32 v[246:247], v[200:201], v[82:83] op_sel:[0,0] op_sel_hi:[1,0]
    v_pk_fma_f32 v[136:137], v[136:137], v[80:81], v[246:247] op_sel:[0,0,0] op_sel_hi:[1,0,1] neg_lo:[0,0,1] neg_hi:[0,0,1]
    v_pk_mul_f32 v[248:249], v[202:203], v[82:83] op_sel:[0,0] op_sel_hi:[1,0]
    v_pk_fma_f32 v[138:139], v[138:139], v[80:81], v[248:249] op_sel:[0,0,0] op_sel_hi:[1,0,1] neg_lo:[0,0,1] neg_hi:[0,0,1]
    v_pk_mul_f32 v[246:247], v[204:205], v[82:83] op_sel:[0,0] op_sel_hi:[1,0]
    v_pk_fma_f32 v[140:141], v[140:141], v[80:81], v[246:247] op_sel:[0,0,0] op_sel_hi:[1,0,1] neg_lo:[0,0,1] neg_hi:[0,0,1]
    v_pk_mul_f32 v[248:249], v[206:207], v[82:83] op_sel:[0,0] op_sel_hi:[1,0]
    v_pk_fma_f32 v[142:143], v[142:143], v[80:81], v[248:249] op_sel:[0,0,0] op_sel_hi:[1,0,1] neg_lo:[0,0,1] neg_hi:[0,0,1]
    v_pk_mul_f32 v[246:247], v[208:209], v[82:83] op_sel:[0,0] op_sel_hi:[1,0]
    v_pk_fma_f32 v[144:145], v[144:145], v[80:81], v[246:247] op_sel:[0,0,0] op_sel_hi:[1,0,1] neg_lo:[0,0,1] neg_hi:[0,0,1]
    v_pk_mul_f32 v[248:249], v[210:211], v[82:83] op_sel:[0,0] op_sel_hi:[1,0]
    v_pk_fma_f32 v[146:147], v[146:147], v[80:81], v[248:249] op_sel:[0,0,0] op_sel_hi:[1,0,1] neg_lo:[0,0,1] neg_hi:[0,0,1]
    v_cvt_pk_bf16_f32 v236, v132, v133
    v_cvt_pk_bf16_f32 v237, v134, v135
    v_cvt_pk_bf16_f32 v238, v136, v137
    v_cvt_pk_bf16_f32 v239, v138, v139
    v_add_u32 v244, v96, v90
    v_cvt_pk_bf16_f32 v240, v140, v141
    v_cvt_pk_bf16_f32 v241, v142, v143
    v_cvt_pk_bf16_f32 v242, v144, v145
    v_cvt_pk_bf16_f32 v243, v146, v147
    v_add_u32 v245, v97, v90
    s_nop 0
    v_permlane32_swap_b32 v236, v238
    v_permlane32_swap_b32 v237, v239
    v_permlane32_swap_b32 v240, v242
    v_permlane32_swap_b32 v241, v243
    buffer_store_dwordx4 v[236:239], v244, s[24:27], 0 offen
    buffer_store_dwordx4 v[240:243], v245, s[24:27], 0 offen
    s_nop 1
    v_pk_mul_f32 v[246:247], v[196:197], v[82:83] op_sel:[0,1] op_sel_hi:[1,1]
    v_pk_fma_f32 v[148:149], v[148:149], v[80:81], v[246:247] op_sel:[0,1,0] op_sel_hi:[1,1,1] neg_lo:[0,0,1] neg_hi:[0,0,1]
    v_pk_mul_f32 v[248:249], v[198:199], v[82:83] op_sel:[0,1] op_sel_hi:[1,1]
    v_pk_fma_f32 v[150:151], v[150:151], v[80:81], v[248:249] op_sel:[0,1,0] op_sel_hi:[1,1,1] neg_lo:[0,0,1] neg_hi:[0,0,1]
    v_pk_mul_f32 v[246:247], v[200:201], v[82:83] op_sel:[0,1] op_sel_hi:[1,1]
    v_pk_fma_f32 v[152:153], v[152:153], v[80:81], v[246:247] op_sel:[0,1,0] op_sel_hi:[1,1,1] neg_lo:[0,0,1] neg_hi:[0,0,1]
    v_pk_mul_f32 v[248:249], v[202:203], v[82:83] op_sel:[0,1] op_sel_hi:[1,1]
    v_pk_fma_f32 v[154:155], v[154:155], v[80:81], v[248:249] op_sel:[0,1,0] op_sel_hi:[1,1,1] neg_lo:[0,0,1] neg_hi:[0,0,1]
    v_pk_mul_f32 v[246:247], v[204:205], v[82:83] op_sel:[0,1] op_sel_hi:[1,1]
    v_pk_fma_f32 v[156:157], v[156:157], v[80:81], v[246:247] op_sel:[0,1,0] op_sel_hi:[1,1,1] neg_lo:[0,0,1] neg_hi:[0,0,1]
    v_pk_mul_f32 v[248:249], v[206:207], v[82:83] op_sel:[0,1] op_sel_hi:[1,1]
    v_pk_fma_f32 v[158:159], v[158:159], v[80:81], v[248:249] op_sel:[0,1,0] op_sel_hi:[1,1,1] neg_lo:[0,0,1] neg_hi:[0,0,1]
    v_pk_mul_f32 v[246:247], v[208:209], v[82:83] op_sel:[0,1] op_sel_hi:[1,1]
    v_pk_fma_f32 v[160:161], v[160:161], v[80:81], v[246:247] op_sel:[0,1,0] op_sel_hi:[1,1,1] neg_lo:[0,0,1] neg_hi:[0,0,1]
    v_pk_mul_f32 v[248:249], v[210:211], v[82:83] op_sel:[0,1] op_sel_hi:[1,1]
    v_pk_fma_f32 v[162:163], v[162:163], v[80:81], v[248:249] op_sel:[0,1,0] op_sel_hi:[1,1,1] neg_lo:[0,0,1] neg_hi:[0,0,1]
    v_cvt_pk_bf16_f32 v236, v148, v149
    v_cvt_pk_bf16_f32 v237, v150, v151
    v_cvt_pk_bf16_f32 v238, v152, v153
    v_cvt_pk_bf16_f32 v239, v154, v155
    v_add_u32 v244, v96, v91
    v_cvt_pk_bf16_f32 v240, v156, v157
    v_cvt_pk_bf16_f32 v241, v158, v159
    v_cvt_pk_bf16_f32 v242, v160, v161
    v_cvt_pk_bf16_f32 v243, v162, v163
    v_add_u32 v245, v97, v91
    s_nop 0
    v_permlane32_swap_b32 v236, v238
    v_permlane32_swap_b32 v237, v239
    v_permlane32_swap_b32 v240, v242
    v_permlane32_swap_b32 v241, v243
    buffer_store_dwordx4 v[236:239], v244, s[24:27], 0 offen
    buffer_store_dwordx4 v[240:243], v245, s[24:27], 0 offen
    s_nop 1
    v_pk_mul_f32 v[246:247], v[212:213], v[82:83] op_sel:[0,0] op_sel_hi:[1,0]
    v_pk_fma_f32 v[164:165], v[164:165], v[80:81], v[246:247] op_sel:[0,0,0] op_sel_hi:[1,0,1] neg_lo:[0,0,1] neg_hi:[0,0,1]
    v_pk_mul_f32 v[248:249], v[214:215], v[82:83] op_sel:[0,0] op_sel_hi:[1,0]
    v_pk_fma_f32 v[166:167], v[166:167], v[80:81], v[248:249] op_sel:[0,0,0] op_sel_hi:[1,0,1] neg_lo:[0,0,1] neg_hi:[0,0,1]
    v_pk_mul_f32 v[246:247], v[216:217], v[82:83] op_sel:[0,0] op_sel_hi:[1,0]
    v_pk_fma_f32 v[168:169], v[168:169], v[80:81], v[246:247] op_sel:[0,0,0] op_sel_hi:[1,0,1] neg_lo:[0,0,1] neg_hi:[0,0,1]
    v_pk_mul_f32 v[248:249], v[218:219], v[82:83] op_sel:[0,0] op_sel_hi:[1,0]
    v_pk_fma_f32 v[170:171], v[170:171], v[80:81], v[248:249] op_sel:[0,0,0] op_sel_hi:[1,0,1] neg_lo:[0,0,1] neg_hi:[0,0,1]
    v_pk_mul_f32 v[246:247], v[220:221], v[82:83] op_sel:[0,0] op_sel_hi:[1,0]
    v_pk_fma_f32 v[172:173], v[172:173], v[80:81], v[246:247] op_sel:[0,0,0] op_sel_hi:[1,0,1] neg_lo:[0,0,1] neg_hi:[0,0,1]
    v_pk_mul_f32 v[248:249], v[222:223], v[82:83] op_sel:[0,0] op_sel_hi:[1,0]
    v_pk_fma_f32 v[174:175], v[174:175], v[80:81], v[248:249] op_sel:[0,0,0] op_sel_hi:[1,0,1] neg_lo:[0,0,1] neg_hi:[0,0,1]
    v_pk_mul_f32 v[246:247], v[224:225], v[82:83] op_sel:[0,0] op_sel_hi:[1,0]
    v_pk_fma_f32 v[176:177], v[176:177], v[80:81], v[246:247] op_sel:[0,0,0] op_sel_hi:[1,0,1] neg_lo:[0,0,1] neg_hi:[0,0,1]
    v_pk_mul_f32 v[248:249], v[226:227], v[82:83] op_sel:[0,0] op_sel_hi:[1,0]
    v_pk_fma_f32 v[178:179], v[178:179], v[80:81], v[248:249] op_sel:[0,0,0] op_sel_hi:[1,0,1] neg_lo:[0,0,1] neg_hi:[0,0,1]
    v_cvt_pk_bf16_f32 v236, v164, v165
    v_cvt_pk_bf16_f32 v237, v166, v167
    v_cvt_pk_bf16_f32 v238, v168, v169
    v_cvt_pk_bf16_f32 v239, v170, v171
    v_add_u32 v244, v98, v90
    v_cvt_pk_bf16_f32 v240, v172, v173
    v_cvt_pk_bf16_f32 v241, v174, v175
    v_cvt_pk_bf16_f32 v242, v176, v177
    v_cvt_pk_bf16_f32 v243, v178, v179
    v_add_u32 v245, v99, v90
    s_nop 0
    v_permlane32_swap_b32 v236, v238
    v_permlane32_swap_b32 v237, v239
    v_permlane32_swap_b32 v240, v242
    v_permlane32_swap_b32 v241, v243
    buffer_store_dwordx4 v[236:239], v244, s[24:27], 0 offen
    buffer_store_dwordx4 v[240:243], v245, s[24:27], 0 offen
    s_nop 1
    v_pk_mul_f32 v[246:247], v[212:213], v[82:83] op_sel:[0,1] op_sel_hi:[1,1]
    v_pk_fma_f32 v[180:181], v[180:181], v[80:81], v[246:247] op_sel:[0,1,0] op_sel_hi:[1,1,1] neg_lo:[0,0,1] neg_hi:[0,0,1]
    v_pk_mul_f32 v[248:249], v[214:215], v[82:83] op_sel:[0,1] op_sel_hi:[1,1]
    v_pk_fma_f32 v[182:183], v[182:183], v[80:81], v[248:249] op_sel:[0,1,0] op_sel_hi:[1,1,1] neg_lo:[0,0,1] neg_hi:[0,0,1]
    v_pk_mul_f32 v[246:247], v[216:217], v[82:83] op_sel:[0,1] op_sel_hi:[1,1]
    v_pk_fma_f32 v[184:185], v[184:185], v[80:81], v[246:247] op_sel:[0,1,0] op_sel_hi:[1,1,1] neg_lo:[0,0,1] neg_hi:[0,0,1]
    v_pk_mul_f32 v[248:249], v[218:219], v[82:83] op_sel:[0,1] op_sel_hi:[1,1]
    v_pk_fma_f32 v[186:187], v[186:187], v[80:81], v[248:249] op_sel:[0,1,0] op_sel_hi:[1,1,1] neg_lo:[0,0,1] neg_hi:[0,0,1]
    v_pk_mul_f32 v[246:247], v[220:221], v[82:83] op_sel:[0,1] op_sel_hi:[1,1]
    v_pk_fma_f32 v[188:189], v[188:189], v[80:81], v[246:247] op_sel:[0,1,0] op_sel_hi:[1,1,1] neg_lo:[0,0,1] neg_hi:[0,0,1]
    v_pk_mul_f32 v[248:249], v[222:223], v[82:83] op_sel:[0,1] op_sel_hi:[1,1]
    v_pk_fma_f32 v[190:191], v[190:191], v[80:81], v[248:249] op_sel:[0,1,0] op_sel_hi:[1,1,1] neg_lo:[0,0,1] neg_hi:[0,0,1]
    v_pk_mul_f32 v[246:247], v[224:225], v[82:83] op_sel:[0,1] op_sel_hi:[1,1]
    v_pk_fma_f32 v[192:193], v[192:193], v[80:81], v[246:247] op_sel:[0,1,0] op_sel_hi:[1,1,1] neg_lo:[0,0,1] neg_hi:[0,0,1]
    v_pk_mul_f32 v[248:249], v[226:227], v[82:83] op_sel:[0,1] op_sel_hi:[1,1]
    v_pk_fma_f32 v[194:195], v[194:195], v[80:81], v[248:249] op_sel:[0,1,0] op_sel_hi:[1,1,1] neg_lo:[0,0,1] neg_hi:[0,0,1]
    v_cvt_pk_bf16_f32 v236, v180, v181
    v_cvt_pk_bf16_f32 v237, v182, v183
    v_cvt_pk_bf16_f32 v238, v184, v185
    v_cvt_pk_bf16_f32 v239, v186, v187
    v_add_u32 v244, v98, v91
    v_cvt_pk_bf16_f32 v240, v188, v189
    v_cvt_pk_bf16_f32 v241, v190, v191
    v_cvt_pk_bf16_f32 v242, v192, v193
    v_cvt_pk_bf16_f32 v243, v194, v195
    v_add_u32 v245, v99, v91
    s_nop 0
    v_permlane32_swap_b32 v236, v238
    v_permlane32_swap_b32 v237, v239
    v_permlane32_swap_b32 v240, v242
    v_permlane32_swap_b32 v241, v243
    buffer_store_dwordx4 v[236:239], v244, s[24:27], 0 offen
    buffer_store_dwordx4 v[240:243], v245, s[24:27], 0 offen
    s_nop 1
    s_endpgm
.e1epiF_25:
    s_waitcnt vmcnt(0) lgkmcnt(0)
    v_lshlrev_b32 v32, 16, v16
    v_and_b32 v33, 0xffff0000, v16
    v_lshlrev_b32 v34, 16, v17
    v_and_b32 v35, 0xffff0000, v17
    v_lshlrev_b32 v36, 16, v18
    v_and_b32 v37, 0xffff0000, v18
    v_lshlrev_b32 v38, 16, v19
    v_and_b32 v39, 0xffff0000, v19
    v_lshlrev_b32 v40, 16, v20
    v_and_b32 v41, 0xffff0000, v20
    v_lshlrev_b32 v42, 16, v21
    v_and_b32 v43, 0xffff0000, v21
    v_lshlrev_b32 v44, 16, v22
    v_and_b32 v45, 0xffff0000, v22
    v_lshlrev_b32 v46, 16, v23
    v_and_b32 v47, 0xffff0000, v23
    v_pk_fma_f32 v[246:247], v[196:197], v[82:83], v[32:33] op_sel:[0,0,0] op_sel_hi:[1,0,1] neg_lo:[0,1,0] neg_hi:[0,1,0]
    v_pk_fma_f32 v[132:133], v[132:133], v[80:81], v[246:247] op_sel:[0,0,0] op_sel_hi:[1,0,1]
    v_pk_fma_f32 v[248:249], v[198:199], v[82:83], v[34:35] op_sel:[0,0,0] op_sel_hi:[1,0,1] neg_lo:[0,1,0] neg_hi:[0,1,0]
    v_pk_fma_f32 v[134:135], v[134:135], v[80:81], v[248:249] op_sel:[0,0,0] op_sel_hi:[1,0,1]
    v_pk_fma_f32 v[246:247], v[200:201], v[82:83], v[36:37] op_sel:[0,0,0] op_sel_hi:[1,0,1] neg_lo:[0,1,0] neg_hi:[0,1,0]
    v_pk_fma_f32 v[136:137], v[136:137], v[80:81], v[246:247] op_sel:[0,0,0] op_sel_hi:[1,0,1]
    v_pk_fma_f32 v[248:249], v[202:203], v[82:83], v[38:39] op_sel:[0,0,0] op_sel_hi:[1,0,1] neg_lo:[0,1,0] neg_hi:[0,1,0]
    v_pk_fma_f32 v[138:139], v[138:139], v[80:81], v[248:249] op_sel:[0,0,0] op_sel_hi:[1,0,1]
    v_pk_fma_f32 v[246:247], v[204:205], v[82:83], v[40:41] op_sel:[0,0,0] op_sel_hi:[1,0,1] neg_lo:[0,1,0] neg_hi:[0,1,0]
    v_pk_fma_f32 v[140:141], v[140:141], v[80:81], v[246:247] op_sel:[0,0,0] op_sel_hi:[1,0,1]
    v_pk_fma_f32 v[248:249], v[206:207], v[82:83], v[42:43] op_sel:[0,0,0] op_sel_hi:[1,0,1] neg_lo:[0,1,0] neg_hi:[0,1,0]
    v_pk_fma_f32 v[142:143], v[142:143], v[80:81], v[248:249] op_sel:[0,0,0] op_sel_hi:[1,0,1]
    v_pk_fma_f32 v[246:247], v[208:209], v[82:83], v[44:45] op_sel:[0,0,0] op_sel_hi:[1,0,1] neg_lo:[0,1,0] neg_hi:[0,1,0]
    v_pk_fma_f32 v[144:145], v[144:145], v[80:81], v[246:247] op_sel:[0,0,0] op_sel_hi:[1,0,1]
    v_pk_fma_f32 v[248:249], v[210:211], v[82:83], v[46:47] op_sel:[0,0,0] op_sel_hi:[1,0,1] neg_lo:[0,1,0] neg_hi:[0,1,0]
    v_pk_fma_f32 v[146:147], v[146:147], v[80:81], v[248:249] op_sel:[0,0,0] op_sel_hi:[1,0,1]
    v_max_f32 v132, 0, v132
    v_max_f32 v133, 0, v133
    v_max_f32 v134, 0, v134
    v_max_f32 v135, 0, v135
    v_max_f32 v136, 0, v136
    v_max_f32 v137, 0, v137
    v_max_f32 v138, 0, v138
    v_max_f32 v139, 0, v139
    v_max_f32 v140, 0, v140
    v_max_f32 v141, 0, v141
    v_max_f32 v142, 0, v142
    v_max_f32 v143, 0, v143
    v_max_f32 v144, 0, v144
    v_max_f32 v145, 0, v145
    v_max_f32 v146, 0, v146
    v_max_f32 v147, 0, v147
    v_pk_mul_f32 v[132:133], v[132:133], v[132:133]
    v_pk_mul_f32 v[134:135], v[134:135], v[134:135]
    v_pk_mul_f32 v[136:137], v[136:137], v[136:137]
    v_pk_mul_f32 v[138:139], v[138:139], v[138:139]
    v_pk_mul_f32 v[140:141], v[140:141], v[140:141]
    v_pk_mul_f32 v[142:143], v[142:143], v[142:143]
    v_pk_mul_f32 v[144:145], v[144:145], v[144:145]
    v_pk_mul_f32 v[146:147], v[146:147], v[146:147]
    v_cvt_pk_bf16_f32 v236, v132, v133
    v_cvt_pk_bf16_f32 v237, v134, v135
    v_cvt_pk_bf16_f32 v238, v136, v137
    v_cvt_pk_bf16_f32 v239, v138, v139
    buffer_store_dwordx4 v[236:239], v90, s[24:27], s45 offen offset:0
    v_cvt_pk_bf16_f32 v240, v140, v141
    v_cvt_pk_bf16_f32 v241, v142, v143
    v_cvt_pk_bf16_f32 v242, v144, v145
    v_cvt_pk_bf16_f32 v243, v146, v147
    buffer_store_dwordx4 v[240:243], v90, s[24:27], s45 offen offset:512
    s_nop 1
    v_pk_fma_f32 v[246:247], v[196:197], v[82:83], v[32:33] op_sel:[0,1,0] op_sel_hi:[1,1,1] neg_lo:[0,1,0] neg_hi:[0,1,0]
    v_pk_fma_f32 v[148:149], v[148:149], v[80:81], v[246:247] op_sel:[0,1,0] op_sel_hi:[1,1,1]
    v_pk_fma_f32 v[248:249], v[198:199], v[82:83], v[34:35] op_sel:[0,1,0] op_sel_hi:[1,1,1] neg_lo:[0,1,0] neg_hi:[0,1,0]
    v_pk_fma_f32 v[150:151], v[150:151], v[80:81], v[248:249] op_sel:[0,1,0] op_sel_hi:[1,1,1]
    v_pk_fma_f32 v[246:247], v[200:201], v[82:83], v[36:37] op_sel:[0,1,0] op_sel_hi:[1,1,1] neg_lo:[0,1,0] neg_hi:[0,1,0]
    v_pk_fma_f32 v[152:153], v[152:153], v[80:81], v[246:247] op_sel:[0,1,0] op_sel_hi:[1,1,1]
    v_pk_fma_f32 v[248:249], v[202:203], v[82:83], v[38:39] op_sel:[0,1,0] op_sel_hi:[1,1,1] neg_lo:[0,1,0] neg_hi:[0,1,0]
    v_pk_fma_f32 v[154:155], v[154:155], v[80:81], v[248:249] op_sel:[0,1,0] op_sel_hi:[1,1,1]
    v_pk_fma_f32 v[246:247], v[204:205], v[82:83], v[40:41] op_sel:[0,1,0] op_sel_hi:[1,1,1] neg_lo:[0,1,0] neg_hi:[0,1,0]
    v_pk_fma_f32 v[156:157], v[156:157], v[80:81], v[246:247] op_sel:[0,1,0] op_sel_hi:[1,1,1]
    v_pk_fma_f32 v[248:249], v[206:207], v[82:83], v[42:43] op_sel:[0,1,0] op_sel_hi:[1,1,1] neg_lo:[0,1,0] neg_hi:[0,1,0]
    v_pk_fma_f32 v[158:159], v[158:159], v[80:81], v[248:249] op_sel:[0,1,0] op_sel_hi:[1,1,1]
    v_pk_fma_f32 v[246:247], v[208:209], v[82:83], v[44:45] op_sel:[0,1,0] op_sel_hi:[1,1,1] neg_lo:[0,1,0] neg_hi:[0,1,0]
    v_pk_fma_f32 v[160:161], v[160:161], v[80:81], v[246:247] op_sel:[0,1,0] op_sel_hi:[1,1,1]
    v_pk_fma_f32 v[248:249], v[210:211], v[82:83], v[46:47] op_sel:[0,1,0] op_sel_hi:[1,1,1] neg_lo:[0,1,0] neg_hi:[0,1,0]
    v_pk_fma_f32 v[162:163], v[162:163], v[80:81], v[248:249] op_sel:[0,1,0] op_sel_hi:[1,1,1]
    v_max_f32 v148, 0, v148
    v_max_f32 v149, 0, v149
    v_max_f32 v150, 0, v150
    v_max_f32 v151, 0, v151
    v_max_f32 v152, 0, v152
    v_max_f32 v153, 0, v153
    v_max_f32 v154, 0, v154
    v_max_f32 v155, 0, v155
    v_max_f32 v156, 0, v156
    v_max_f32 v157, 0, v157
    v_max_f32 v158, 0, v158
    v_max_f32 v159, 0, v159
    v_max_f32 v160, 0, v160
    v_max_f32 v161, 0, v161
    v_max_f32 v162, 0, v162
    v_max_f32 v163, 0, v163
    v_pk_mul_f32 v[148:149], v[148:149], v[148:149]
    v_pk_mul_f32 v[150:151], v[150:151], v[150:151]
    v_pk_mul_f32 v[152:153], v[152:153], v[152:153]
    v_pk_mul_f32 v[154:155], v[154:155], v[154:155]
    v_pk_mul_f32 v[156:157], v[156:157], v[156:157]
    v_pk_mul_f32 v[158:159], v[158:159], v[158:159]
    v_pk_mul_f32 v[160:161], v[160:161], v[160:161]
    v_pk_mul_f32 v[162:163], v[162:163], v[162:163]
    v_cvt_pk_bf16_f32 v236, v148, v149
    v_cvt_pk_bf16_f32 v237, v150, v151
    v_cvt_pk_bf16_f32 v238, v152, v153
    v_cvt_pk_bf16_f32 v239, v154, v155
    buffer_store_dwordx4 v[236:239], v91, s[24:27], s45 offen offset:0
    v_cvt_pk_bf16_f32 v240, v156, v157
    v_cvt_pk_bf16_f32 v241, v158, v159
    v_cvt_pk_bf16_f32 v242, v160, v161
    v_cvt_pk_bf16_f32 v243, v162, v163
    buffer_store_dwordx4 v[240:243], v91, s[24:27], s45 offen offset:512
    s_nop 1
    v_lshlrev_b32 v32, 16, v24
    v_and_b32 v33, 0xffff0000, v24
    v_lshlrev_b32 v34, 16, v25
    v_and_b32 v35, 0xffff0000, v25
    v_lshlrev_b32 v36, 16, v26
    v_and_b32 v37, 0xffff0000, v26
    v_lshlrev_b32 v38, 16, v27
    v_and_b32 v39, 0xffff0000, v27
    v_lshlrev_b32 v40, 16, v28
    v_and_b32 v41, 0xffff0000, v28
    v_lshlrev_b32 v42, 16, v29
    v_and_b32 v43, 0xffff0000, v29
    v_lshlrev_b32 v44, 16, v30
    v_and_b32 v45, 0xffff0000, v30
    v_lshlrev_b32 v46, 16, v31
    v_and_b32 v47, 0xffff0000, v31
    v_pk_fma_f32 v[246:247], v[212:213], v[82:83], v[32:33] op_sel:[0,0,0] op_sel_hi:[1,0,1] neg_lo:[0,1,0] neg_hi:[0,1,0]
    v_pk_fma_f32 v[164:165], v[164:165], v[80:81], v[246:247] op_sel:[0,0,0] op_sel_hi:[1,0,1]
    v_pk_fma_f32 v[248:249], v[214:215], v[82:83], v[34:35] op_sel:[0,0,0] op_sel_hi:[1,0,1] neg_lo:[0,1,0] neg_hi:[0,1,0]
    v_pk_fma_f32 v[166:167], v[166:167], v[80:81], v[248:249] op_sel:[0,0,0] op_sel_hi:[1,0,1]
    v_pk_fma_f32 v[246:247], v[216:217], v[82:83], v[36:37] op_sel:[0,0,0] op_sel_hi:[1,0,1] neg_lo:[0,1,0] neg_hi:[0,1,0]
    v_pk_fma_f32 v[168:169], v[168:169], v[80:81], v[246:247] op_sel:[0,0,0] op_sel_hi:[1,0,1]
    v_pk_fma_f32 v[248:249], v[218:219], v[82:83], v[38:39] op_sel:[0,0,0] op_sel_hi:[1,0,1] neg_lo:[0,1,0] neg_hi:[0,1,0]
    v_pk_fma_f32 v[170:171], v[170:171], v[80:81], v[248:249] op_sel:[0,0,0] op_sel_hi:[1,0,1]
    v_pk_fma_f32 v[246:247], v[220:221], v[82:83], v[40:41] op_sel:[0,0,0] op_sel_hi:[1,0,1] neg_lo:[0,1,0] neg_hi:[0,1,0]
    v_pk_fma_f32 v[172:173], v[172:173], v[80:81], v[246:247] op_sel:[0,0,0] op_sel_hi:[1,0,1]
    v_pk_fma_f32 v[248:249], v[222:223], v[82:83], v[42:43] op_sel:[0,0,0] op_sel_hi:[1,0,1] neg_lo:[0,1,0] neg_hi:[0,1,0]
    v_pk_fma_f32 v[174:175], v[174:175], v[80:81], v[248:249] op_sel:[0,0,0] op_sel_hi:[1,0,1]
    v_pk_fma_f32 v[246:247], v[224:225], v[82:83], v[44:45] op_sel:[0,0,0] op_sel_hi:[1,0,1] neg_lo:[0,1,0] neg_hi:[0,1,0]
    v_pk_fma_f32 v[176:177], v[176:177], v[80:81], v[246:247] op_sel:[0,0,0] op_sel_hi:[1,0,1]
    v_pk_fma_f32 v[248:249], v[226:227], v[82:83], v[46:47] op_sel:[0,0,0] op_sel_hi:[1,0,1] neg_lo:[0,1,0] neg_hi:[0,1,0]
    v_pk_fma_f32 v[178:179], v[178:179], v[80:81], v[248:249] op_sel:[0,0,0] op_sel_hi:[1,0,1]
    v_max_f32 v164, 0, v164
    v_max_f32 v165, 0, v165
    v_max_f32 v166, 0, v166
    v_max_f32 v167, 0, v167
    v_max_f32 v168, 0, v168
    v_max_f32 v169, 0, v169
    v_max_f32 v170, 0, v170
    v_max_f32 v171, 0, v171
    v_max_f32 v172, 0, v172
    v_max_f32 v173, 0, v173
    v_max_f32 v174, 0, v174
    v_max_f32 v175, 0, v175
    v_max_f32 v176, 0, v176
    v_max_f32 v177, 0, v177
    v_max_f32 v178, 0, v178
    v_max_f32 v179, 0, v179
    v_pk_mul_f32 v[164:165], v[164:165], v[164:165]
    v_pk_mul_f32 v[166:167], v[166:167], v[166:167]
    v_pk_mul_f32 v[168:169], v[168:169], v[168:169]
    v_pk_mul_f32 v[170:171], v[170:171], v[170:171]
    v_pk_mul_f32 v[172:173], v[172:173], v[172:173]
    v_pk_mul_f32 v[174:175], v[174:175], v[174:175]
    v_pk_mul_f32 v[176:177], v[176:177], v[176:177]
    v_pk_mul_f32 v[178:179], v[178:179], v[178:179]
    v_cvt_pk_bf16_f32 v236, v164, v165
    v_cvt_pk_bf16_f32 v237, v166, v167
    v_cvt_pk_bf16_f32 v238, v168, v169
    v_cvt_pk_bf16_f32 v239, v170, v171
    buffer_store_dwordx4 v[236:239], v90, s[24:27], s46 offen offset:0
    v_cvt_pk_bf16_f32 v240, v172, v173
    v_cvt_pk_bf16_f32 v241, v174, v175
    v_cvt_pk_bf16_f32 v242, v176, v177
    v_cvt_pk_bf16_f32 v243, v178, v179
    buffer_store_dwordx4 v[240:243], v90, s[24:27], s46 offen offset:512
    s_nop 1
    v_pk_fma_f32 v[246:247], v[212:213], v[82:83], v[32:33] op_sel:[0,1,0] op_sel_hi:[1,1,1] neg_lo:[0,1,0] neg_hi:[0,1,0]
    v_pk_fma_f32 v[180:181], v[180:181], v[80:81], v[246:247] op_sel:[0,1,0] op_sel_hi:[1,1,1]
    v_pk_fma_f32 v[248:249], v[214:215], v[82:83], v[34:35] op_sel:[0,1,0] op_sel_hi:[1,1,1] neg_lo:[0,1,0] neg_hi:[0,1,0]
    v_pk_fma_f32 v[182:183], v[182:183], v[80:81], v[248:249] op_sel:[0,1,0] op_sel_hi:[1,1,1]
    v_pk_fma_f32 v[246:247], v[216:217], v[82:83], v[36:37] op_sel:[0,1,0] op_sel_hi:[1,1,1] neg_lo:[0,1,0] neg_hi:[0,1,0]
    v_pk_fma_f32 v[184:185], v[184:185], v[80:81], v[246:247] op_sel:[0,1,0] op_sel_hi:[1,1,1]
    v_pk_fma_f32 v[248:249], v[218:219], v[82:83], v[38:39] op_sel:[0,1,0] op_sel_hi:[1,1,1] neg_lo:[0,1,0] neg_hi:[0,1,0]
    v_pk_fma_f32 v[186:187], v[186:187], v[80:81], v[248:249] op_sel:[0,1,0] op_sel_hi:[1,1,1]
    v_pk_fma_f32 v[246:247], v[220:221], v[82:83], v[40:41] op_sel:[0,1,0] op_sel_hi:[1,1,1] neg_lo:[0,1,0] neg_hi:[0,1,0]
    v_pk_fma_f32 v[188:189], v[188:189], v[80:81], v[246:247] op_sel:[0,1,0] op_sel_hi:[1,1,1]
    v_pk_fma_f32 v[248:249], v[222:223], v[82:83], v[42:43] op_sel:[0,1,0] op_sel_hi:[1,1,1] neg_lo:[0,1,0] neg_hi:[0,1,0]
    v_pk_fma_f32 v[190:191], v[190:191], v[80:81], v[248:249] op_sel:[0,1,0] op_sel_hi:[1,1,1]
    v_pk_fma_f32 v[246:247], v[224:225], v[82:83], v[44:45] op_sel:[0,1,0] op_sel_hi:[1,1,1] neg_lo:[0,1,0] neg_hi:[0,1,0]
    v_pk_fma_f32 v[192:193], v[192:193], v[80:81], v[246:247] op_sel:[0,1,0] op_sel_hi:[1,1,1]
    v_pk_fma_f32 v[248:249], v[226:227], v[82:83], v[46:47] op_sel:[0,1,0] op_sel_hi:[1,1,1] neg_lo:[0,1,0] neg_hi:[0,1,0]
    v_pk_fma_f32 v[194:195], v[194:195], v[80:81], v[248:249] op_sel:[0,1,0] op_sel_hi:[1,1,1]
    v_max_f32 v180, 0, v180
    v_max_f32 v181, 0, v181
    v_max_f32 v182, 0, v182
    v_max_f32 v183, 0, v183
    v_max_f32 v184, 0, v184
    v_max_f32 v185, 0, v185
    v_max_f32 v186, 0, v186
    v_max_f32 v187, 0, v187
    v_max_f32 v188, 0, v188
    v_max_f32 v189, 0, v189
    v_max_f32 v190, 0, v190
    v_max_f32 v191, 0, v191
    v_max_f32 v192, 0, v192
    v_max_f32 v193, 0, v193
    v_max_f32 v194, 0, v194
    v_max_f32 v195, 0, v195
    v_pk_mul_f32 v[180:181], v[180:181], v[180:181]
    v_pk_mul_f32 v[182:183], v[182:183], v[182:183]
    v_pk_mul_f32 v[184:185], v[184:185], v[184:185]
    v_pk_mul_f32 v[186:187], v[186:187], v[186:187]
    v_pk_mul_f32 v[188:189], v[188:189], v[188:189]
    v_pk_mul_f32 v[190:191], v[190:191], v[190:191]
    v_pk_mul_f32 v[192:193], v[192:193], v[192:193]
    v_pk_mul_f32 v[194:195], v[194:195], v[194:195]
    v_cvt_pk_bf16_f32 v236, v180, v181
    v_cvt_pk_bf16_f32 v237, v182, v183
    v_cvt_pk_bf16_f32 v238, v184, v185
    v_cvt_pk_bf16_f32 v239, v186, v187
    buffer_store_dwordx4 v[236:239], v91, s[24:27], s46 offen offset:0
    v_cvt_pk_bf16_f32 v240, v188, v189
    v_cvt_pk_bf16_f32 v241, v190, v191
    v_cvt_pk_bf16_f32 v242, v192, v193
    v_cvt_pk_bf16_f32 v243, v194, v195
    buffer_store_dwordx4 v[240:243], v91, s[24:27], s46 offen offset:512
    s_nop 1
    s_endpgm
.e1epiV_13:
    s_lshl_b32 s39, s36, 8
    s_lshl_b32 s40, s55, 7
    s_add_u32 s39, s39, s40
    s_add_u32 s39, s39, 148480
    v_add_u32 v3, s39, v88
    ds_read_b32 v80, v3
    s_lshl_b32 s39, s36, 8
    s_lshl_b32 s40, s56, 7
    s_add_u32 s39, s39, s40
    s_add_u32 s39, s39, 148480
    v_add_u32 v3, s39, v88
    ds_read_b32 v81, v3
    s_mul_i32 s39, s32, 8
    s_lshl_b32 s40, s35, 1
    s_add_u32 s39, s39, s40
    s_add_u32 s39, s39, s53
    s_mul_i32 s46, s39, 3072
    s_waitcnt lgkmcnt(0)
    v_pk_mul_f32 v[246:247], v[48:49], v[80:81] op_sel:[0,0] op_sel_hi:[1,0]
    v_pk_fma_f32 v[132:133], v[132:133], v[16:17], v[246:247] neg_lo:[0,0,1] neg_hi:[0,0,1]
    v_pk_mul_f32 v[248:249], v[50:51], v[80:81] op_sel:[0,0] op_sel_hi:[1,0]
    v_pk_fma_f32 v[134:135], v[134:135], v[18:19], v[248:249] neg_lo:[0,0,1] neg_hi:[0,0,1]
    v_pk_mul_f32 v[246:247], v[52:53], v[80:81] op_sel:[0,0] op_sel_hi:[1,0]
    v_pk_fma_f32 v[136:137], v[136:137], v[20:21], v[246:247] neg_lo:[0,0,1] neg_hi:[0,0,1]
    v_pk_mul_f32 v[248:249], v[54:55], v[80:81] op_sel:[0,0] op_sel_hi:[1,0]
    v_pk_fma_f32 v[138:139], v[138:139], v[22:23], v[248:249] neg_lo:[0,0,1] neg_hi:[0,0,1]
    v_pk_mul_f32 v[246:247], v[56:57], v[80:81] op_sel:[0,0] op_sel_hi:[1,0]
    v_pk_fma_f32 v[140:141], v[140:141], v[24:25], v[246:247] neg_lo:[0,0,1] neg_hi:[0,0,1]
    v_pk_mul_f32 v[248:249], v[58:59], v[80:81] op_sel:[0,0] op_sel_hi:[1,0]
    v_pk_fma_f32 v[142:143], v[142:143], v[26:27], v[248:249] neg_lo:[0,0,1] neg_hi:[0,0,1]
    v_pk_mul_f32 v[246:247], v[60:61], v[80:81] op_sel:[0,0] op_sel_hi:[1,0]
    v_pk_fma_f32 v[144:145], v[144:145], v[28:29], v[246:247] neg_lo:[0,0,1] neg_hi:[0,0,1]
    v_pk_mul_f32 v[248:249], v[62:63], v[80:81] op_sel:[0,0] op_sel_hi:[1,0]
    v_pk_fma_f32 v[146:147], v[146:147], v[30:31], v[248:249] neg_lo:[0,0,1] neg_hi:[0,0,1]
    v_cvt_pk_bf16_f32 v236, v132, v133
    v_cvt_pk_bf16_f32 v237, v134, v135
    v_cvt_pk_bf16_f32 v238, v136, v137
    v_cvt_pk_bf16_f32 v239, v138, v139
    buffer_store_dwordx4 v[236:239], v90, s[24:27], s46 offen offset:0
    v_cvt_pk_bf16_f32 v240, v140, v141
    v_cvt_pk_bf16_f32 v241, v142, v143
    v_cvt_pk_bf16_f32 v242, v144, v145
    v_cvt_pk_bf16_f32 v243, v146, v147
    buffer_store_dwordx4 v[240:243], v90, s[24:27], s46 offen offset:768
    s_nop 1
    v_pk_mul_f32 v[246:247], v[48:49], v[80:81] op_sel:[0,1] op_sel_hi:[1,1]
    v_pk_fma_f32 v[164:165], v[164:165], v[16:17], v[246:247] neg_lo:[0,0,1] neg_hi:[0,0,1]
    v_pk_mul_f32 v[248:249], v[50:51], v[80:81] op_sel:[0,1] op_sel_hi:[1,1]
    v_pk_fma_f32 v[166:167], v[166:167], v[18:19], v[248:249] neg_lo:[0,0,1] neg_hi:[0,0,1]
    v_pk_mul_f32 v[246:247], v[52:53], v[80:81] op_sel:[0,1] op_sel_hi:[1,1]
    v_pk_fma_f32 v[168:169], v[168:169], v[20:21], v[246:247] neg_lo:[0,0,1] neg_hi:[0,0,1]
    v_pk_mul_f32 v[248:249], v[54:55], v[80:81] op_sel:[0,1] op_sel_hi:[1,1]
    v_pk_fma_f32 v[170:171], v[170:171], v[22:23], v[248:249] neg_lo:[0,0,1] neg_hi:[0,0,1]
    v_pk_mul_f32 v[246:247], v[56:57], v[80:81] op_sel:[0,1] op_sel_hi:[1,1]
    v_pk_fma_f32 v[172:173], v[172:173], v[24:25], v[246:247] neg_lo:[0,0,1] neg_hi:[0,0,1]
    v_pk_mul_f32 v[248:249], v[58:59], v[80:81] op_sel:[0,1] op_sel_hi:[1,1]
    v_pk_fma_f32 v[174:175], v[174:175], v[26:27], v[248:249] neg_lo:[0,0,1] neg_hi:[0,0,1]
    v_pk_mul_f32 v[246:247], v[60:61], v[80:81] op_sel:[0,1] op_sel_hi:[1,1]
    v_pk_fma_f32 v[176:177], v[176:177], v[28:29], v[246:247] neg_lo:[0,0,1] neg_hi:[0,0,1]
    v_pk_mul_f32 v[248:249], v[62:63], v[80:81] op_sel:[0,1] op_sel_hi:[1,1]
    v_pk_fma_f32 v[178:179], v[178:179], v[30:31], v[248:249] neg_lo:[0,0,1] neg_hi:[0,0,1]
    v_cvt_pk_bf16_f32 v236, v164, v165
    v_cvt_pk_bf16_f32 v237, v166, v167
    v_cvt_pk_bf16_f32 v238, v168, v169
    v_cvt_pk_bf16_f32 v239, v170, v171
    buffer_store_dwordx4 v[236:239], v91, s[24:27], s46 offen offset:0
    v_cvt_pk_bf16_f32 v240, v172, v173
    v_cvt_pk_bf16_f32 v241, v174, v175
    v_cvt_pk_bf16_f32 v242, v176, v177
    v_cvt_pk_bf16_f32 v243, v178, v179
    buffer_store_dwordx4 v[240:243], v91, s[24:27], s46 offen offset:768
    s_nop 1
    s_mul_i32 s39, s32, 8
    s_lshl_b32 s40, s35, 1
    s_add_u32 s39, s39, s40
    s_add_u32 s39, s39, s54
    s_mul_i32 s46, s39, 3072
    v_pk_mul_f32 v[246:247], v[64:65], v[80:81] op_sel:[0,0] op_sel_hi:[1,0]
    v_pk_fma_f32 v[148:149], v[148:149], v[32:33], v[246:247] neg_lo:[0,0,1] neg_hi:[0,0,1]
    v_pk_mul_f32 v[248:249], v[66:67], v[80:81] op_sel:[0,0] op_sel_hi:[1,0]
    v_pk_fma_f32 v[150:151], v[150:151], v[34:35], v[248:249] neg_lo:[0,0,1] neg_hi:[0,0,1]
    v_pk_mul_f32 v[246:247], v[68:69], v[80:81] op_sel:[0,0] op_sel_hi:[1,0]
    v_pk_fma_f32 v[152:153], v[152:153], v[36:37], v[246:247] neg_lo:[0,0,1] neg_hi:[0,0,1]
    v_pk_mul_f32 v[248:249], v[70:71], v[80:81] op_sel:[0,0] op_sel_hi:[1,0]
    v_pk_fma_f32 v[154:155], v[154:155], v[38:39], v[248:249] neg_lo:[0,0,1] neg_hi:[0,0,1]
    v_pk_mul_f32 v[246:247], v[72:73], v[80:81] op_sel:[0,0] op_sel_hi:[1,0]
    v_pk_fma_f32 v[156:157], v[156:157], v[40:41], v[246:247] neg_lo:[0,0,1] neg_hi:[0,0,1]
    v_pk_mul_f32 v[248:249], v[74:75], v[80:81] op_sel:[0,0] op_sel_hi:[1,0]
    v_pk_fma_f32 v[158:159], v[158:159], v[42:43], v[248:249] neg_lo:[0,0,1] neg_hi:[0,0,1]
    v_pk_mul_f32 v[246:247], v[76:77], v[80:81] op_sel:[0,0] op_sel_hi:[1,0]
    v_pk_fma_f32 v[160:161], v[160:161], v[44:45], v[246:247] neg_lo:[0,0,1] neg_hi:[0,0,1]
    v_pk_mul_f32 v[248:249], v[78:79], v[80:81] op_sel:[0,0] op_sel_hi:[1,0]
    v_pk_fma_f32 v[162:163], v[162:163], v[46:47], v[248:249] neg_lo:[0,0,1] neg_hi:[0,0,1]
    v_cvt_pk_bf16_f32 v236, v148, v149
    v_cvt_pk_bf16_f32 v237, v150, v151
    v_cvt_pk_bf16_f32 v238, v152, v153
    v_cvt_pk_bf16_f32 v239, v154, v155
    buffer_store_dwordx4 v[236:239], v90, s[24:27], s46 offen offset:0
    v_cvt_pk_bf16_f32 v240, v156, v157
    v_cvt_pk_bf16_f32 v241, v158, v159
    v_cvt_pk_bf16_f32 v242, v160, v161
    v_cvt_pk_bf16_f32 v243, v162, v163
    buffer_store_dwordx4 v[240:243], v90, s[24:27], s46 offen offset:768
    s_nop 1
    v_pk_mul_f32 v[246:247], v[64:65], v[80:81] op_sel:[0,1] op_sel_hi:[1,1]
    v_pk_fma_f32 v[180:181], v[180:181], v[32:33], v[246:247] neg_lo:[0,0,1] neg_hi:[0,0,1]
    v_pk_mul_f32 v[248:249], v[66:67], v[80:81] op_sel:[0,1] op_sel_hi:[1,1]
    v_pk_fma_f32 v[182:183], v[182:183], v[34:35], v[248:249] neg_lo:[0,0,1] neg_hi:[0,0,1]
    v_pk_mul_f32 v[246:247], v[68:69], v[80:81] op_sel:[0,1] op_sel_hi:[1,1]
    v_pk_fma_f32 v[184:185], v[184:185], v[36:37], v[246:247] neg_lo:[0,0,1] neg_hi:[0,0,1]
    v_pk_mul_f32 v[248:249], v[70:71], v[80:81] op_sel:[0,1] op_sel_hi:[1,1]
    v_pk_fma_f32 v[186:187], v[186:187], v[38:39], v[248:249] neg_lo:[0,0,1] neg_hi:[0,0,1]
    v_pk_mul_f32 v[246:247], v[72:73], v[80:81] op_sel:[0,1] op_sel_hi:[1,1]
    v_pk_fma_f32 v[188:189], v[188:189], v[40:41], v[246:247] neg_lo:[0,0,1] neg_hi:[0,0,1]
    v_pk_mul_f32 v[248:249], v[74:75], v[80:81] op_sel:[0,1] op_sel_hi:[1,1]
    v_pk_fma_f32 v[190:191], v[190:191], v[42:43], v[248:249] neg_lo:[0,0,1] neg_hi:[0,0,1]
    v_pk_mul_f32 v[246:247], v[76:77], v[80:81] op_sel:[0,1] op_sel_hi:[1,1]
    v_pk_fma_f32 v[192:193], v[192:193], v[44:45], v[246:247] neg_lo:[0,0,1] neg_hi:[0,0,1]
    v_pk_mul_f32 v[248:249], v[78:79], v[80:81] op_sel:[0,1] op_sel_hi:[1,1]
    v_pk_fma_f32 v[194:195], v[194:195], v[46:47], v[248:249] neg_lo:[0,0,1] neg_hi:[0,0,1]
    v_cvt_pk_bf16_f32 v236, v180, v181
    v_cvt_pk_bf16_f32 v237, v182, v183
    v_cvt_pk_bf16_f32 v238, v184, v185
    v_cvt_pk_bf16_f32 v239, v186, v187
    buffer_store_dwordx4 v[236:239], v91, s[24:27], s46 offen offset:0
    v_cvt_pk_bf16_f32 v240, v188, v189
    v_cvt_pk_bf16_f32 v241, v190, v191
    v_cvt_pk_bf16_f32 v242, v192, v193
    v_cvt_pk_bf16_f32 v243, v194, v195
    buffer_store_dwordx4 v[240:243], v91, s[24:27], s46 offen offset:768
    s_nop 1
    s_endpgm
.k1st_2:
    s_mov_b32 s32, s2
    s_load_dwordx2 s[4:5], s[0:1], 0
    s_load_dwordx2 s[12:13], s[0:1], 80
    s_load_dwordx2 s[14:15], s[0:1], 72
    v_and_b32 v1, 63, v0
    v_lshrrev_b32 v2, 6, v0
    s_nop 0
    v_readfirstlane_b32 s40, v2
    s_nop 3
    s_mul_i32 s43, s32, 64
    s_mul_i32 s44, s40, 8
    s_add_u32 s43, s43, s44
    v_lshrrev_b32 v2, 4, v1
    v_add_u32 v2, s43, v2
    v_mul_u32_u24 v3, 1280, v2
    v_and_b32 v4, 15, v1
    v_lshlrev_b32 v4, 4, v4
    v_add_u32 v6, v3, v4
    s_waitcnt lgkmcnt(0)
    s_mov_b32 s16, s4
    s_mov_b32 s17, s5
    s_mov_b32 s18, 2621440
    s_mov_b32 s19, 0x00020000
    s_mov_b32 s44, 0
    buffer_load_dwordx4 v[16:19], v6, s[16:19], s44 offen offset:0
    buffer_load_dwordx4 v[20:23], v6, s[16:19], s44 offen offset:256
    buffer_load_dwordx4 v[24:27], v6, s[16:19], s44 offen offset:512
    buffer_load_dwordx4 v[28:31], v6, s[16:19], s44 offen offset:768
    buffer_load_dwordx4 v[32:35], v6, s[16:19], s44 offen offset:1024
    s_mov_b32 s44, 5120
    buffer_load_dwordx4 v[36:39], v6, s[16:19], s44 offen offset:0
    buffer_load_dwordx4 v[40:43], v6, s[16:19], s44 offen offset:256
    buffer_load_dwordx4 v[44:47], v6, s[16:19], s44 offen offset:512
    buffer_load_dwordx4 v[48:51], v6, s[16:19], s44 offen offset:768
    buffer_load_dwordx4 v[52:55], v6, s[16:19], s44 offen offset:1024
    s_add_u32 s20, s12, 3145728
    s_addc_u32 s21, s13, 0
    s_mov_b32 s22, 6291456
    s_mov_b32 s23, 0x00020000
    s_add_u32 s24, s12, 28311552
    s_addc_u32 s25, s13, 0
    s_mov_b32 s26, 16384
    s_mov_b32 s27, 0x00020000
    s_mov_b32 s28, s14
    s_mov_b32 s29, s15
    s_mov_b32 s30, 256
    s_mov_b32 s31, 0x00020000
    s_cmp_lg_u32 s32, 0
    s_cbranch_scc1 .nozero_26
    s_add_u32 s48, s12, 28377088
    s_addc_u32 s49, s13, 0
    s_mov_b32 s50, 16384
    s_mov_b32 s51, 0x00020000
    v_lshlrev_b32 v3, 8, v0
    v_mov_b32 v4, 0
    v_cmp_gt_u32 vcc, 48, v0
    s_and_saveexec_b64 s[46:47], vcc
    buffer_store_dword v4, v3, s[48:51], 0 offen
    s_mov_b64 exec, s[46:47]
    s_waitcnt vmcnt(0)
.nozero_26:
    v_mov_b32 v8, 0x3f803f80
    v_mov_b32 v9, 0x3f803f80
    v_mov_b32 v10, 0x3f803f80
    v_mov_b32 v11, 0x3f803f80
    s_mul_i32 s43, s32, 256
    v_add_u32 v3, s43, v0
    v_lshrrev_b32 v4, 2, v3
    v_mul_u32_u24 v4, 3072, v4
    v_and_b32 v5, 3, v3
    v_mul_u32_u24 v5, 384, v5
    v_add_u32 v4, v4, v5
    v_add_u32 v4, 1856, v4
    v_cmp_gt_u32 vcc, 256, v0
    s_and_saveexec_b64 s[46:47], vcc
    buffer_store_dwordx4 v[8:11], v4, s[20:23], 0 offen
    v_add_u32 v4, 393216, v4
    s_mov_b64 exec, s[46:47]
    s_mov_b32 s45, 0x3f803f80
    s_waitcnt vmcnt(6)
    v_mov_b32 v12, 0
    v_mov_b32 v14, 0
    v_dot2c_f32_bf16 v12, s45, v16
    v_dot2c_f32_bf16 v14, v16, v16
    v_dot2c_f32_bf16 v12, s45, v17
    v_dot2c_f32_bf16 v14, v17, v17
    v_dot2c_f32_bf16 v12, s45, v18
    v_dot2c_f32_bf16 v14, v18, v18
    v_dot2c_f32_bf16 v12, s45, v19
    v_dot2c_f32_bf16 v14, v19, v19
    v_dot2c_f32_bf16 v12, s45, v20
    v_dot2c_f32_bf16 v14, v20, v20
    v_dot2c_f32_bf16 v12, s45, v21
    v_dot2c_f32_bf16 v14, v21, v21
    v_dot2c_f32_bf16 v12, s45, v22
    v_dot2c_f32_bf16 v14, v22, v22
    v_dot2c_f32_bf16 v12, s45, v23
    v_dot2c_f32_bf16 v14, v23, v23
    v_dot2c_f32_bf16 v12, s45, v24
    v_dot2c_f32_bf16 v14, v24, v24
    v_dot2c_f32_bf16 v12, s45, v25
    v_dot2c_f32_bf16 v14, v25, v25
    v_dot2c_f32_bf16 v12, s45, v26
    v_dot2c_f32_bf16 v14, v26, v26
    v_dot2c_f32_bf16 v12, s45, v27
    v_dot2c_f32_bf16 v14, v27, v27
    v_dot2c_f32_bf16 v12, s45, v28
    v_dot2c_f32_bf16 v14, v28, v28
    v_dot2c_f32_bf16 v12, s45, v29
    v_dot2c_f32_bf16 v14, v29, v29
    v_dot2c_f32_bf16 v12, s45, v30
    v_dot2c_f32_bf16 v14, v30, v30
    v_dot2c_f32_bf16 v12, s45, v31
    v_dot2c_f32_bf16 v14, v31, v31
    v_dot2c_f32_bf16 v12, s45, v32
    v_dot2c_f32_bf16 v14, v32, v32
    v_dot2c_f32_bf16 v12, s45, v33
    v_dot2c_f32_bf16 v14, v33, v33
    v_dot2c_f32_bf16 v12, s45, v34
    v_dot2c_f32_bf16 v14, v34, v34
    v_dot2c_f32_bf16 v12, s45, v35
    v_dot2c_f32_bf16 v14, v35, v35
    s_waitcnt vmcnt(1)
    v_mov_b32 v13, 0
    v_mov_b32 v15, 0
    v_dot2c_f32_bf16 v13, s45, v36
    v_dot2c_f32_bf16 v15, v36, v36
    v_dot2c_f32_bf16 v13, s45, v37
    v_dot2c_f32_bf16 v15, v37, v37
    v_dot2c_f32_bf16 v13, s45, v38
    v_dot2c_f32_bf16 v15, v38, v38
    v_dot2c_f32_bf16 v13, s45, v39
    v_dot2c_f32_bf16 v15, v39, v39
    v_dot2c_f32_bf16 v13, s45, v40
    v_dot2c_f32_bf16 v15, v40, v40
    v_dot2c_f32_bf16 v13, s45, v41
    v_dot2c_f32_bf16 v15, v41, v41
    v_dot2c_f32_bf16 v13, s45, v42
    v_dot2c_f32_bf16 v15, v42, v42
    v_dot2c_f32_bf16 v13, s45, v43
    v_dot2c_f32_bf16 v15, v43, v43
    v_dot2c_f32_bf16 v13, s45, v44
    v_dot2c_f32_bf16 v15, v44, v44
    v_dot2c_f32_bf16 v13, s45, v45
    v_dot2c_f32_bf16 v15, v45, v45
    v_dot2c_f32_bf16 v13, s45, v46
    v_dot2c_f32_bf16 v15, v46, v46
    v_dot2c_f32_bf16 v13, s45, v47
    v_dot2c_f32_bf16 v15, v47, v47
    v_dot2c_f32_bf16 v13, s45, v48
    v_dot2c_f32_bf16 v15, v48, v48
    v_dot2c_f32_bf16 v13, s45, v49
    v_dot2c_f32_bf16 v15, v49, v49
    v_dot2c_f32_bf16 v13, s45, v50
    v_dot2c_f32_bf16 v15, v50, v50
    v_dot2c_f32_bf16 v13, s45, v51
    v_dot2c_f32_bf16 v15, v51, v51
    v_dot2c_f32_bf16 v13, s45, v52
    v_dot2c_f32_bf16 v15, v52, v52
    v_dot2c_f32_bf16 v13, s45, v53
    v_dot2c_f32_bf16 v15, v53, v53
    v_dot2c_f32_bf16 v13, s45, v54
    v_dot2c_f32_bf16 v15, v54, v54
    v_dot2c_f32_bf16 v13, s45, v55
    v_dot2c_f32_bf16 v15, v55, v55
    s_nop 2
    v_add_f32_dpp v12, v12, v12 row_ror:8 row_mask:0xf bank_mask:0xf
    v_add_f32_dpp v14, v14, v14 row_ror:8 row_mask:0xf bank_mask:0xf
    v_add_f32_dpp v13, v13, v13 row_ror:8 row_mask:0xf bank_mask:0xf
    v_add_f32_dpp v15, v15, v15 row_ror:8 row_mask:0xf bank_mask:0xf
    v_add_f32_dpp v12, v12, v12 row_ror:4 row_mask:0xf bank_mask:0xf
    v_add_f32_dpp v14, v14, v14 row_ror:4 row_mask:0xf bank_mask:0xf
    v_add_f32_dpp v13, v13, v13 row_ror:4 row_mask:0xf bank_mask:0xf
    v_add_f32_dpp v15, v15, v15 row_ror:4 row_mask:0xf bank_mask:0xf
    v_add_f32_dpp v12, v12, v12 row_ror:2 row_mask:0xf bank_mask:0xf
    v_add_f32_dpp v14, v14, v14 row_ror:2 row_mask:0xf bank_mask:0xf
    v_add_f32_dpp v13, v13, v13 row_ror:2 row_mask:0xf bank_mask:0xf
    v_add_f32_dpp v15, v15, v15 row_ror:2 row_mask:0xf bank_mask:0xf
    v_add_f32_dpp v12, v12, v12 row_ror:1 row_mask:0xf bank_mask:0xf
    v_add_f32_dpp v14, v14, v14 row_ror:1 row_mask:0xf bank_mask:0xf
    v_add_f32_dpp v13, v13, v13 row_ror:1 row_mask:0xf bank_mask:0xf
    v_add_f32_dpp v15, v15, v15 row_ror:1 row_mask:0xf bank_mask:0xf
    v_mul_f32 v12, 0x3acccccd, v12
    v_mul_f32 v14, 0x3acccccd, v14
    v_mul_f32 v13, 0x3acccccd, v13
    v_mul_f32 v15, 0x3acccccd, v15
    v_fma_f32 v14, -v12, v12, v14
    v_fma_f32 v15, -v13, v13, v15
    v_max_f32 v14, 0, v14
    v_max_f32 v15, 0, v15
    v_add_f32 v14, 0x3727c5ac, v14
    v_add_f32 v15, 0x3727c5ac, v15
    v_rsq_f32 v14, v14
    v_rsq_f32 v15, v15
    s_nop 0
    v_mul_f32 v12, v12, v14
    v_mul_f32 v13, v13, v15
    v_lshlrev_b32 v2, 2, v2
    v_add_u32 v3, 8192, v2
    v_and_b32 v4, 15, v1
    v_cmp_eq_u32 vcc, 0, v4
    s_and_saveexec_b64 s[46:47], vcc
    buffer_store_dword v14, v2, s[24:27], 0 offen offset:0 sc1
    buffer_store_dword v12, v3, s[24:27], 0 offen offset:0 sc1
    buffer_store_dword v15, v2, s[24:27], 0 offen offset:16 sc1
    buffer_store_dword v13, v3, s[24:27], 0 offen offset:16 sc1
    s_mov_b64 exec, s[46:47]
    s_waitcnt vmcnt(0)
    s_barrier
    s_mul_i32 s43, s32, 64
    s_lshr_b32 s43, s43, 7
    s_lshl_b32 s43, s43, 2
    v_lshlrev_b32 v2, 2, v0
    v_add_u32 v2, s43, v2
    v_mov_b32 v3, 1
    v_cmp_gt_u32 vcc, 1, v0
    s_and_saveexec_b64 s[46:47], vcc
    buffer_atomic_add v3, v2, s[28:31], 0 offen
    s_mov_b64 exec, s[46:47]
    s_endpgm
.k1pr_3:
    s_sub_u32 s32, s2, 248
    s_load_dwordx2 s[4:5], s[0:1], 16
    s_load_dwordx2 s[6:7], s[0:1], 48
    s_load_dwordx2 s[12:13], s[0:1], 80
    v_and_b32 v1, 63, v0
    v_lshrrev_b32 v2, 6, v0
    s_nop 0
    v_readfirstlane_b32 s40, v2
    v_add_u32 v2, 0, v1
    v_mul_u32_u24 v3, 6554, v2
    v_lshrrev_b32 v3, 16, v3
    v_mul_u32_u24 v4, 10, v3
    v_sub_u32 v2, v2, v4
    v_lshlrev_b32 v2, 4, v2
    v_bfe_u32 v4, v3, 3, 1
    v_mul_u32_u24 v6, 20, v4
    v_lshlrev_b32 v16, 4, v4
    v_bfe_u32 v4, v3, 2, 1
    v_lshlrev_b32 v4, 2, v4
    v_and_b32 v5, 3, v3
    v_add_u32 v4, v4, v5
    v_lshrrev_b32 v5, 4, v3
    v_lshlrev_b32 v5, 3, v5
    v_add_u32 v4, v4, v5
    v_add_u32 v6, v6, v4
    v_add_u32 v16, v16, v4
    v_bfe_u32 v4, v3, 2, 2
    v_mul_u32_u24 v11, 40, v4
    v_lshrrev_b32 v5, 4, v3
    v_mul_u32_u24 v5, 20, v5
    v_and_b32 v4, 3, v3
    v_add3_u32 v11, v11, v5, v4
    v_add_u32 v11, 16, v11
    v_mul_u32_u24 v6, 1280, v6
    v_add_u32 v6, v6, v2
    v_mul_u32_u24 v11, 1280, v11
    v_add_u32 v11, v11, v2
    v_mul_u32_u24 v16, 1280, v16
    v_add_u32 v16, v16, v2
    v_add_u32 v2, 64, v1
    v_mul_u32_u24 v3, 6554, v2
    v_lshrrev_b32 v3, 16, v3
    v_mul_u32_u24 v4, 10, v3
    v_sub_u32 v2, v2, v4
    v_lshlrev_b32 v2, 4, v2
    v_bfe_u32 v4, v3, 3, 1
    v_mul_u32_u24 v7, 20, v4
    v_lshlrev_b32 v17, 4, v4
    v_bfe_u32 v4, v3, 2, 1
    v_lshlrev_b32 v4, 2, v4
    v_and_b32 v5, 3, v3
    v_add_u32 v4, v4, v5
    v_lshrrev_b32 v5, 4, v3
    v_lshlrev_b32 v5, 3, v5
    v_add_u32 v4, v4, v5
    v_add_u32 v7, v7, v4
    v_add_u32 v17, v17, v4
    v_bfe_u32 v4, v3, 2, 2
    v_mul_u32_u24 v12, 40, v4
    v_lshrrev_b32 v5, 4, v3
    v_mul_u32_u24 v5, 20, v5
    v_and_b32 v4, 3, v3
    v_add3_u32 v12, v12, v5, v4
    v_add_u32 v12, 16, v12
    v_mul_u32_u24 v7, 1280, v7
    v_add_u32 v7, v7, v2
    v_mul_u32_u24 v12, 1280, v12
    v_add_u32 v12, v12, v2
    v_mul_u32_u24 v17, 1280, v17
    v_add_u32 v17, v17, v2
    v_add_u32 v2, 128, v1
    v_mul_u32_u24 v3, 6554, v2
    v_lshrrev_b32 v3, 16, v3
    v_mul_u32_u24 v4, 10, v3
    v_sub_u32 v2, v2, v4
    v_lshlrev_b32 v2, 4, v2
    v_bfe_u32 v4, v3, 3, 1
    v_mul_u32_u24 v8, 20, v4
    v_lshlrev_b32 v18, 4, v4
    v_bfe_u32 v4, v3, 2, 1
    v_lshlrev_b32 v4, 2, v4
    v_and_b32 v5, 3, v3
    v_add_u32 v4, v4, v5
    v_lshrrev_b32 v5, 4, v3
    v_lshlrev_b32 v5, 3, v5
    v_add_u32 v4, v4, v5
    v_add_u32 v8, v8, v4
    v_add_u32 v18, v18, v4
    v_bfe_u32 v4, v3, 2, 2
    v_mul_u32_u24 v13, 40, v4
    v_lshrrev_b32 v5, 4, v3
    v_mul_u32_u24 v5, 20, v5
    v_and_b32 v4, 3, v3
    v_add3_u32 v13, v13, v5, v4
    v_add_u32 v13, 16, v13
    v_mul_u32_u24 v8, 1280, v8
    v_add_u32 v8, v8, v2
    v_mul_u32_u24 v13, 1280, v13
    v_add_u32 v13, v13, v2
    v_mul_u32_u24 v18, 1280, v18
    v_add_u32 v18, v18, v2
    v_add_u32 v2, 192, v1
    v_mul_u32_u24 v3, 6554, v2
    v_lshrrev_b32 v3, 16, v3
    v_mul_u32_u24 v4, 10, v3
    v_sub_u32 v2, v2, v4
    v_lshlrev_b32 v2, 4, v2
    v_bfe_u32 v4, v3, 3, 1
    v_mul_u32_u24 v9, 20, v4
    v_lshlrev_b32 v19, 4, v4
    v_bfe_u32 v4, v3, 2, 1
    v_lshlrev_b32 v4, 2, v4
    v_and_b32 v5, 3, v3
    v_add_u32 v4, v4, v5
    v_lshrrev_b32 v5, 4, v3
    v_lshlrev_b32 v5, 3, v5
    v_add_u32 v4, v4, v5
    v_add_u32 v9, v9, v4
    v_add_u32 v19, v19, v4
    v_bfe_u32 v4, v3, 2, 2
    v_mul_u32_u24 v14, 40, v4
    v_lshrrev_b32 v5, 4, v3
    v_mul_u32_u24 v5, 20, v5
    v_and_b32 v4, 3, v3
    v_add3_u32 v14, v14, v5, v4
    v_add_u32 v14, 16, v14
    v_mul_u32_u24 v9, 1280, v9
    v_add_u32 v9, v9, v2
    v_mul_u32_u24 v14, 1280, v14
    v_add_u32 v14, v14, v2
    v_mul_u32_u24 v19, 1280, v19
    v_add_u32 v19, v19, v2
    v_add_u32 v2, 256, v1
    v_mul_u32_u24 v3, 6554, v2
    v_lshrrev_b32 v3, 16, v3
    v_mul_u32_u24 v4, 10, v3
    v_sub_u32 v2, v2, v4
    v_lshlrev_b32 v2, 4, v2
    v_bfe_u32 v4, v3, 3, 1
    v_mul_u32_u24 v10, 20, v4
    v_lshlrev_b32 v20, 4, v4
    v_bfe_u32 v4, v3, 2, 1
    v_lshlrev_b32 v4, 2, v4
    v_and_b32 v5, 3, v3
    v_add_u32 v4, v4, v5
    v_lshrrev_b32 v5, 4, v3
    v_lshlrev_b32 v5, 3, v5
    v_add_u32 v4, v4, v5
    v_add_u32 v10, v10, v4
    v_add_u32 v20, v20, v4
    v_bfe_u32 v4, v3, 2, 2
    v_mul_u32_u24 v15, 40, v4
    v_lshrrev_b32 v5, 4, v3
    v_mul_u32_u24 v5, 20, v5
    v_and_b32 v4, 3, v3
    v_add3_u32 v15, v15, v5, v4
    v_add_u32 v15, 16, v15
    v_mul_u32_u24 v10, 1280, v10
    v_add_u32 v10, v10, v2
    v_mul_u32_u24 v15, 1280, v15
    v_add_u32 v15, v15, v2
    v_mul_u32_u24 v20, 1280, v20
    v_add_u32 v20, v20, v2
    v_lshrrev_b32 v2, 4, v1
    v_lshlrev_b32 v2, 2, v2
    v_bfe_u32 v3, v1, 2, 2
    v_add_u32 v2, v2, v3
    v_mul_u32_u24 v2, 160, v2
    v_and_b32 v3, 3, v1
    v_lshlrev_b32 v3, 3, v3
    v_add_u32 v2, v2, v3
    s_mul_i32 s45, s40, 15360
    v_add_u32 v26, s45, v2
    v_lshlrev_b32 v27, 4, v1
    v_add_u32 v28, 4096, v27
    s_waitcnt lgkmcnt(0)
    s_mov_b32 s20, s4
    s_mov_b32 s21, s5
    s_mov_b32 s22, 819200
    s_mov_b32 s23, 0x00020000
    s_mov_b32 s24, s6
    s_mov_b32 s25, s7
    s_mov_b32 s26, 1966080
    s_mov_b32 s27, 0x00020000
    s_add_u32 s28, s12, 25165824
    s_addc_u32 s29, s13, 0
    s_mov_b32 s30, 2916352
    s_mov_b32 s31, 0x00020000
    s_mul_i32 s41, s32, 8
    s_add_u32 s41, s41, s40
    s_add_u32 s41, s41, 384
    s_add_u32 s42, s41, 0
    s_min_u32 s42, s42, 543
    s_cmp_ge_u32 s42, 384
    s_cbranch_scc1 .pwo_27
    s_mul_i32 s48, s42, 1366
    s_lshr_b32 s48, s48, 16
    s_mul_i32 s43, s48, 48
    s_sub_u32 s49, s42, s43
    s_mul_i32 s46, s49, 40960
    v_mov_b32 v21, v16
    v_mov_b32 v22, v17
    v_mov_b32 v23, v18
    v_mov_b32 v24, v19
    v_mov_b32 v25, v20
    s_mov_b32 s36, s24
    s_mov_b32 s37, s25
    s_mov_b32 s38, s26
    s_mov_b32 s39, 0x00020000
    s_branch .pgo_28
.pwo_27:
    s_sub_u32 s44, s42, 384
    s_mul_i32 s48, s44, 3277
    s_lshr_b32 s48, s48, 16
    s_mul_i32 s43, s48, 20
    s_sub_u32 s49, s44, s43
    s_mul_i32 s46, s49, 51200
    s_sub_u32 s43, s49, 16
    s_mul_i32 s43, s43, 204800
    s_cmp_ge_u32 s49, 16
    s_cselect_b32 s46, s43, s46
    s_cselect_b64 vcc, -1, 0
    v_cndmask_b32 v21, v6, v11, vcc
    v_cndmask_b32 v22, v7, v12, vcc
    v_cndmask_b32 v23, v8, v13, vcc
    v_cndmask_b32 v24, v9, v14, vcc
    v_cndmask_b32 v25, v10, v15, vcc
    s_mov_b32 s36, s20
    s_mov_b32 s37, s21
    s_mov_b32 s38, s22
    s_mov_b32 s39, 0x00020000
.pgo_28:
    s_mul_i32 s43, s48, 160
    s_add_u32 s46, s46, s43
    s_add_u32 m0, s45, 0
    s_nop 0
    buffer_load_dwordx4 v21, s[36:39], s46 offen lds
    s_add_u32 m0, m0, 1024
    s_nop 0
    buffer_load_dwordx4 v22, s[36:39], s46 offen lds
    s_add_u32 m0, m0, 1024
    s_nop 0
    buffer_load_dwordx4 v23, s[36:39], s46 offen lds
    s_add_u32 m0, m0, 1024
    s_nop 0
    buffer_load_dwordx4 v24, s[36:39], s46 offen lds
    s_add_u32 m0, m0, 1024
    s_nop 0
    buffer_load_dwordx4 v25, s[36:39], s46 offen lds
    s_add_u32 s42, s41, 64
    s_min_u32 s42, s42, 543
    s_cmp_ge_u32 s42, 384
    s_cbranch_scc1 .pwo_29
    s_mul_i32 s48, s42, 1366
    s_lshr_b32 s48, s48, 16
    s_mul_i32 s43, s48, 48
    s_sub_u32 s49, s42, s43
    s_mul_i32 s46, s49, 40960
    v_mov_b32 v21, v16
    v_mov_b32 v22, v17
    v_mov_b32 v23, v18
    v_mov_b32 v24, v19
    v_mov_b32 v25, v20
    s_mov_b32 s36, s24
    s_mov_b32 s37, s25
    s_mov_b32 s38, s26
    s_mov_b32 s39, 0x00020000
    s_branch .pgo_30
.pwo_29:
    s_sub_u32 s44, s42, 384
    s_mul_i32 s48, s44, 3277
    s_lshr_b32 s48, s48, 16
    s_mul_i32 s43, s48, 20
    s_sub_u32 s49, s44, s43
    s_mul_i32 s46, s49, 51200
    s_sub_u32 s43, s49, 16
    s_mul_i32 s43, s43, 204800
    s_cmp_ge_u32 s49, 16
    s_cselect_b32 s46, s43, s46
    s_cselect_b64 vcc, -1, 0
    v_cndmask_b32 v21, v6, v11, vcc
    v_cndmask_b32 v22, v7, v12, vcc
    v_cndmask_b32 v23, v8, v13, vcc
    v_cndmask_b32 v24, v9, v14, vcc
    v_cndmask_b32 v25, v10, v15, vcc
    s_mov_b32 s36, s20
    s_mov_b32 s37, s21
    s_mov_b32 s38, s22
    s_mov_b32 s39, 0x00020000
.pgo_30:
    s_mul_i32 s43, s48, 160
    s_add_u32 s46, s46, s43
    s_add_u32 m0, s45, 5120
    s_nop 0
    buffer_load_dwordx4 v21, s[36:39], s46 offen lds
    s_add_u32 m0, m0, 1024
    s_nop 0
    buffer_load_dwordx4 v22, s[36:39], s46 offen lds
    s_add_u32 m0, m0, 1024
    s_nop 0
    buffer_load_dwordx4 v23, s[36:39], s46 offen lds
    s_add_u32 m0, m0, 1024
    s_nop 0
    buffer_load_dwordx4 v24, s[36:39], s46 offen lds
    s_add_u32 m0, m0, 1024
    s_nop 0
    buffer_load_dwordx4 v25, s[36:39], s46 offen lds
    s_add_u32 s42, s41, 128
    s_min_u32 s42, s42, 543
    s_cmp_ge_u32 s42, 384
    s_cbranch_scc1 .pwo_31
    s_mul_i32 s48, s42, 1366
    s_lshr_b32 s48, s48, 16
    s_mul_i32 s43, s48, 48
    s_sub_u32 s49, s42, s43
    s_mul_i32 s46, s49, 40960
    v_mov_b32 v21, v16
    v_mov_b32 v22, v17
    v_mov_b32 v23, v18
    v_mov_b32 v24, v19
    v_mov_b32 v25, v20
    s_mov_b32 s36, s24
    s_mov_b32 s37, s25
    s_mov_b32 s38, s26
    s_mov_b32 s39, 0x00020000
    s_branch .pgo_32
.pwo_31:
    s_sub_u32 s44, s42, 384
    s_mul_i32 s48, s44, 3277
    s_lshr_b32 s48, s48, 16
    s_mul_i32 s43, s48, 20
    s_sub_u32 s49, s44, s43
    s_mul_i32 s46, s49, 51200
    s_sub_u32 s43, s49, 16
    s_mul_i32 s43, s43, 204800
    s_cmp_ge_u32 s49, 16
    s_cselect_b32 s46, s43, s46
    s_cselect_b64 vcc, -1, 0
    v_cndmask_b32 v21, v6, v11, vcc
    v_cndmask_b32 v22, v7, v12, vcc
    v_cndmask_b32 v23, v8, v13, vcc
    v_cndmask_b32 v24, v9, v14, vcc
    v_cndmask_b32 v25, v10, v15, vcc
    s_mov_b32 s36, s20
    s_mov_b32 s37, s21
    s_mov_b32 s38, s22
    s_mov_b32 s39, 0x00020000
.pgo_32:
    s_mul_i32 s43, s48, 160
    s_add_u32 s46, s46, s43
    s_add_u32 m0, s45, 10240
    s_nop 0
    buffer_load_dwordx4 v21, s[36:39], s46 offen lds
    s_add_u32 m0, m0, 1024
    s_nop 0
    buffer_load_dwordx4 v22, s[36:39], s46 offen lds
    s_add_u32 m0, m0, 1024
    s_nop 0
    buffer_load_dwordx4 v23, s[36:39], s46 offen lds
    s_add_u32 m0, m0, 1024
    s_nop 0
    buffer_load_dwordx4 v24, s[36:39], s46 offen lds
    s_add_u32 m0, m0, 1024
    s_nop 0
    buffer_load_dwordx4 v25, s[36:39], s46 offen lds
    s_waitcnt vmcnt(10)
    ds_read_b64_tr_b16 v[32:33], v26 offset:0
    ds_read_b64_tr_b16 v[34:35], v26 offset:2560
    ds_read_b64_tr_b16 v[36:37], v26 offset:32
    ds_read_b64_tr_b16 v[38:39], v26 offset:2592
    ds_read_b64_tr_b16 v[40:41], v26 offset:64
    ds_read_b64_tr_b16 v[42:43], v26 offset:2624
    ds_read_b64_tr_b16 v[44:45], v26 offset:96
    ds_read_b64_tr_b16 v[46:47], v26 offset:2656
    ds_read_b64_tr_b16 v[48:49], v26 offset:128
    ds_read_b64_tr_b16 v[50:51], v26 offset:2688
    s_add_u32 s42, s41, 0
    s_min_u32 s42, s42, 543
    s_mul_i32 s47, s42, 5120
    s_add_u32 s43, s47, 131072
    s_cmp_ge_u32 s42, 384
    s_cselect_b32 s47, s43, s47
    s_waitcnt lgkmcnt(0)
    buffer_store_dwordx4 v[32:35], v27, s[28:31], s47 offen offset:0
    buffer_store_dwordx4 v[36:39], v27, s[28:31], s47 offen offset:1024
    buffer_store_dwordx4 v[40:43], v27, s[28:31], s47 offen offset:2048
    buffer_store_dwordx4 v[44:47], v27, s[28:31], s47 offen offset:3072
    buffer_store_dwordx4 v[48:51], v28, s[28:31], s47 offen
    s_waitcnt vmcnt(10)
    ds_read_b64_tr_b16 v[52:53], v26 offset:5120
    ds_read_b64_tr_b16 v[54:55], v26 offset:7680
    ds_read_b64_tr_b16 v[56:57], v26 offset:5152
    ds_read_b64_tr_b16 v[58:59], v26 offset:7712
    ds_read_b64_tr_b16 v[60:61], v26 offset:5184
    ds_read_b64_tr_b16 v[62:63], v26 offset:7744
    ds_read_b64_tr_b16 v[64:65], v26 offset:5216
    ds_read_b64_tr_b16 v[66:67], v26 offset:7776
    ds_read_b64_tr_b16 v[68:69], v26 offset:5248
    ds_read_b64_tr_b16 v[70:71], v26 offset:7808
    s_add_u32 s42, s41, 64
    s_min_u32 s42, s42, 543
    s_mul_i32 s47, s42, 5120
    s_add_u32 s43, s47, 131072
    s_cmp_ge_u32 s42, 384
    s_cselect_b32 s47, s43, s47
    s_waitcnt lgkmcnt(0)
    buffer_store_dwordx4 v[52:55], v27, s[28:31], s47 offen offset:0
    buffer_store_dwordx4 v[56:59], v27, s[28:31], s47 offen offset:1024
    buffer_store_dwordx4 v[60:63], v27, s[28:31], s47 offen offset:2048
    buffer_store_dwordx4 v[64:67], v27, s[28:31], s47 offen offset:3072
    buffer_store_dwordx4 v[68:71], v28, s[28:31], s47 offen
    s_waitcnt vmcnt(10)
    ds_read_b64_tr_b16 v[32:33], v26 offset:10240
    ds_read_b64_tr_b16 v[34:35], v26 offset:12800
    ds_read_b64_tr_b16 v[36:37], v26 offset:10272
    ds_read_b64_tr_b16 v[38:39], v26 offset:12832
    ds_read_b64_tr_b16 v[40:41], v26 offset:10304
    ds_read_b64_tr_b16 v[42:43], v26 offset:12864
    ds_read_b64_tr_b16 v[44:45], v26 offset:10336
    ds_read_b64_tr_b16 v[46:47], v26 offset:12896
    ds_read_b64_tr_b16 v[48:49], v26 offset:10368
    ds_read_b64_tr_b16 v[50:51], v26 offset:12928
    s_add_u32 s42, s41, 128
    s_min_u32 s42, s42, 543
    s_mul_i32 s47, s42, 5120
    s_add_u32 s43, s47, 131072
    s_cmp_ge_u32 s42, 384
    s_cselect_b32 s47, s43, s47
    s_waitcnt lgkmcnt(0)
    buffer_store_dwordx4 v[32:35], v27, s[28:31], s47 offen offset:0
    buffer_store_dwordx4 v[36:39], v27, s[28:31], s47 offen offset:1024
    buffer_store_dwordx4 v[40:43], v27, s[28:31], s47 offen offset:2048
    buffer_store_dwordx4 v[44:47], v27, s[28:31], s47 offen offset:3072
    buffer_store_dwordx4 v[48:51], v28, s[28:31], s47 offen
    s_endpgm
.k1end_1:
    s_endpgm
.globl k2_kernel
.p2align 8
.type k2_kernel,@function
k2_kernel:
    s_cmp_ge_u32 s2, 768
    s_cbranch_scc1 .k2end_33
    s_cmp_ge_u32 s2, 512
    s_cbranch_scc1 .k2gemm_34
    s_and_b32 s33, s2, 7
    s_lshl_b32 s33, s33, 2
    s_lshr_b32 s32, s2, 7
    s_add_u32 s33, s33, s32
    s_lshr_b32 s32, s2, 3
    s_and_b32 s32, s32, 15
    s_load_dwordx2 s[4:5], s[0:1], 80
    v_and_b32 v1, 63, v0
    v_lshrrev_b32 v2, 6, v0
    s_nop 0
    v_readfirstlane_b32 s34, v2
    s_mov_b32 s44, 0
    s_mov_b32 s45, -1
    s_lshr_b32 s56, s2, 8
    s_and_b32 s56, s56, 1
    v_lshlrev_b32 v8, 4, v1
    s_mul_i32 s35, s33, 196608
    v_add_u32 v6, s35, v8
    s_and_b32 s36, s33, 1
    s_mul_i32 s36, s36, 196608
    v_mov_b32 v2, s36
    v_cndmask_b32 v2, v2, 0, s[44:45]
    v_sub_u32 v7, v6, v2
    s_mul_i32 s43, s34, 3072
    s_lshl_b32 s35, s32, 2
    s_add_u32 s35, s35, s34
    s_lshl_b32 s36, s33, 6
    s_add_u32 s36, s36, s35
    s_mul_i32 s50, s36, 1536
    s_and_b32 s37, s33, 30
    s_lshl_b32 s37, s37, 6
    s_add_u32 s37, s37, s35
    s_mul_i32 s37, s37, 1536
    s_and_b32 s35, s33, 1
    s_lshl_b32 s35, s35, 3
    s_add_u32 s37, s37, s35
    s_add_u32 s51, s37, 1024
    v_and_b32 v17, 31, v1
    v_lshlrev_b32 v17, 4, v17
    s_waitcnt lgkmcnt(0)
    s_mov_b32 s8, s4
    s_mov_b32 s9, s5
    s_mov_b32 s10, 3145728
    s_mov_b32 s11, 0x00020000
    s_add_u32 s12, s4, 3145728
    s_addc_u32 s13, s5, 0
    s_mov_b32 s14, 6291456
    s_mov_b32 s15, 0x00020000
    buffer_load_dwordx4 v[20:23], v8, s[8:11], s50 offen
    buffer_load_dwordx2 v[24:25], v17, s[8:11], s51 offen
    s_mov_b32 s41, 0
    s_mov_b32 s53, 0
    s_add_u32 s47, s41, s43
    s_add_u32 m0, s53, s43
    s_nop 0
    buffer_load_dwordx4 v6, s[12:15], s47 offen offset:0 lds
    buffer_load_dwordx4 v7, s[12:15], s47 offen offset:1024 lds
    buffer_load_dwordx4 v6, s[12:15], s47 offen offset:2048 lds
    s_mov_b32 s41, 12288
    s_mov_b32 s53, 12288
    s_add_u32 s47, s41, s43
    s_add_u32 m0, s53, s43
    s_nop 0
    buffer_load_dwordx4 v6, s[12:15], s47 offen offset:0 lds
    buffer_load_dwordx4 v7, s[12:15], s47 offen offset:1024 lds
    buffer_load_dwordx4 v6, s[12:15], s47 offen offset:2048 lds
    s_mov_b32 s41, 24576
    s_mov_b32 s53, 24576
    s_add_u32 s47, s41, s43
    s_add_u32 m0, s53, s43
    s_nop 0
    buffer_load_dwordx4 v6, s[12:15], s47 offen offset:0 lds
    buffer_load_dwordx4 v7, s[12:15], s47 offen offset:1024 lds
    buffer_load_dwordx4 v6, s[12:15], s47 offen offset:2048 lds
    s_add_u32 s16, s4, 15728640
    s_addc_u32 s17, s5, 0
    s_mov_b32 s18, 2621440
    s_mov_b32 s19, 0x00020000
    v_lshrrev_b32 v3, 5, v1
    s_and_b32 s42, s33, 1
    s_lshl_b32 s42, s42, 3
    s_add_u32 s42, s42, 1024
    v_add_u32 v9, s42, v17
    v_mov_b32 v4, 1856
    v_cndmask_b32 v9, v9, v4, s[44:45]
    v_mul_u32_u24 v4, 384, v3
    v_add_u32 v10, v17, v4
    v_add_u32 v10, 1536, v10
    s_mov_b32 s52, 0x49800000
    v_mov_b32 v11, v8
    v_mov_b32 v12, v9
    v_mov_b32 v13, v10
    v_add_u32 v14, 12288, v8
    v_add_u32 v15, 12288, v9
    v_mov_b32 v104, 0
    v_mov_b32 v105, 0
    v_mov_b32 v106, 0
    v_mov_b32 v107, 0
    v_mov_b32 v108, 0
    v_mov_b32 v109, 0
    v_mov_b32 v110, 0
    v_mov_b32 v111, 0
    v_mov_b32 v112, 0
    v_mov_b32 v113, 0
    v_mov_b32 v114, 0
    v_mov_b32 v115, 0
    v_mov_b32 v116, 0
    v_mov_b32 v117, 0
    v_mov_b32 v118, 0
    v_mov_b32 v119, 0
    v_mov_b32 v96, 0
    v_mov_b32 v97, 0
    v_mov_b32 v98, 0
    v_mov_b32 v99, 0
    v_mov_b32 v100, 0
    v_mov_b32 v101, 0
    v_mov_b32 v102, 0
    v_mov_b32 v103, 0
    v_mov_b32 v48, 0
    v_mov_b32 v49, 0
    v_mov_b32 v50, 0
    v_mov_b32 v51, 0
    v_mov_b32 v52, 0
    v_mov_b32 v53, 0
    v_mov_b32 v54, 0
    v_mov_b32 v55, 0
    v_mov_b32 v40, 0
    v_mov_b32 v41, 0
    v_mov_b32 v42, 0
    v_mov_b32 v43, 0
    v_mov_b32 v44, 0
    v_mov_b32 v45, 0
    v_mov_b32 v46, 0
    v_mov_b32 v47, 0
    s_mov_b32 s58, 0x001fffff
    s_mov_b32 s59, 0x001fffff
    s_mov_b32 s39, 0
    s_mov_b32 s40, 12288
    s_mov_b32 s41, 36864
    s_mov_b32 s53, 36864
    v_mov_b32 v2, 49280
    v_mov_b32 v3, 0
    ds_write_b32 v2, v3
    s_waitcnt vmcnt(6) lgkmcnt(0)
    s_barrier
    ds_read_b128 v[28:31], v11
    ds_read_b64 v[36:37], v12
    ds_read_b128 v[32:35], v11 offset:3072
    ds_read_b64 v[38:39], v12 offset:3072
    v_cndmask_b32 v24, v24, 0, s[44:45]
    v_cndmask_b32 v25, v25, 0, s[44:45]
    s_waitcnt lgkmcnt(0)
    s_nop 1
    v_mfma_f32_32x32x16_bf16 v[56:71], v[28:31], v[20:23], 0
    v_mfma_f32_32x32x8_bf16 v[56:71], v[36:37], v[24:25], v[56:71]
    s_nop 15
    v_max3_f32 v2, v56, v57, v58
    v_max3_f32 v2, v2, v59, v60
    v_max3_f32 v2, v2, v61, v62
    v_max3_f32 v2, v2, v63, v64
    v_max3_f32 v2, v2, v65, v66
    v_max3_f32 v2, v2, v67, v68
    v_max3_f32 v2, v2, v69, v70
    v_max_f32 v2, v2, v71
    v_mov_b32 v3, v2
    s_nop 1
    v_permlane32_swap_b32 v2, v3
    s_nop 1
    v_max_f32 v2, v2, v3
    v_ceil_f32 v2, v2
    v_add_f32 v16, 0x42a80000, v2
    v_and_b32 v2, 0xffff0000, v16
    v_sub_f32 v3, v16, v2
    v_and_b32 v4, 0xffff0000, v3
    v_sub_f32 v3, v3, v4
    v_xor_b32 v2, 0x80000000, v2
    v_xor_b32 v4, 0x80000000, v4
    v_xor_b32 v3, 0x80000000, v3
    v_lshrrev_b32 v2, 16, v2
    v_or_b32 v2, v2, v4
    v_lshrrev_b32 v3, 16, v3
    v_cndmask_b32 v24, v24, v2, s[44:45]
    v_cndmask_b32 v25, v25, v3, s[44:45]
    s_nop 1
    v_mfma_f32_32x32x16_bf16 v[56:71], v[28:31], v[20:23], 0
    v_mfma_f32_32x32x8_bf16 v[56:71], v[36:37], v[24:25], v[56:71]
    s_nop 13
    s_mov_b32 s38, 0
.p2align 6
.atloop_35:
    s_cmp_eq_u32 s56, 1
    s_cbranch_scc1 .pr1_36
    s_setprio 0
    s_branch .pr2_37
.pr1_36:
    s_setprio 1
.pr2_37:
    s_waitcnt lgkmcnt(0)
    v_cmp_lt_f32 vcc, s52, v112
    s_and_b64 vcc, vcc, s[44:45]
    s_cbranch_scc1 .resc_38
.rback_39:
    v_mfma_f32_32x32x16_bf16 v[72:87], v[32:35], v[20:23], 0
    v_exp_f32 v56, v56
    v_exp_f32 v57, v57
    ds_read_b128 v[28:31], v8 offset:6144
    v_exp_f32 v58, v58
    v_exp_f32 v59, v59
    v_mfma_f32_32x32x8_bf16 v[72:87], v[38:39], v[24:25], v[72:87]
    s_mov_b64 exec, 0xffffffff
    ds_read_b64 v[36:37], v9 offset:6144
    s_mov_b64 exec, s[58:59]
    ds_read_b128 v[40:43], v10 offset:0
    ds_read_b128 v[44:47], v10 offset:768
    s_mov_b64 exec, -1
    v_exp_f32 v60, v60
    v_exp_f32 v61, v61
    v_exp_f32 v62, v62
    v_exp_f32 v63, v63
    v_cvt_pk_bf16_f32 v88, v56, v57
    v_cvt_pk_bf16_f32 v89, v58, v59
    v_mfma_f32_32x32x16_bf16 v[104:119], v[48:51], v[96:99], v[104:119]
    v_exp_f32 v64, v64
    v_exp_f32 v65, v65
    v_exp_f32 v66, v66
    v_exp_f32 v67, v67
    v_cvt_pk_bf16_f32 v90, v60, v61
    v_cvt_pk_bf16_f32 v91, v62, v63
    v_mfma_f32_32x32x16_bf16 v[104:119], v[52:55], v[100:103], v[104:119]
    v_exp_f32 v68, v68
    v_exp_f32 v69, v69
    v_exp_f32 v70, v70
    v_exp_f32 v71, v71
    v_cvt_pk_bf16_f32 v92, v64, v65
    v_cvt_pk_bf16_f32 v93, v66, v67
    v_cvt_pk_bf16_f32 v94, v68, v69
    v_cvt_pk_bf16_f32 v95, v70, v71
    s_waitcnt lgkmcnt(0)
    v_mfma_f32_32x32x16_bf16 v[56:71], v[28:31], v[20:23], 0
    v_exp_f32 v72, v72
    v_exp_f32 v73, v73
    ds_read_b128 v[32:35], v8 offset:9216
    v_exp_f32 v74, v74
    v_exp_f32 v75, v75
    v_mfma_f32_32x32x8_bf16 v[56:71], v[36:37], v[24:25], v[56:71]
    s_mov_b64 exec, 0xffffffff
    ds_read_b64 v[38:39], v9 offset:9216
    s_mov_b64 exec, s[58:59]
    ds_read_b128 v[48:51], v10 offset:3072
    ds_read_b128 v[52:55], v10 offset:3840
    s_mov_b64 exec, -1
    v_exp_f32 v76, v76
    v_exp_f32 v77, v77
    v_exp_f32 v78, v78
    v_exp_f32 v79, v79
    v_cvt_pk_bf16_f32 v96, v72, v73
    v_cvt_pk_bf16_f32 v97, v74, v75
    v_mfma_f32_32x32x16_bf16 v[104:119], v[40:43], v[88:91], v[104:119]
    v_exp_f32 v80, v80
    v_exp_f32 v81, v81
    v_exp_f32 v82, v82
    v_exp_f32 v83, v83
    v_cvt_pk_bf16_f32 v98, v76, v77
    v_cvt_pk_bf16_f32 v99, v78, v79
    v_mfma_f32_32x32x16_bf16 v[104:119], v[44:47], v[92:95], v[104:119]
    v_exp_f32 v84, v84
    v_exp_f32 v85, v85
    v_exp_f32 v86, v86
    v_exp_f32 v87, v87
    v_cvt_pk_bf16_f32 v100, v80, v81
    v_cvt_pk_bf16_f32 v101, v82, v83
    v_cvt_pk_bf16_f32 v102, v84, v85
    v_cvt_pk_bf16_f32 v103, v86, v87
    s_waitcnt vmcnt(3)
    s_barrier
    s_waitcnt lgkmcnt(0)
    v_mfma_f32_32x32x16_bf16 v[72:87], v[32:35], v[20:23], 0
    v_exp_f32 v56, v56
    v_exp_f32 v57, v57
    ds_read_b128 v[28:31], v8 offset:12288
    v_exp_f32 v58, v58
    v_exp_f32 v59, v59
    v_mfma_f32_32x32x8_bf16 v[72:87], v[38:39], v[24:25], v[72:87]
    s_mov_b64 exec, 0xffffffff
    ds_read_b64 v[36:37], v9 offset:12288
    s_mov_b64 exec, s[58:59]
    ds_read_b128 v[40:43], v10 offset:6144
    ds_read_b128 v[44:47], v10 offset:6912
    s_mov_b64 exec, -1
    v_exp_f32 v60, v60
    v_exp_f32 v61, v61
    v_exp_f32 v62, v62
    v_exp_f32 v63, v63
    v_cvt_pk_bf16_f32 v88, v56, v57
    v_cvt_pk_bf16_f32 v89, v58, v59
    v_mfma_f32_32x32x16_bf16 v[104:119], v[48:51], v[96:99], v[104:119]
    v_exp_f32 v64, v64
    v_exp_f32 v65, v65
    v_exp_f32 v66, v66
    v_exp_f32 v67, v67
    v_cvt_pk_bf16_f32 v90, v60, v61
    v_cvt_pk_bf16_f32 v91, v62, v63
    s_add_u32 m0, s43, 36864
    s_add_u32 s47, s41, s43
    buffer_load_dwordx4 v6, s[12:15], s47 offen offset:0 lds
    v_mfma_f32_32x32x16_bf16 v[104:119], v[52:55], v[100:103], v[104:119]
    v_exp_f32 v68, v68
    v_exp_f32 v69, v69
    v_exp_f32 v70, v70
    v_exp_f32 v71, v71
    v_cvt_pk_bf16_f32 v92, v64, v65
    v_cvt_pk_bf16_f32 v93, v66, v67
    v_cvt_pk_bf16_f32 v94, v68, v69
    v_cvt_pk_bf16_f32 v95, v70, v71
    s_waitcnt lgkmcnt(0)
    v_mfma_f32_32x32x16_bf16 v[56:71], v[28:31], v[20:23], 0
    v_exp_f32 v72, v72
    v_exp_f32 v73, v73
    ds_read_b128 v[32:35], v8 offset:15360
    v_exp_f32 v74, v74
    v_exp_f32 v75, v75
    v_mfma_f32_32x32x8_bf16 v[56:71], v[36:37], v[24:25], v[56:71]
    s_mov_b64 exec, 0xffffffff
    ds_read_b64 v[38:39], v9 offset:15360
    s_mov_b64 exec, s[58:59]
    ds_read_b128 v[48:51], v10 offset:9216
    ds_read_b128 v[52:55], v10 offset:9984
    s_mov_b64 exec, -1
    v_exp_f32 v76, v76
    v_exp_f32 v77, v77
    v_exp_f32 v78, v78
    v_exp_f32 v79, v79
    v_cvt_pk_bf16_f32 v96, v72, v73
    v_cvt_pk_bf16_f32 v97, v74, v75
    v_mfma_f32_32x32x16_bf16 v[104:119], v[40:43], v[88:91], v[104:119]
    v_exp_f32 v80, v80
    v_exp_f32 v81, v81
    v_exp_f32 v82, v82
    v_exp_f32 v83, v83
    v_cvt_pk_bf16_f32 v98, v76, v77
    v_cvt_pk_bf16_f32 v99, v78, v79
    buffer_load_dwordx4 v7, s[12:15], s47 offen offset:1024 lds
    v_mfma_f32_32x32x16_bf16 v[104:119], v[44:47], v[92:95], v[104:119]
    v_exp_f32 v84, v84
    v_exp_f32 v85, v85
    v_exp_f32 v86, v86
    v_exp_f32 v87, v87
    buffer_load_dwordx4 v6, s[12:15], s47 offen offset:2048 lds
    s_add_u32 s41, s41, 12288
    s_min_u32 s41, s41, 184320
    v_cvt_pk_bf16_f32 v100, v80, v81
    v_cvt_pk_bf16_f32 v101, v82, v83
    v_cvt_pk_bf16_f32 v102, v84, v85
    v_cvt_pk_bf16_f32 v103, v86, v87
    s_cmp_eq_u32 s56, 1
    s_cbranch_scc1 .pr1_40
    s_setprio 0
    s_branch .pr2_41
.pr1_40:
    s_setprio 1
.pr2_41:
    s_waitcnt lgkmcnt(0)
    v_mfma_f32_32x32x16_bf16 v[72:87], v[32:35], v[20:23], 0
    v_exp_f32 v56, v56
    v_exp_f32 v57, v57
    ds_read_b128 v[28:31], v8 offset:18432
    v_exp_f32 v58, v58
    v_exp_f32 v59, v59
    v_mfma_f32_32x32x8_bf16 v[72:87], v[38:39], v[24:25], v[72:87]
    s_mov_b64 exec, 0xffffffff
    ds_read_b64 v[36:37], v9 offset:18432
    s_mov_b64 exec, s[58:59]
    ds_read_b128 v[40:43], v10 offset:12288
    ds_read_b128 v[44:47], v10 offset:13056
    s_mov_b64 exec, -1
    v_exp_f32 v60, v60
    v_exp_f32 v61, v61
    v_exp_f32 v62, v62
    v_exp_f32 v63, v63
    v_cvt_pk_bf16_f32 v88, v56, v57
    v_cvt_pk_bf16_f32 v89, v58, v59
    v_mfma_f32_32x32x16_bf16 v[104:119], v[48:51], v[96:99], v[104:119]
    v_exp_f32 v64, v64
    v_exp_f32 v65, v65
    v_exp_f32 v66, v66
    v_exp_f32 v67, v67
    v_cvt_pk_bf16_f32 v90, v60, v61
    v_cvt_pk_bf16_f32 v91, v62, v63
    v_mfma_f32_32x32x16_bf16 v[104:119], v[52:55], v[100:103], v[104:119]
    v_exp_f32 v68, v68
    v_exp_f32 v69, v69
    v_exp_f32 v70, v70
    v_exp_f32 v71, v71
    v_cvt_pk_bf16_f32 v92, v64, v65
    v_cvt_pk_bf16_f32 v93, v66, v67
    v_cvt_pk_bf16_f32 v94, v68, v69
    v_cvt_pk_bf16_f32 v95, v70, v71
    s_waitcnt lgkmcnt(0)
    v_mfma_f32_32x32x16_bf16 v[56:71], v[28:31], v[20:23], 0
    v_exp_f32 v72, v72
    v_exp_f32 v73, v73
    ds_read_b128 v[32:35], v8 offset:21504
    v_exp_f32 v74, v74
    v_exp_f32 v75, v75
    v_mfma_f32_32x32x8_bf16 v[56:71], v[36:37], v[24:25], v[56:71]
    s_mov_b64 exec, 0xffffffff
    ds_read_b64 v[38:39], v9 offset:21504
    s_mov_b64 exec, s[58:59]
    ds_read_b128 v[48:51], v10 offset:15360
    ds_read_b128 v[52:55], v10 offset:16128
    s_mov_b64 exec, -1
    v_exp_f32 v76, v76
    v_exp_f32 v77, v77
    v_exp_f32 v78, v78
    v_exp_f32 v79, v79
    v_cvt_pk_bf16_f32 v96, v72, v73
    v_cvt_pk_bf16_f32 v97, v74, v75
    v_mfma_f32_32x32x16_bf16 v[104:119], v[40:43], v[88:91], v[104:119]
    v_exp_f32 v80, v80
    v_exp_f32 v81, v81
    v_exp_f32 v82, v82
    v_exp_f32 v83, v83
    v_cvt_pk_bf16_f32 v98, v76, v77
    v_cvt_pk_bf16_f32 v99, v78, v79
    v_mfma_f32_32x32x16_bf16 v[104:119], v[44:47], v[92:95], v[104:119]
    v_exp_f32 v84, v84
    v_exp_f32 v85, v85
    v_exp_f32 v86, v86
    v_exp_f32 v87, v87
    v_cvt_pk_bf16_f32 v100, v80, v81
    v_cvt_pk_bf16_f32 v101, v82, v83
    v_cvt_pk_bf16_f32 v102, v84, v85
    v_cvt_pk_bf16_f32 v103, v86, v87
    s_waitcnt vmcnt(3)
    s_barrier
    s_waitcnt lgkmcnt(0)
    v_mfma_f32_32x32x16_bf16 v[72:87], v[32:35], v[20:23], 0
    v_exp_f32 v56, v56
    v_exp_f32 v57, v57
    ds_read_b128 v[28:31], v8 offset:24576
    v_exp_f32 v58, v58
    v_exp_f32 v59, v59
    v_mfma_f32_32x32x8_bf16 v[72:87], v[38:39], v[24:25], v[72:87]
    s_mov_b64 exec, 0xffffffff
    ds_read_b64 v[36:37], v9 offset:24576
    s_mov_b64 exec, s[58:59]
    ds_read_b128 v[40:43], v10 offset:18432
    ds_read_b128 v[44:47], v10 offset:19200
    s_mov_b64 exec, -1
    v_exp_f32 v60, v60
    v_exp_f32 v61, v61
    v_exp_f32 v62, v62
    v_exp_f32 v63, v63
    v_cvt_pk_bf16_f32 v88, v56, v57
    v_cvt_pk_bf16_f32 v89, v58, v59
    v_mfma_f32_32x32x16_bf16 v[104:119], v[48:51], v[96:99], v[104:119]
    v_exp_f32 v64, v64
    v_exp_f32 v65, v65
    v_exp_f32 v66, v66
    v_exp_f32 v67, v67
    v_cvt_pk_bf16_f32 v90, v60, v61
    v_cvt_pk_bf16_f32 v91, v62, v63
    s_add_u32 m0, s43, 0
    s_add_u32 s47, s41, s43
    buffer_load_dwordx4 v6, s[12:15], s47 offen offset:0 lds
    v_mfma_f32_32x32x16_bf16 v[104:119], v[52:55], v[100:103], v[104:119]
    v_exp_f32 v68, v68
    v_exp_f32 v69, v69
    v_exp_f32 v70, v70
    v_exp_f32 v71, v71
    v_cvt_pk_bf16_f32 v92, v64, v65
    v_cvt_pk_bf16_f32 v93, v66, v67
    v_cvt_pk_bf16_f32 v94, v68, v69
    v_cvt_pk_bf16_f32 v95, v70, v71
    s_waitcnt lgkmcnt(0)
    v_mfma_f32_32x32x16_bf16 v[56:71], v[28:31], v[20:23], 0
    v_exp_f32 v72, v72
    v_exp_f32 v73, v73
    ds_read_b128 v[32:35], v8 offset:27648
    v_exp_f32 v74, v74
    v_exp_f32 v75, v75
    v_mfma_f32_32x32x8_bf16 v[56:71], v[36:37], v[24:25], v[56:71]
    s_mov_b64 exec, 0xffffffff
    ds_read_b64 v[38:39], v9 offset:27648
    s_mov_b64 exec, s[58:59]
    ds_read_b128 v[48:51], v10 offset:21504
    ds_read_b128 v[52:55], v10 offset:22272
    s_mov_b64 exec, -1
    v_exp_f32 v76, v76
    v_exp_f32 v77, v77
    v_exp_f32 v78, v78
    v_exp_f32 v79, v79
    v_cvt_pk_bf16_f32 v96, v72, v73
    v_cvt_pk_bf16_f32 v97, v74, v75
    v_mfma_f32_32x32x16_bf16 v[104:119], v[40:43], v[88:91], v[104:119]
    v_exp_f32 v80, v80
    v_exp_f32 v81, v81
    v_exp_f32 v82, v82
    v_exp_f32 v83, v83
    v_cvt_pk_bf16_f32 v98, v76, v77
    v_cvt_pk_bf16_f32 v99, v78, v79
    buffer_load_dwordx4 v7, s[12:15], s47 offen offset:1024 lds
    v_mfma_f32_32x32x16_bf16 v[104:119], v[44:47], v[92:95], v[104:119]
    v_exp_f32 v84, v84
    v_exp_f32 v85, v85
    v_exp_f32 v86, v86
    v_exp_f32 v87, v87
    buffer_load_dwordx4 v6, s[12:15], s47 offen offset:2048 lds
    s_add_u32 s41, s41, 12288
    s_min_u32 s41, s41, 184320
    v_cvt_pk_bf16_f32 v100, v80, v81
    v_cvt_pk_bf16_f32 v101, v82, v83
    v_cvt_pk_bf16_f32 v102, v84, v85
    v_cvt_pk_bf16_f32 v103, v86, v87
    s_cmp_eq_u32 s56, 1
    s_cbranch_scc1 .pr1_42
    s_setprio 0
    s_branch .pr2_43
.pr1_42:
    s_setprio 1
.pr2_43:
    s_waitcnt lgkmcnt(0)
    v_mfma_f32_32x32x16_bf16 v[72:87], v[32:35], v[20:23], 0
    v_exp_f32 v56, v56
    v_exp_f32 v57, v57
    ds_read_b128 v[28:31], v8 offset:30720
    v_exp_f32 v58, v58
    v_exp_f32 v59, v59
    v_mfma_f32_32x32x8_bf16 v[72:87], v[38:39], v[24:25], v[72:87]
    s_mov_b64 exec, 0xffffffff
    ds_read_b64 v[36:37], v9 offset:30720
    s_mov_b64 exec, s[58:59]
    ds_read_b128 v[40:43], v10 offset:24576
    ds_read_b128 v[44:47], v10 offset:25344
    s_mov_b64 exec, -1
    v_exp_f32 v60, v60
    v_exp_f32 v61, v61
    v_exp_f32 v62, v62
    v_exp_f32 v63, v63
    v_cvt_pk_bf16_f32 v88, v56, v57
    v_cvt_pk_bf16_f32 v89, v58, v59
    v_mfma_f32_32x32x16_bf16 v[104:119], v[48:51], v[96:99], v[104:119]
    v_exp_f32 v64, v64
    v_exp_f32 v65, v65
    v_exp_f32 v66, v66
    v_exp_f32 v67, v67
    v_cvt_pk_bf16_f32 v90, v60, v61
    v_cvt_pk_bf16_f32 v91, v62, v63
    v_mfma_f32_32x32x16_bf16 v[104:119], v[52:55], v[100:103], v[104:119]
    v_exp_f32 v68, v68
    v_exp_f32 v69, v69
    v_exp_f32 v70, v70
    v_exp_f32 v71, v71
    v_cvt_pk_bf16_f32 v92, v64, v65
    v_cvt_pk_bf16_f32 v93, v66, v67
    v_cvt_pk_bf16_f32 v94, v68, v69
    v_cvt_pk_bf16_f32 v95, v70, v71
    s_waitcnt lgkmcnt(0)
    v_mfma_f32_32x32x16_bf16 v[56:71], v[28:31], v[20:23], 0
    v_exp_f32 v72, v72
    v_exp_f32 v73, v73
    ds_read_b128 v[32:35], v8 offset:33792
    v_exp_f32 v74, v74
    v_exp_f32 v75, v75
    v_mfma_f32_32x32x8_bf16 v[56:71], v[36:37], v[24:25], v[56:71]
    s_mov_b64 exec, 0xffffffff
    ds_read_b64 v[38:39], v9 offset:33792
    s_mov_b64 exec, s[58:59]
    ds_read_b128 v[48:51], v10 offset:27648
    ds_read_b128 v[52:55], v10 offset:28416
    s_mov_b64 exec, -1
    v_exp_f32 v76, v76
    v_exp_f32 v77, v77
    v_exp_f32 v78, v78
    v_exp_f32 v79, v79
    v_cvt_pk_bf16_f32 v96, v72, v73
    v_cvt_pk_bf16_f32 v97, v74, v75
    v_mfma_f32_32x32x16_bf16 v[104:119], v[40:43], v[88:91], v[104:119]
    v_exp_f32 v80, v80
    v_exp_f32 v81, v81
    v_exp_f32 v82, v82
    v_exp_f32 v83, v83
    v_cvt_pk_bf16_f32 v98, v76, v77
    v_cvt_pk_bf16_f32 v99, v78, v79
    v_mfma_f32_32x32x16_bf16 v[104:119], v[44:47], v[92:95], v[104:119]
    v_exp_f32 v84, v84
    v_exp_f32 v85, v85
    v_exp_f32 v86, v86
    v_exp_f32 v87, v87
    v_cvt_pk_bf16_f32 v100, v80, v81
    v_cvt_pk_bf16_f32 v101, v82, v83
    v_cvt_pk_bf16_f32 v102, v84, v85
    v_cvt_pk_bf16_f32 v103, v86, v87
    s_waitcnt vmcnt(3)
    s_barrier
    s_waitcnt lgkmcnt(0)
    v_mfma_f32_32x32x16_bf16 v[72:87], v[32:35], v[20:23], 0
    v_exp_f32 v56, v56
    v_exp_f32 v57, v57
    ds_read_b128 v[28:31], v8 offset:36864
    v_exp_f32 v58, v58
    v_exp_f32 v59, v59
    v_mfma_f32_32x32x8_bf16 v[72:87], v[38:39], v[24:25], v[72:87]
    s_mov_b64 exec, 0xffffffff
    ds_read_b64 v[36:37], v9 offset:36864
    s_mov_b64 exec, s[58:59]
    ds_read_b128 v[40:43], v10 offset:30720
    ds_read_b128 v[44:47], v10 offset:31488
    s_mov_b64 exec, -1
    v_exp_f32 v60, v60
    v_exp_f32 v61, v61
    v_exp_f32 v62, v62
    v_exp_f32 v63, v63
    v_cvt_pk_bf16_f32 v88, v56, v57
    v_cvt_pk_bf16_f32 v89, v58, v59
    v_mfma_f32_32x32x16_bf16 v[104:119], v[48:51], v[96:99], v[104:119]
    v_exp_f32 v64, v64
    v_exp_f32 v65, v65
    v_exp_f32 v66, v66
    v_exp_f32 v67, v67
    v_cvt_pk_bf16_f32 v90, v60, v61
    v_cvt_pk_bf16_f32 v91, v62, v63
    s_add_u32 m0, s43, 12288
    s_add_u32 s47, s41, s43
    buffer_load_dwordx4 v6, s[12:15], s47 offen offset:0 lds
    v_mfma_f32_32x32x16_bf16 v[104:119], v[52:55], v[100:103], v[104:119]
    v_exp_f32 v68, v68
    v_exp_f32 v69, v69
    v_exp_f32 v70, v70
    v_exp_f32 v71, v71
    v_cvt_pk_bf16_f32 v92, v64, v65
    v_cvt_pk_bf16_f32 v93, v66, v67
    v_cvt_pk_bf16_f32 v94, v68, v69
    v_cvt_pk_bf16_f32 v95, v70, v71
    s_waitcnt lgkmcnt(0)
    v_mfma_f32_32x32x16_bf16 v[56:71], v[28:31], v[20:23], 0
    v_exp_f32 v72, v72
    v_exp_f32 v73, v73
    ds_read_b128 v[32:35], v8 offset:39936
    v_exp_f32 v74, v74
    v_exp_f32 v75, v75
    v_mfma_f32_32x32x8_bf16 v[56:71], v[36:37], v[24:25], v[56:71]
    s_mov_b64 exec, 0xffffffff
    ds_read_b64 v[38:39], v9 offset:39936
    s_mov_b64 exec, s[58:59]
    ds_read_b128 v[48:51], v10 offset:33792
    ds_read_b128 v[52:55], v10 offset:34560
    s_mov_b64 exec, -1
    v_exp_f32 v76, v76
    v_exp_f32 v77, v77
    v_exp_f32 v78, v78
    v_exp_f32 v79, v79
    v_cvt_pk_bf16_f32 v96, v72, v73
    v_cvt_pk_bf16_f32 v97, v74, v75
    v_mfma_f32_32x32x16_bf16 v[104:119], v[40:43], v[88:91], v[104:119]
    v_exp_f32 v80, v80
    v_exp_f32 v81, v81
    v_exp_f32 v82, v82
    v_exp_f32 v83, v83
    v_cvt_pk_bf16_f32 v98, v76, v77
    v_cvt_pk_bf16_f32 v99, v78, v79
    buffer_load_dwordx4 v7, s[12:15], s47 offen offset:1024 lds
    v_mfma_f32_32x32x16_bf16 v[104:119], v[44:47], v[92:95], v[104:119]
    v_exp_f32 v84, v84
    v_exp_f32 v85, v85
    v_exp_f32 v86, v86
    v_exp_f32 v87, v87
    buffer_load_dwordx4 v6, s[12:15], s47 offen offset:2048 lds
    s_add_u32 s41, s41, 12288
    s_min_u32 s41, s41, 184320
    v_cvt_pk_bf16_f32 v100, v80, v81
    v_cvt_pk_bf16_f32 v101, v82, v83
    v_cvt_pk_bf16_f32 v102, v84, v85
    v_cvt_pk_bf16_f32 v103, v86, v87
    s_cmp_eq_u32 s56, 0
    s_cbranch_scc1 .pr1_44
    s_setprio 0
    s_branch .pr2_45
.pr1_44:
    s_setprio 1
.pr2_45:
    s_waitcnt lgkmcnt(0)
    v_mfma_f32_32x32x16_bf16 v[72:87], v[32:35], v[20:23], 0
    v_exp_f32 v56, v56
    v_exp_f32 v57, v57
    ds_read_b128 v[28:31], v8 offset:43008
    v_exp_f32 v58, v58
    v_exp_f32 v59, v59
    v_mfma_f32_32x32x8_bf16 v[72:87], v[38:39], v[24:25], v[72:87]
    s_mov_b64 exec, 0xffffffff
    ds_read_b64 v[36:37], v9 offset:43008
    s_mov_b64 exec, s[58:59]
    ds_read_b128 v[40:43], v10 offset:36864
    ds_read_b128 v[44:47], v10 offset:37632
    s_mov_b64 exec, -1
    v_exp_f32 v60, v60
    v_exp_f32 v61, v61
    v_exp_f32 v62, v62
    v_exp_f32 v63, v63
    v_cvt_pk_bf16_f32 v88, v56, v57
    v_cvt_pk_bf16_f32 v89, v58, v59
    v_mfma_f32_32x32x16_bf16 v[104:119], v[48:51], v[96:99], v[104:119]
    v_exp_f32 v64, v64
    v_exp_f32 v65, v65
    v_exp_f32 v66, v66
    v_exp_f32 v67, v67
    v_cvt_pk_bf16_f32 v90, v60, v61
    v_cvt_pk_bf16_f32 v91, v62, v63
    v_mfma_f32_32x32x16_bf16 v[104:119], v[52:55], v[100:103], v[104:119]
    v_exp_f32 v68, v68
    v_exp_f32 v69, v69
    v_exp_f32 v70, v70
    v_exp_f32 v71, v71
    v_cvt_pk_bf16_f32 v92, v64, v65
    v_cvt_pk_bf16_f32 v93, v66, v67
    v_cvt_pk_bf16_f32 v94, v68, v69
    v_cvt_pk_bf16_f32 v95, v70, v71
    s_waitcnt lgkmcnt(0)
    v_mfma_f32_32x32x16_bf16 v[56:71], v[28:31], v[20:23], 0
    v_exp_f32 v72, v72
    v_exp_f32 v73, v73
    ds_read_b128 v[32:35], v8 offset:46080
    v_exp_f32 v74, v74
    v_exp_f32 v75, v75
    v_mfma_f32_32x32x8_bf16 v[56:71], v[36:37], v[24:25], v[56:71]
    s_mov_b64 exec, 0xffffffff
    ds_read_b64 v[38:39], v9 offset:46080
    s_mov_b64 exec, s[58:59]
    ds_read_b128 v[48:51], v10 offset:39936
    ds_read_b128 v[52:55], v10 offset:40704
    s_mov_b64 exec, -1
    v_exp_f32 v76, v76
    v_exp_f32 v77, v77
    v_exp_f32 v78, v78
    v_exp_f32 v79, v79
    v_cvt_pk_bf16_f32 v96, v72, v73
    v_cvt_pk_bf16_f32 v97, v74, v75
    v_mfma_f32_32x32x16_bf16 v[104:119], v[40:43], v[88:91], v[104:119]
    v_exp_f32 v80, v80
    v_exp_f32 v81, v81
    v_exp_f32 v82, v82
    v_exp_f32 v83, v83
    v_cvt_pk_bf16_f32 v98, v76, v77
    v_cvt_pk_bf16_f32 v99, v78, v79
    v_mfma_f32_32x32x16_bf16 v[104:119], v[44:47], v[92:95], v[104:119]
    v_exp_f32 v84, v84
    v_exp_f32 v85, v85
    v_exp_f32 v86, v86
    v_exp_f32 v87, v87
    v_cvt_pk_bf16_f32 v100, v80, v81
    v_cvt_pk_bf16_f32 v101, v82, v83
    v_cvt_pk_bf16_f32 v102, v84, v85
    v_cvt_pk_bf16_f32 v103, v86, v87
    s_waitcnt vmcnt(3)
    s_barrier
    s_waitcnt lgkmcnt(0)
    v_mfma_f32_32x32x16_bf16 v[72:87], v[32:35], v[20:23], 0
    v_exp_f32 v56, v56
    v_exp_f32 v57, v57
    ds_read_b128 v[28:31], v8 offset:0
    v_exp_f32 v58, v58
    v_exp_f32 v59, v59
    v_mfma_f32_32x32x8_bf16 v[72:87], v[38:39], v[24:25], v[72:87]
    s_mov_b64 exec, 0xffffffff
    ds_read_b64 v[36:37], v9 offset:0
    s_mov_b64 exec, s[58:59]
    ds_read_b128 v[40:43], v10 offset:43008
    ds_read_b128 v[44:47], v10 offset:43776
    s_mov_b64 exec, -1
    v_exp_f32 v60, v60
    v_exp_f32 v61, v61
    v_exp_f32 v62, v62
    v_exp_f32 v63, v63
    v_cvt_pk_bf16_f32 v88, v56, v57
    v_cvt_pk_bf16_f32 v89, v58, v59
    v_mfma_f32_32x32x16_bf16 v[104:119], v[48:51], v[96:99], v[104:119]
    v_exp_f32 v64, v64
    v_exp_f32 v65, v65
    v_exp_f32 v66, v66
    v_exp_f32 v67, v67
    v_cvt_pk_bf16_f32 v90, v60, v61
    v_cvt_pk_bf16_f32 v91, v62, v63
    s_add_u32 m0, s43, 24576
    s_add_u32 s47, s41, s43
    buffer_load_dwordx4 v6, s[12:15], s47 offen offset:0 lds
    v_mfma_f32_32x32x16_bf16 v[104:119], v[52:55], v[100:103], v[104:119]
    v_exp_f32 v68, v68
    v_exp_f32 v69, v69
    v_exp_f32 v70, v70
    v_exp_f32 v71, v71
    v_cvt_pk_bf16_f32 v92, v64, v65
    v_cvt_pk_bf16_f32 v93, v66, v67
    v_cvt_pk_bf16_f32 v94, v68, v69
    v_cvt_pk_bf16_f32 v95, v70, v71
    s_waitcnt lgkmcnt(0)
    v_mfma_f32_32x32x16_bf16 v[56:71], v[28:31], v[20:23], 0
    v_exp_f32 v72, v72
    v_exp_f32 v73, v73
    ds_read_b128 v[32:35], v8 offset:3072
    v_exp_f32 v74, v74
    v_exp_f32 v75, v75
    v_mfma_f32_32x32x8_bf16 v[56:71], v[36:37], v[24:25], v[56:71]
    s_mov_b64 exec, 0xffffffff
    ds_read_b64 v[38:39], v9 offset:3072
    s_mov_b64 exec, s[58:59]
    ds_read_b128 v[48:51], v10 offset:46080
    ds_read_b128 v[52:55], v10 offset:46848
    s_mov_b64 exec, -1
    v_exp_f32 v76, v76
    v_exp_f32 v77, v77
    v_exp_f32 v78, v78
    v_exp_f32 v79, v79
    v_cvt_pk_bf16_f32 v96, v72, v73
    v_cvt_pk_bf16_f32 v97, v74, v75
    v_mfma_f32_32x32x16_bf16 v[104:119], v[40:43], v[88:91], v[104:119]
    v_exp_f32 v80, v80
    v_exp_f32 v81, v81
    v_exp_f32 v82, v82
    v_exp_f32 v83, v83
    v_cvt_pk_bf16_f32 v98, v76, v77
    v_cvt_pk_bf16_f32 v99, v78, v79
    buffer_load_dwordx4 v7, s[12:15], s47 offen offset:1024 lds
    v_mfma_f32_32x32x16_bf16 v[104:119], v[44:47], v[92:95], v[104:119]
    v_exp_f32 v84, v84
    v_exp_f32 v85, v85
    v_exp_f32 v86, v86
    v_exp_f32 v87, v87
    buffer_load_dwordx4 v6, s[12:15], s47 offen offset:2048 lds
    s_add_u32 s41, s41, 12288
    s_min_u32 s41, s41, 184320
    v_cvt_pk_bf16_f32 v100, v80, v81
    v_cvt_pk_bf16_f32 v101, v82, v83
    v_cvt_pk_bf16_f32 v102, v84, v85
    v_cvt_pk_bf16_f32 v103, v86, v87
    s_add_u32 s38, s38, 1
    s_cmp_lt_u32 s38, 4
    s_cbranch_scc1 .atloop_35
    s_waitcnt lgkmcnt(0)
    v_mfma_f32_32x32x16_bf16 v[104:119], v[48:51], v[96:99], v[104:119]
    v_mfma_f32_32x32x16_bf16 v[104:119], v[52:55], v[100:103], v[104:119]
    s_mov_b64 s[54:55], 0
    s_movk_i32 s49, 0x207
    s_nop 13
    v_cmp_class_f32 vcc, v104, s49
    s_or_b64 s[54:55], s[54:55], vcc
    v_cmp_class_f32 vcc, v105, s49
    s_or_b64 s[54:55], s[54:55], vcc
    v_cmp_class_f32 vcc, v106, s49
    s_or_b64 s[54:55], s[54:55], vcc
    v_cmp_class_f32 vcc, v107, s49
    s_or_b64 s[54:55], s[54:55], vcc
    v_cmp_class_f32 vcc, v108, s49
    s_or_b64 s[54:55], s[54:55], vcc
    v_cmp_class_f32 vcc, v109, s49
    s_or_b64 s[54:55], s[54:55], vcc
    v_cmp_class_f32 vcc, v110, s49
    s_or_b64 s[54:55], s[54:55], vcc
    v_cmp_class_f32 vcc, v111, s49
    s_or_b64 s[54:55], s[54:55], vcc
    v_cmp_class_f32 vcc, v112, s49
    s_or_b64 s[54:55], s[54:55], vcc
    v_cmp_class_f32 vcc, v113, s49
    s_andn2_b64 vcc, vcc, s[44:45]
    s_or_b64 s[54:55], s[54:55], vcc
    v_cmp_class_f32 vcc, v114, s49
    s_andn2_b64 vcc, vcc, s[44:45]
    s_or_b64 s[54:55], s[54:55], vcc
    v_cmp_class_f32 vcc, v115, s49
    s_andn2_b64 vcc, vcc, s[44:45]
    s_or_b64 s[54:55], s[54:55], vcc
    v_cmp_ge_f32 vcc, 0, v112
    s_and_b64 vcc, vcc, s[44:45]
    s_or_b64 s[54:55], s[54:55], vcc
    s_cmp_eq_u64 s[54:55], 0
    s_cbranch_scc1 .good_47
    v_mov_b32 v2, 49280
    v_mov_b32 v3, 1
    ds_write_b32 v2, v3
.good_47:
    s_lshl_b32 s35, s32, 3
    s_lshl_b32 s36, s34, 1
    s_add_u32 s35, s35, s36
    s_mul_i32 s35, s35, 20480
    v_bfe_u32 v4, v1, 4, 1
    v_mul_u32_u24 v4, 20480, v4
    v_and_b32 v3, 15, v1
    v_lshlrev_b32 v3, 4, v3
    v_add_u32 v4, v4, v3
    v_add_u32 v11, s35, v4
    s_lshr_b32 s35, s33, 1
    s_lshl_b32 s35, s35, 10
    s_and_b32 s36, s33, 1
    s_lshl_b32 s36, s36, 9
    s_add_u32 s35, s35, s36
    v_lshrrev_b32 v3, 5, v1
    v_lshlrev_b32 v3, 8, v3
    v_add3_u32 v12, v11, v3, s35
    s_lshr_b32 s35, s33, 3
    s_add_u32 s35, s35, 16
    s_lshl_b32 s35, s35, 10
    s_and_b32 s36, s33, 7
    s_lshr_b32 s36, s36, 1
    s_lshl_b32 s36, s36, 8
    s_add_u32 s35, s35, s36
    s_and_b32 s36, s33, 1
    s_lshl_b32 s36, s36, 3
    s_add_u32 s35, s35, s36
    v_add_u32 v13, s35, v11
    v_mov_b32 v2, v112
    v_mov_b32 v3, v112
    s_nop 1
    v_permlane32_swap_b32 v2, v3
    s_nop 1
    v_rcp_f32 v3, v3
    s_nop 0
    v_mul_f32 v104, v104, v3
    v_mul_f32 v105, v105, v3
    v_mul_f32 v106, v106, v3
    v_mul_f32 v107, v107, v3
    v_mul_f32 v108, v108, v3
    v_mul_f32 v109, v109, v3
    v_mul_f32 v110, v110, v3
    v_mul_f32 v111, v111, v3
    v_mul_f32 v112, v112, v3
    v_mul_f32 v113, v113, v3
    v_mul_f32 v114, v114, v3
    v_mul_f32 v115, v115, v3
    v_cvt_pk_bf16_f32 v88, v104, v105
    v_cvt_pk_bf16_f32 v89, v106, v107
    v_cvt_pk_bf16_f32 v90, v108, v109
    v_cvt_pk_bf16_f32 v91, v110, v111
    v_cvt_pk_bf16_f32 v92, v112, v113
    v_cvt_pk_bf16_f32 v93, v114, v115
    buffer_store_dwordx4 v[88:91], v12, s[16:19], 0 offen sc1
    s_mov_b64 exec, 0xffffffff
    buffer_store_dwordx2 v[92:93], v13, s[16:19], 0 offen sc1
    s_mov_b64 exec, -1
    s_add_u32 s64, s4, 28377088
    s_addc_u32 s65, s5, 0
    s_mov_b32 s66, 4096
    s_mov_b32 s67, 0x00020000
    s_lshl_b32 s35, s32, 8
    v_mov_b32 v4, s35
    v_mov_b32 v5, 1
    v_mov_b32 v2, 49280
    s_waitcnt vmcnt(0) lgkmcnt(0)
    s_barrier
    ds_read_b32 v3, v2
    s_waitcnt lgkmcnt(0)
    v_readfirstlane_b32 s36, v3
    s_nop 3
    s_cmp_lg_u32 s36, 0
    s_cbranch_scc1 .fallback_46
    v_cmp_eq_u32 vcc, 0, v0
    s_and_saveexec_b64 s[62:63], vcc
    buffer_atomic_add v5, v4, s[64:67], 0 offen
    s_mov_b64 exec, s[62:63]
    s_endpgm
.fallback_46:
    s_barrier
    v_mov_b32 v11, v8
    v_mov_b32 v12, v9
    v_mov_b32 v13, v10
    v_add_u32 v14, 12288, v8
    v_add_u32 v15, 12288, v9
    v_mov_b32 v104, 0
    v_mov_b32 v105, 0
    v_mov_b32 v106, 0
    v_mov_b32 v107, 0
    v_mov_b32 v108, 0
    v_mov_b32 v109, 0
    v_mov_b32 v110, 0
    v_mov_b32 v111, 0
    v_mov_b32 v112, 0
    v_mov_b32 v113, 0
    v_mov_b32 v114, 0
    v_mov_b32 v115, 0
    v_mov_b32 v116, 0
    v_mov_b32 v117, 0
    v_mov_b32 v118, 0
    v_mov_b32 v119, 0
    buffer_load_dwordx2 v[24:25], v17, s[8:11], s51 offen
    s_waitcnt vmcnt(0)
    v_cndmask_b32 v24, v24, 0, s[44:45]
    v_cndmask_b32 v25, v25, 0, s[44:45]
    v_mov_b32 v16, 0
    s_mov_b32 s38, 0
.fbloop_48:
    s_barrier
    s_mul_i32 s41, s38, 12288
    s_mov_b32 s53, 0
    s_add_u32 s47, s41, s43
    s_add_u32 m0, s53, s43
    s_nop 0
    buffer_load_dwordx4 v6, s[12:15], s47 offen offset:0 lds
    buffer_load_dwordx4 v7, s[12:15], s47 offen offset:1024 lds
    buffer_load_dwordx4 v6, s[12:15], s47 offen offset:2048 lds
    s_waitcnt vmcnt(0)
    s_barrier
    ds_read_b128 v[28:31], v8 offset:0
    ds_read_b64 v[36:37], v9 offset:0
    ds_read_b128 v[40:43], v10 offset:0
    ds_read_b128 v[44:47], v10 offset:768
    s_waitcnt lgkmcnt(0)
    v_mfma_f32_32x32x16_bf16 v[56:71], v[28:31], v[20:23], 0
    v_mfma_f32_32x32x8_bf16 v[56:71], v[36:37], v[24:25], v[56:71]
    s_nop 15
    v_max3_f32 v2, v56, v57, v58
    v_max3_f32 v2, v2, v59, v60
    v_max3_f32 v2, v2, v61, v62
    v_max3_f32 v2, v2, v63, v64
    v_max3_f32 v2, v2, v65, v66
    v_max3_f32 v2, v2, v67, v68
    v_max3_f32 v2, v2, v69, v70
    v_max_f32 v2, v2, v71
    v_mov_b32 v3, v2
    s_nop 1
    v_permlane32_swap_b32 v2, v3
    s_nop 1
    v_max_f32 v2, v2, v3
    v_ceil_f32 v2, v2
    v_add_f32 v2, 0x42a80000, v2
    v_max_f32 v3, 0, v2
    s_cmp_eq_u32 s38, 0
    s_cselect_b64 vcc, -1, 0
    v_cndmask_b32 v2, v3, v2, vcc
    v_add_f32 v3, v16, v2
    v_sub_f32 v2, v3, v16
    v_mov_b32 v16, v3
    v_cvt_i32_f32 v4, v2
    v_sub_u32 v4, 0, v4
    v_sub_f32 v56, v56, v2
    v_sub_f32 v57, v57, v2
    v_sub_f32 v58, v58, v2
    v_sub_f32 v59, v59, v2
    v_sub_f32 v60, v60, v2
    v_sub_f32 v61, v61, v2
    v_sub_f32 v62, v62, v2
    v_sub_f32 v63, v63, v2
    v_sub_f32 v64, v64, v2
    v_sub_f32 v65, v65, v2
    v_sub_f32 v66, v66, v2
    v_sub_f32 v67, v67, v2
    v_sub_f32 v68, v68, v2
    v_sub_f32 v69, v69, v2
    v_sub_f32 v70, v70, v2
    v_sub_f32 v71, v71, v2
    v_ldexp_f32 v104, v104, v4
    v_ldexp_f32 v105, v105, v4
    v_ldexp_f32 v106, v106, v4
    v_ldexp_f32 v107, v107, v4
    v_ldexp_f32 v108, v108, v4
    v_ldexp_f32 v109, v109, v4
    v_ldexp_f32 v110, v110, v4
    v_ldexp_f32 v111, v111, v4
    v_ldexp_f32 v112, v112, v4
    v_ldexp_f32 v113, v113, v4
    v_ldexp_f32 v114, v114, v4
    v_ldexp_f32 v115, v115, v4
    v_and_b32 v2, 0xffff0000, v16
    v_sub_f32 v3, v16, v2
    v_and_b32 v4, 0xffff0000, v3
    v_sub_f32 v3, v3, v4
    v_xor_b32 v2, 0x80000000, v2
    v_xor_b32 v4, 0x80000000, v4
    v_xor_b32 v3, 0x80000000, v3
    v_lshrrev_b32 v2, 16, v2
    v_or_b32 v2, v2, v4
    v_lshrrev_b32 v3, 16, v3
    v_cndmask_b32 v24, v24, v2, s[44:45]
    v_cndmask_b32 v25, v25, v3, s[44:45]
    s_nop 1
    v_exp_f32 v56, v56
    v_exp_f32 v57, v57
    v_exp_f32 v58, v58
    v_exp_f32 v59, v59
    v_exp_f32 v60, v60
    v_exp_f32 v61, v61
    v_exp_f32 v62, v62
    v_exp_f32 v63, v63
    v_exp_f32 v64, v64
    v_exp_f32 v65, v65
    v_exp_f32 v66, v66
    v_exp_f32 v67, v67
    v_exp_f32 v68, v68
    v_exp_f32 v69, v69
    v_exp_f32 v70, v70
    v_exp_f32 v71, v71
    s_nop 0
    v_cvt_pk_bf16_f32 v88, v56, v57
    v_cvt_pk_bf16_f32 v89, v58, v59
    v_cvt_pk_bf16_f32 v90, v60, v61
    v_cvt_pk_bf16_f32 v91, v62, v63
    v_cvt_pk_bf16_f32 v92, v64, v65
    v_cvt_pk_bf16_f32 v93, v66, v67
    v_cvt_pk_bf16_f32 v94, v68, v69
    v_cvt_pk_bf16_f32 v95, v70, v71
    s_nop 1
    v_mfma_f32_32x32x16_bf16 v[104:119], v[40:43], v[88:91], v[104:119]
    v_mfma_f32_32x32x16_bf16 v[104:119], v[44:47], v[92:95], v[104:119]
    s_nop 15
    ds_read_b128 v[28:31], v8 offset:3072
    ds_read_b64 v[36:37], v9 offset:3072
    ds_read_b128 v[40:43], v10 offset:3072
    ds_read_b128 v[44:47], v10 offset:3840
    s_waitcnt lgkmcnt(0)
    v_mfma_f32_32x32x16_bf16 v[56:71], v[28:31], v[20:23], 0
    v_mfma_f32_32x32x8_bf16 v[56:71], v[36:37], v[24:25], v[56:71]
    s_nop 15
    v_max3_f32 v2, v56, v57, v58
    v_max3_f32 v2, v2, v59, v60
    v_max3_f32 v2, v2, v61, v62
    v_max3_f32 v2, v2, v63, v64
    v_max3_f32 v2, v2, v65, v66
    v_max3_f32 v2, v2, v67, v68
    v_max3_f32 v2, v2, v69, v70
    v_max_f32 v2, v2, v71
    v_mov_b32 v3, v2
    s_nop 1
    v_permlane32_swap_b32 v2, v3
    s_nop 1
    v_max_f32 v2, v2, v3
    v_ceil_f32 v2, v2
    v_add_f32 v2, 0x42a80000, v2
    v_max_f32 v2, 0, v2
    v_add_f32 v3, v16, v2
    v_sub_f32 v2, v3, v16
    v_mov_b32 v16, v3
    v_cvt_i32_f32 v4, v2
    v_sub_u32 v4, 0, v4
    v_sub_f32 v56, v56, v2
    v_sub_f32 v57, v57, v2
    v_sub_f32 v58, v58, v2
    v_sub_f32 v59, v59, v2
    v_sub_f32 v60, v60, v2
    v_sub_f32 v61, v61, v2
    v_sub_f32 v62, v62, v2
    v_sub_f32 v63, v63, v2
    v_sub_f32 v64, v64, v2
    v_sub_f32 v65, v65, v2
    v_sub_f32 v66, v66, v2
    v_sub_f32 v67, v67, v2
    v_sub_f32 v68, v68, v2
    v_sub_f32 v69, v69, v2
    v_sub_f32 v70, v70, v2
    v_sub_f32 v71, v71, v2
    v_ldexp_f32 v104, v104, v4
    v_ldexp_f32 v105, v105, v4
    v_ldexp_f32 v106, v106, v4
    v_ldexp_f32 v107, v107, v4
    v_ldexp_f32 v108, v108, v4
    v_ldexp_f32 v109, v109, v4
    v_ldexp_f32 v110, v110, v4
    v_ldexp_f32 v111, v111, v4
    v_ldexp_f32 v112, v112, v4
    v_ldexp_f32 v113, v113, v4
    v_ldexp_f32 v114, v114, v4
    v_ldexp_f32 v115, v115, v4
    v_and_b32 v2, 0xffff0000, v16
    v_sub_f32 v3, v16, v2
    v_and_b32 v4, 0xffff0000, v3
    v_sub_f32 v3, v3, v4
    v_xor_b32 v2, 0x80000000, v2
    v_xor_b32 v4, 0x80000000, v4
    v_xor_b32 v3, 0x80000000, v3
    v_lshrrev_b32 v2, 16, v2
    v_or_b32 v2, v2, v4
    v_lshrrev_b32 v3, 16, v3
    v_cndmask_b32 v24, v24, v2, s[44:45]
    v_cndmask_b32 v25, v25, v3, s[44:45]
    s_nop 1
    v_exp_f32 v56, v56
    v_exp_f32 v57, v57
    v_exp_f32 v58, v58
    v_exp_f32 v59, v59
    v_exp_f32 v60, v60
    v_exp_f32 v61, v61
    v_exp_f32 v62, v62
    v_exp_f32 v63, v63
    v_exp_f32 v64, v64
    v_exp_f32 v65, v65
    v_exp_f32 v66, v66
    v_exp_f32 v67, v67
    v_exp_f32 v68, v68
    v_exp_f32 v69, v69
    v_exp_f32 v70, v70
    v_exp_f32 v71, v71
    s_nop 0
    v_cvt_pk_bf16_f32 v88, v56, v57
    v_cvt_pk_bf16_f32 v89, v58, v59
    v_cvt_pk_bf16_f32 v90, v60, v61
    v_cvt_pk_bf16_f32 v91, v62, v63
    v_cvt_pk_bf16_f32 v92, v64, v65
    v_cvt_pk_bf16_f32 v93, v66, v67
    v_cvt_pk_bf16_f32 v94, v68, v69
    v_cvt_pk_bf16_f32 v95, v70, v71
    s_nop 1
    v_mfma_f32_32x32x16_bf16 v[104:119], v[40:43], v[88:91], v[104:119]
    v_mfma_f32_32x32x16_bf16 v[104:119], v[44:47], v[92:95], v[104:119]
    s_nop 15
    ds_read_b128 v[28:31], v8 offset:6144
    ds_read_b64 v[36:37], v9 offset:6144
    ds_read_b128 v[40:43], v10 offset:6144
    ds_read_b128 v[44:47], v10 offset:6912
    s_waitcnt lgkmcnt(0)
    v_mfma_f32_32x32x16_bf16 v[56:71], v[28:31], v[20:23], 0
    v_mfma_f32_32x32x8_bf16 v[56:71], v[36:37], v[24:25], v[56:71]
    s_nop 15
    v_max3_f32 v2, v56, v57, v58
    v_max3_f32 v2, v2, v59, v60
    v_max3_f32 v2, v2, v61, v62
    v_max3_f32 v2, v2, v63, v64
    v_max3_f32 v2, v2, v65, v66
    v_max3_f32 v2, v2, v67, v68
    v_max3_f32 v2, v2, v69, v70
    v_max_f32 v2, v2, v71
    v_mov_b32 v3, v2
    s_nop 1
    v_permlane32_swap_b32 v2, v3
    s_nop 1
    v_max_f32 v2, v2, v3
    v_ceil_f32 v2, v2
    v_add_f32 v2, 0x42a80000, v2
    v_max_f32 v2, 0, v2
    v_add_f32 v3, v16, v2
    v_sub_f32 v2, v3, v16
    v_mov_b32 v16, v3
    v_cvt_i32_f32 v4, v2
    v_sub_u32 v4, 0, v4
    v_sub_f32 v56, v56, v2
    v_sub_f32 v57, v57, v2
    v_sub_f32 v58, v58, v2
    v_sub_f32 v59, v59, v2
    v_sub_f32 v60, v60, v2
    v_sub_f32 v61, v61, v2
    v_sub_f32 v62, v62, v2
    v_sub_f32 v63, v63, v2
    v_sub_f32 v64, v64, v2
    v_sub_f32 v65, v65, v2
    v_sub_f32 v66, v66, v2
    v_sub_f32 v67, v67, v2
    v_sub_f32 v68, v68, v2
    v_sub_f32 v69, v69, v2
    v_sub_f32 v70, v70, v2
    v_sub_f32 v71, v71, v2
    v_ldexp_f32 v104, v104, v4
    v_ldexp_f32 v105, v105, v4
    v_ldexp_f32 v106, v106, v4
    v_ldexp_f32 v107, v107, v4
    v_ldexp_f32 v108, v108, v4
    v_ldexp_f32 v109, v109, v4
    v_ldexp_f32 v110, v110, v4
    v_ldexp_f32 v111, v111, v4
    v_ldexp_f32 v112, v112, v4
    v_ldexp_f32 v113, v113, v4
    v_ldexp_f32 v114, v114, v4
    v_ldexp_f32 v115, v115, v4
    v_and_b32 v2, 0xffff0000, v16
    v_sub_f32 v3, v16, v2
    v_and_b32 v4, 0xffff0000, v3
    v_sub_f32 v3, v3, v4
    v_xor_b32 v2, 0x80000000, v2
    v_xor_b32 v4, 0x80000000, v4
    v_xor_b32 v3, 0x80000000, v3
    v_lshrrev_b32 v2, 16, v2
    v_or_b32 v2, v2, v4
    v_lshrrev_b32 v3, 16, v3
    v_cndmask_b32 v24, v24, v2, s[44:45]
    v_cndmask_b32 v25, v25, v3, s[44:45]
    s_nop 1
    v_exp_f32 v56, v56
    v_exp_f32 v57, v57
    v_exp_f32 v58, v58
    v_exp_f32 v59, v59
    v_exp_f32 v60, v60
    v_exp_f32 v61, v61
    v_exp_f32 v62, v62
    v_exp_f32 v63, v63
    v_exp_f32 v64, v64
    v_exp_f32 v65, v65
    v_exp_f32 v66, v66
    v_exp_f32 v67, v67
    v_exp_f32 v68, v68
    v_exp_f32 v69, v69
    v_exp_f32 v70, v70
    v_exp_f32 v71, v71
    s_nop 0
    v_cvt_pk_bf16_f32 v88, v56, v57
    v_cvt_pk_bf16_f32 v89, v58, v59
    v_cvt_pk_bf16_f32 v90, v60, v61
    v_cvt_pk_bf16_f32 v91, v62, v63
    v_cvt_pk_bf16_f32 v92, v64, v65
    v_cvt_pk_bf16_f32 v93, v66, v67
    v_cvt_pk_bf16_f32 v94, v68, v69
    v_cvt_pk_bf16_f32 v95, v70, v71
    s_nop 1
    v_mfma_f32_32x32x16_bf16 v[104:119], v[40:43], v[88:91], v[104:119]
    v_mfma_f32_32x32x16_bf16 v[104:119], v[44:47], v[92:95], v[104:119]
    s_nop 15
    ds_read_b128 v[28:31], v8 offset:9216
    ds_read_b64 v[36:37], v9 offset:9216
    ds_read_b128 v[40:43], v10 offset:9216
    ds_read_b128 v[44:47], v10 offset:9984
    s_waitcnt lgkmcnt(0)
    v_mfma_f32_32x32x16_bf16 v[56:71], v[28:31], v[20:23], 0
    v_mfma_f32_32x32x8_bf16 v[56:71], v[36:37], v[24:25], v[56:71]
    s_nop 15
    v_max3_f32 v2, v56, v57, v58
    v_max3_f32 v2, v2, v59, v60
    v_max3_f32 v2, v2, v61, v62
    v_max3_f32 v2, v2, v63, v64
    v_max3_f32 v2, v2, v65, v66
    v_max3_f32 v2, v2, v67, v68
    v_max3_f32 v2, v2, v69, v70
    v_max_f32 v2, v2, v71
    v_mov_b32 v3, v2
    s_nop 1
    v_permlane32_swap_b32 v2, v3
    s_nop 1
    v_max_f32 v2, v2, v3
    v_ceil_f32 v2, v2
    v_add_f32 v2, 0x42a80000, v2
    v_max_f32 v2, 0, v2
    v_add_f32 v3, v16, v2
    v_sub_f32 v2, v3, v16
    v_mov_b32 v16, v3
    v_cvt_i32_f32 v4, v2
    v_sub_u32 v4, 0, v4
    v_sub_f32 v56, v56, v2
    v_sub_f32 v57, v57, v2
    v_sub_f32 v58, v58, v2
    v_sub_f32 v59, v59, v2
    v_sub_f32 v60, v60, v2
    v_sub_f32 v61, v61, v2
    v_sub_f32 v62, v62, v2
    v_sub_f32 v63, v63, v2
    v_sub_f32 v64, v64, v2
    v_sub_f32 v65, v65, v2
    v_sub_f32 v66, v66, v2
    v_sub_f32 v67, v67, v2
    v_sub_f32 v68, v68, v2
    v_sub_f32 v69, v69, v2
    v_sub_f32 v70, v70, v2
    v_sub_f32 v71, v71, v2
    v_ldexp_f32 v104, v104, v4
    v_ldexp_f32 v105, v105, v4
    v_ldexp_f32 v106, v106, v4
    v_ldexp_f32 v107, v107, v4
    v_ldexp_f32 v108, v108, v4
    v_ldexp_f32 v109, v109, v4
    v_ldexp_f32 v110, v110, v4
    v_ldexp_f32 v111, v111, v4
    v_ldexp_f32 v112, v112, v4
    v_ldexp_f32 v113, v113, v4
    v_ldexp_f32 v114, v114, v4
    v_ldexp_f32 v115, v115, v4
    v_and_b32 v2, 0xffff0000, v16
    v_sub_f32 v3, v16, v2
    v_and_b32 v4, 0xffff0000, v3
    v_sub_f32 v3, v3, v4
    v_xor_b32 v2, 0x80000000, v2
    v_xor_b32 v4, 0x80000000, v4
    v_xor_b32 v3, 0x80000000, v3
    v_lshrrev_b32 v2, 16, v2
    v_or_b32 v2, v2, v4
    v_lshrrev_b32 v3, 16, v3
    v_cndmask_b32 v24, v24, v2, s[44:45]
    v_cndmask_b32 v25, v25, v3, s[44:45]
    s_nop 1
    v_exp_f32 v56, v56
    v_exp_f32 v57, v57
    v_exp_f32 v58, v58
    v_exp_f32 v59, v59
    v_exp_f32 v60, v60
    v_exp_f32 v61, v61
    v_exp_f32 v62, v62
    v_exp_f32 v63, v63
    v_exp_f32 v64, v64
    v_exp_f32 v65, v65
    v_exp_f32 v66, v66
    v_exp_f32 v67, v67
    v_exp_f32 v68, v68
    v_exp_f32 v69, v69
    v_exp_f32 v70, v70
    v_exp_f32 v71, v71
    s_nop 0
    v_cvt_pk_bf16_f32 v88, v56, v57
    v_cvt_pk_bf16_f32 v89, v58, v59
    v_cvt_pk_bf16_f32 v90, v60, v61
    v_cvt_pk_bf16_f32 v91, v62, v63
    v_cvt_pk_bf16_f32 v92, v64, v65
    v_cvt_pk_bf16_f32 v93, v66, v67
    v_cvt_pk_bf16_f32 v94, v68, v69
    v_cvt_pk_bf16_f32 v95, v70, v71
    s_nop 1
    v_mfma_f32_32x32x16_bf16 v[104:119], v[40:43], v[88:91], v[104:119]
    v_mfma_f32_32x32x16_bf16 v[104:119], v[44:47], v[92:95], v[104:119]
    s_nop 15
    s_add_u32 s38, s38, 1
    s_cmp_lt_u32 s38, 16
    s_cbranch_scc1 .fbloop_48
    s_nop 3
    s_lshl_b32 s35, s32, 3
    s_lshl_b32 s36, s34, 1
    s_add_u32 s35, s35, s36
    s_mul_i32 s35, s35, 20480
    v_bfe_u32 v4, v1, 4, 1
    v_mul_u32_u24 v4, 20480, v4
    v_and_b32 v3, 15, v1
    v_lshlrev_b32 v3, 4, v3
    v_add_u32 v4, v4, v3
    v_add_u32 v11, s35, v4
    s_lshr_b32 s35, s33, 1
    s_lshl_b32 s35, s35, 10
    s_and_b32 s36, s33, 1
    s_lshl_b32 s36, s36, 9
    s_add_u32 s35, s35, s36
    v_lshrrev_b32 v3, 5, v1
    v_lshlrev_b32 v3, 8, v3
    v_add3_u32 v12, v11, v3, s35
    s_lshr_b32 s35, s33, 3
    s_add_u32 s35, s35, 16
    s_lshl_b32 s35, s35, 10
    s_and_b32 s36, s33, 7
    s_lshr_b32 s36, s36, 1
    s_lshl_b32 s36, s36, 8
    s_add_u32 s35, s35, s36
    s_and_b32 s36, s33, 1
    s_lshl_b32 s36, s36, 3
    s_add_u32 s35, s35, s36
    v_add_u32 v13, s35, v11
    v_mov_b32 v2, v112
    v_mov_b32 v3, v112
    s_nop 1
    v_permlane32_swap_b32 v2, v3
    s_nop 1
    v_rcp_f32 v3, v3
    s_nop 0
    v_mul_f32 v104, v104, v3
    v_mul_f32 v105, v105, v3
    v_mul_f32 v106, v106, v3
    v_mul_f32 v107, v107, v3
    v_mul_f32 v108, v108, v3
    v_mul_f32 v109, v109, v3
    v_mul_f32 v110, v110, v3
    v_mul_f32 v111, v111, v3
    v_mul_f32 v112, v112, v3
    v_mul_f32 v113, v113, v3
    v_mul_f32 v114, v114, v3
    v_mul_f32 v115, v115, v3
    v_cvt_pk_bf16_f32 v88, v104, v105
    v_cvt_pk_bf16_f32 v89, v106, v107
    v_cvt_pk_bf16_f32 v90, v108, v109
    v_cvt_pk_bf16_f32 v91, v110, v111
    v_cvt_pk_bf16_f32 v92, v112, v113
    v_cvt_pk_bf16_f32 v93, v114, v115
    buffer_store_dwordx4 v[88:91], v12, s[16:19], 0 offen sc1
    s_mov_b64 exec, 0xffffffff
    buffer_store_dwordx2 v[92:93], v13, s[16:19], 0 offen sc1
    s_mov_b64 exec, -1
    s_add_u32 s64, s4, 28377088
    s_addc_u32 s65, s5, 0
    s_mov_b32 s66, 4096
    s_mov_b32 s67, 0x00020000
    s_lshl_b32 s35, s32, 8
    v_mov_b32 v4, s35
    v_mov_b32 v5, 1
    v_mov_b32 v2, 49280
    s_waitcnt vmcnt(0) lgkmcnt(0)
    s_barrier
    v_cmp_eq_u32 vcc, 0, v0
    s_and_saveexec_b64 s[62:63], vcc
    buffer_atomic_add v5, v4, s[64:67], 0 offen
    s_mov_b64 exec, s[62:63]
    s_endpgm
.resc_38:
    s_nop 15
    v_mov_b32 v2, v112
    v_mov_b32 v3, v112
    s_nop 1
    v_permlane32_swap_b32 v2, v3
    s_nop 1
    v_log_f32 v2, v3
    s_nop 0
    v_ceil_f32 v2, v2
    v_add_f32 v2, 0x42a80000, v2
    v_max_f32 v2, 0, v2
    v_add_f32 v3, v16, v2
    v_sub_f32 v2, v3, v16
    v_mov_b32 v16, v3
    v_cvt_i32_f32 v4, v2
    v_sub_u32 v4, 0, v4
    v_sub_f32 v56, v56, v2
    v_sub_f32 v57, v57, v2
    v_sub_f32 v58, v58, v2
    v_sub_f32 v59, v59, v2
    v_sub_f32 v60, v60, v2
    v_sub_f32 v61, v61, v2
    v_sub_f32 v62, v62, v2
    v_sub_f32 v63, v63, v2
    v_sub_f32 v64, v64, v2
    v_sub_f32 v65, v65, v2
    v_sub_f32 v66, v66, v2
    v_sub_f32 v67, v67, v2
    v_sub_f32 v68, v68, v2
    v_sub_f32 v69, v69, v2
    v_sub_f32 v70, v70, v2
    v_sub_f32 v71, v71, v2
    v_ldexp_f32 v104, v104, v4
    v_ldexp_f32 v105, v105, v4
    v_ldexp_f32 v106, v106, v4
    v_ldexp_f32 v107, v107, v4
    v_ldexp_f32 v108, v108, v4
    v_ldexp_f32 v109, v109, v4
    v_ldexp_f32 v110, v110, v4
    v_ldexp_f32 v111, v111, v4
    v_ldexp_f32 v112, v112, v4
    v_ldexp_f32 v113, v113, v4
    v_ldexp_f32 v114, v114, v4
    v_ldexp_f32 v115, v115, v4
    v_lshlrev_b32 v3, 16, v96
    v_and_b32 v5, 0xffff0000, v96
    v_ldexp_f32 v3, v3, v4
    v_ldexp_f32 v5, v5, v4
    v_cvt_pk_bf16_f32 v96, v3, v5
    v_lshlrev_b32 v3, 16, v97
    v_and_b32 v5, 0xffff0000, v97
    v_ldexp_f32 v3, v3, v4
    v_ldexp_f32 v5, v5, v4
    v_cvt_pk_bf16_f32 v97, v3, v5
    v_lshlrev_b32 v3, 16, v98
    v_and_b32 v5, 0xffff0000, v98
    v_ldexp_f32 v3, v3, v4
    v_ldexp_f32 v5, v5, v4
    v_cvt_pk_bf16_f32 v98, v3, v5
    v_lshlrev_b32 v3, 16, v99
    v_and_b32 v5, 0xffff0000, v99
    v_ldexp_f32 v3, v3, v4
    v_ldexp_f32 v5, v5, v4
    v_cvt_pk_bf16_f32 v99, v3, v5
    v_lshlrev_b32 v3, 16, v100
    v_and_b32 v5, 0xffff0000, v100
    v_ldexp_f32 v3, v3, v4
    v_ldexp_f32 v5, v5, v4
    v_cvt_pk_bf16_f32 v100, v3, v5
    v_lshlrev_b32 v3, 16, v101
    v_and_b32 v5, 0xffff0000, v101
    v_ldexp_f32 v3, v3, v4
    v_ldexp_f32 v5, v5, v4
    v_cvt_pk_bf16_f32 v101, v3, v5
    v_lshlrev_b32 v3, 16, v102
    v_and_b32 v5, 0xffff0000, v102
    v_ldexp_f32 v3, v3, v4
    v_ldexp_f32 v5, v5, v4
    v_cvt_pk_bf16_f32 v102, v3, v5
    v_lshlrev_b32 v3, 16, v103
    v_and_b32 v5, 0xffff0000, v103
    v_ldexp_f32 v3, v3, v4
    v_ldexp_f32 v5, v5, v4
    v_cvt_pk_bf16_f32 v103, v3, v5
    v_and_b32 v2, 0xffff0000, v16
    v_sub_f32 v3, v16, v2
    v_and_b32 v4, 0xffff0000, v3
    v_sub_f32 v3, v3, v4
    v_xor_b32 v2, 0x80000000, v2
    v_xor_b32 v4, 0x80000000, v4
    v_xor_b32 v3, 0x80000000, v3
    v_lshrrev_b32 v2, 16, v2
    v_or_b32 v2, v2, v4
    v_lshrrev_b32 v3, 16, v3
    v_cndmask_b32 v24, v24, v2, s[44:45]
    v_cndmask_b32 v25, v25, v3, s[44:45]
    s_nop 1
    s_branch .rback_39
.k2gemm_34:
    s_sub_u32 s69, s2, 512
    s_and_b32 s32, s69, 7
    s_lshl_b32 s32, s32, 2
    s_lshr_b32 s33, s69, 3
    s_and_b32 s33, s33, 3
    s_add_u32 s32, s32, s33
    s_lshr_b32 s33, s69, 5
    s_load_dwordx2 s[14:15], s[0:1], 80
    s_load_dwordx2 s[6:7], s[0:1], 48
    s_load_dwordx2 s[4:5], s[0:1], 0
    s_load_dwordx2 s[10:11], s[0:1], 56
    s_load_dwordx2 s[12:13], s[0:1], 64
    s_load_dwordx2 s[8:9], s[0:1], 72
    v_and_b32 v1, 63, v0
    v_lshrrev_b32 v2, 6, v0
    s_nop 0
    v_readfirstlane_b32 s48, v2
    v_lshlrev_b32 v6, 4, v1
    v_add_u32 v7, 4096, v6
    s_nop 1
    s_add_u32 s49, s48, 0
    s_and_b32 s49, s49, 3
    s_lshl_b32 s50, s32, 2
    s_add_u32 s49, s49, s50
    s_mul_i32 s56, s49, 20480
    s_mul_i32 s60, s49, 49152
    s_add_u32 s49, s48, 1
    s_and_b32 s49, s49, 3
    s_lshl_b32 s50, s32, 2
    s_add_u32 s49, s49, s50
    s_mul_i32 s57, s49, 20480
    s_mul_i32 s61, s49, 49152
    s_add_u32 s49, s48, 2
    s_and_b32 s49, s49, 3
    s_lshl_b32 s50, s32, 2
    s_add_u32 s49, s49, s50
    s_mul_i32 s58, s49, 20480
    s_mul_i32 s62, s49, 49152
    s_add_u32 s49, s48, 3
    s_and_b32 s49, s49, 3
    s_lshl_b32 s50, s32, 2
    s_add_u32 s49, s49, s50
    s_mul_i32 s59, s49, 20480
    s_mul_i32 s63, s49, 49152
    v_add_u32 v2, 0, v1
    v_mul_u32_u24 v3, 6554, v2
    v_lshrrev_b32 v3, 16, v3
    v_mul_u32_u24 v4, 10, v3
    v_sub_u32 v2, v2, v4
    v_lshlrev_b32 v2, 4, v2
    v_bfe_u32 v4, v3, 3, 1
    v_lshlrev_b32 v148, 4, v4
    v_and_b32 v4, 7, v3
    v_add_u32 v148, v148, v4
    v_lshrrev_b32 v4, 4, v3
    v_lshlrev_b32 v4, 3, v4
    v_add_u32 v148, v148, v4
    v_mul_u32_u24 v148, 1280, v148
    v_add_u32 v148, v148, v2
    v_add_u32 v2, 64, v1
    v_mul_u32_u24 v3, 6554, v2
    v_lshrrev_b32 v3, 16, v3
    v_mul_u32_u24 v4, 10, v3
    v_sub_u32 v2, v2, v4
    v_lshlrev_b32 v2, 4, v2
    v_bfe_u32 v4, v3, 3, 1
    v_lshlrev_b32 v149, 4, v4
    v_and_b32 v4, 7, v3
    v_add_u32 v149, v149, v4
    v_lshrrev_b32 v4, 4, v3
    v_lshlrev_b32 v4, 3, v4
    v_add_u32 v149, v149, v4
    v_mul_u32_u24 v149, 1280, v149
    v_add_u32 v149, v149, v2
    v_add_u32 v2, 128, v1
    v_mul_u32_u24 v3, 6554, v2
    v_lshrrev_b32 v3, 16, v3
    v_mul_u32_u24 v4, 10, v3
    v_sub_u32 v2, v2, v4
    v_lshlrev_b32 v2, 4, v2
    v_bfe_u32 v4, v3, 3, 1
    v_lshlrev_b32 v150, 4, v4
    v_and_b32 v4, 7, v3
    v_add_u32 v150, v150, v4
    v_lshrrev_b32 v4, 4, v3
    v_lshlrev_b32 v4, 3, v4
    v_add_u32 v150, v150, v4
    v_mul_u32_u24 v150, 1280, v150
    v_add_u32 v150, v150, v2
    v_add_u32 v2, 192, v1
    v_mul_u32_u24 v3, 6554, v2
    v_lshrrev_b32 v3, 16, v3
    v_mul_u32_u24 v4, 10, v3
    v_sub_u32 v2, v2, v4
    v_lshlrev_b32 v2, 4, v2
    v_bfe_u32 v4, v3, 3, 1
    v_lshlrev_b32 v151, 4, v4
    v_and_b32 v4, 7, v3
    v_add_u32 v151, v151, v4
    v_lshrrev_b32 v4, 4, v3
    v_lshlrev_b32 v4, 3, v4
    v_add_u32 v151, v151, v4
    v_mul_u32_u24 v151, 1280, v151
    v_add_u32 v151, v151, v2
    v_add_u32 v2, 256, v1
    v_mul_u32_u24 v3, 6554, v2
    v_lshrrev_b32 v3, 16, v3
    v_mul_u32_u24 v4, 10, v3
    v_sub_u32 v2, v2, v4
    v_lshlrev_b32 v2, 4, v2
    v_bfe_u32 v4, v3, 3, 1
    v_lshlrev_b32 v152, 4, v4
    v_and_b32 v4, 7, v3
    v_add_u32 v152, v152, v4
    v_lshrrev_b32 v4, 4, v3
    v_lshlrev_b32 v4, 3, v4
    v_add_u32 v152, v152, v4
    v_mul_u32_u24 v152, 1280, v152
    v_add_u32 v152, v152, v2
    s_mul_i32 s52, s48, 10240
    s_waitcnt lgkmcnt(0)
    s_mov_b32 s68, s6
    s_mov_b32 s69, s7
    s_mov_b32 s70, 1966080
    s_mov_b32 s71, 0x00020000
    s_add_u32 s36, s14, 9437184
    s_addc_u32 s37, s15, 0
    s_mov_b32 s38, 6291456
    s_mov_b32 s39, 0x00020000
    s_mul_i32 s53, s48, 12
    s_add_u32 s53, s53, 0
    s_mul_i32 s54, s53, 40960
    s_mul_i32 s49, s33, 160
    s_add_u32 s54, s54, s49
    s_lshl_b32 s53, s53, 10
    s_add_u32 m0, s52, 0
    s_nop 0
    buffer_load_dwordx4 v148, s[68:71], s54 offen lds
    s_add_u32 m0, m0, 1024
    s_nop 0
    buffer_load_dwordx4 v149, s[68:71], s54 offen lds
    s_add_u32 m0, m0, 1024
    s_nop 0
    buffer_load_dwordx4 v150, s[68:71], s54 offen lds
    s_add_u32 m0, m0, 1024
    s_nop 0
    buffer_load_dwordx4 v151, s[68:71], s54 offen lds
    s_add_u32 m0, m0, 1024
    s_nop 0
    buffer_load_dwordx4 v152, s[68:71], s54 offen lds
    s_add_u32 s51, s60, s53
    buffer_load_dwordx4 v[92:95], v6, s[36:39], s51 offen
    s_add_u32 s51, s61, s53
    buffer_load_dwordx4 v[96:99], v6, s[36:39], s51 offen
    s_add_u32 s51, s62, s53
    buffer_load_dwordx4 v[100:103], v6, s[36:39], s51 offen
    s_add_u32 s51, s63, s53
    buffer_load_dwordx4 v[104:107], v6, s[36:39], s51 offen
    s_mul_i32 s53, s48, 12
    s_add_u32 s53, s53, 1
    s_mul_i32 s54, s53, 40960
    s_mul_i32 s49, s33, 160
    s_add_u32 s54, s54, s49
    s_lshl_b32 s53, s53, 10
    s_add_u32 m0, s52, 5120
    s_nop 0
    buffer_load_dwordx4 v148, s[68:71], s54 offen lds
    s_add_u32 m0, m0, 1024
    s_nop 0
    buffer_load_dwordx4 v149, s[68:71], s54 offen lds
    s_add_u32 m0, m0, 1024
    s_nop 0
    buffer_load_dwordx4 v150, s[68:71], s54 offen lds
    s_add_u32 m0, m0, 1024
    s_nop 0
    buffer_load_dwordx4 v151, s[68:71], s54 offen lds
    s_add_u32 m0, m0, 1024
    s_nop 0
    buffer_load_dwordx4 v152, s[68:71], s54 offen lds
    s_add_u32 s51, s60, s53
    buffer_load_dwordx4 v[108:111], v6, s[36:39], s51 offen
    s_add_u32 s51, s61, s53
    buffer_load_dwordx4 v[112:115], v6, s[36:39], s51 offen
    s_add_u32 s51, s62, s53
    buffer_load_dwordx4 v[116:119], v6, s[36:39], s51 offen
    s_add_u32 s51, s63, s53
    buffer_load_dwordx4 v[120:123], v6, s[36:39], s51 offen
    s_lshl_b32 s49, s32, 6
    s_lshl_b32 s50, s48, 4
    s_add_u32 s49, s49, s50
    v_and_b32 v2, 15, v1
    v_add_u32 v2, s49, v2
    v_mul_u32_u24 v2, 1280, v2
    v_lshrrev_b32 v3, 4, v1
    v_lshlrev_b32 v3, 3, v3
    s_mul_i32 s49, s33, 160
    v_add_u32 v9, s49, v3
    v_add_u32 v8, v2, v9
    v_lshrrev_b32 v2, 4, v1
    v_lshlrev_b32 v2, 2, v2
    v_bfe_u32 v3, v1, 2, 2
    v_add_u32 v2, v2, v3
    v_mul_u32_u24 v2, 160, v2
    v_and_b32 v3, 3, v1
    v_lshlrev_b32 v3, 3, v3
    v_add_u32 v2, v2, v3
    v_add_u32 v153, s52, v2
    s_mov_b32 s24, s12
    s_mov_b32 s25, s13
    s_mov_b32 s26, 2621440
    s_mov_b32 s27, 0x00020000
    s_mov_b32 s16, s4
    s_mov_b32 s17, s5
    s_mov_b32 s18, 2621440
    s_mov_b32 s19, 0x00020000
    s_mov_b32 s20, s10
    s_mov_b32 s21, s11
    s_mov_b32 s22, 1280
    s_mov_b32 s23, 0x00020000
    s_add_u32 s40, s14, 27262976
    s_addc_u32 s41, s15, 0
    s_mov_b32 s42, 819200
    s_mov_b32 s43, 0x00020000
    s_add_u32 s28, s14, 15728640
    s_addc_u32 s29, s15, 0
    s_mov_b32 s30, 2621440
    s_mov_b32 s31, 0x00020000
    s_add_u32 s44, s14, 28377088
    s_addc_u32 s45, s15, 0
    s_mov_b32 s46, 4096
    s_mov_b32 s47, 0x00020000
    s_waitcnt vmcnt(9)
    ds_read_b64_tr_b16 v[124:125], v153 offset:0
    ds_read_b64_tr_b16 v[126:127], v153 offset:2560
    ds_read_b64_tr_b16 v[128:129], v153 offset:32
    ds_read_b64_tr_b16 v[130:131], v153 offset:2592
    ds_read_b64_tr_b16 v[132:133], v153 offset:64
    ds_read_b64_tr_b16 v[134:135], v153 offset:2624
    ds_read_b64_tr_b16 v[136:137], v153 offset:96
    ds_read_b64_tr_b16 v[138:139], v153 offset:2656
    ds_read_b64_tr_b16 v[140:141], v153 offset:128
    ds_read_b64_tr_b16 v[142:143], v153 offset:2688
    s_waitcnt lgkmcnt(8)
    v_mfma_f32_16x16x32_bf16 v[12:15], v[124:127], v[92:95], 0
    v_mfma_f32_16x16x32_bf16 v[32:35], v[124:127], v[96:99], 0
    v_mfma_f32_16x16x32_bf16 v[52:55], v[124:127], v[100:103], 0
    v_mfma_f32_16x16x32_bf16 v[72:75], v[124:127], v[104:107], 0
    s_waitcnt lgkmcnt(6)
    v_mfma_f32_16x16x32_bf16 v[16:19], v[128:131], v[92:95], 0
    v_mfma_f32_16x16x32_bf16 v[36:39], v[128:131], v[96:99], 0
    v_mfma_f32_16x16x32_bf16 v[56:59], v[128:131], v[100:103], 0
    v_mfma_f32_16x16x32_bf16 v[76:79], v[128:131], v[104:107], 0
    s_waitcnt lgkmcnt(4)
    v_mfma_f32_16x16x32_bf16 v[20:23], v[132:135], v[92:95], 0
    v_mfma_f32_16x16x32_bf16 v[40:43], v[132:135], v[96:99], 0
    v_mfma_f32_16x16x32_bf16 v[60:63], v[132:135], v[100:103], 0
    v_mfma_f32_16x16x32_bf16 v[80:83], v[132:135], v[104:107], 0
    s_waitcnt lgkmcnt(2)
    v_mfma_f32_16x16x32_bf16 v[24:27], v[136:139], v[92:95], 0
    v_mfma_f32_16x16x32_bf16 v[44:47], v[136:139], v[96:99], 0
    v_mfma_f32_16x16x32_bf16 v[64:67], v[136:139], v[100:103], 0
    v_mfma_f32_16x16x32_bf16 v[84:87], v[136:139], v[104:107], 0
    s_waitcnt lgkmcnt(0)
    v_mfma_f32_16x16x32_bf16 v[28:31], v[140:143], v[92:95], 0
    v_mfma_f32_16x16x32_bf16 v[48:51], v[140:143], v[96:99], 0
    v_mfma_f32_16x16x32_bf16 v[68:71], v[140:143], v[100:103], 0
    v_mfma_f32_16x16x32_bf16 v[88:91], v[140:143], v[104:107], 0
    s_mul_i32 s53, s48, 12
    s_add_u32 s53, s53, 2
    s_mul_i32 s54, s53, 40960
    s_mul_i32 s49, s33, 160
    s_add_u32 s54, s54, s49
    s_lshl_b32 s53, s53, 10
    s_add_u32 m0, s52, 0
    s_nop 0
    buffer_load_dwordx4 v148, s[68:71], s54 offen lds
    s_add_u32 m0, m0, 1024
    s_nop 0
    buffer_load_dwordx4 v149, s[68:71], s54 offen lds
    s_add_u32 m0, m0, 1024
    s_nop 0
    buffer_load_dwordx4 v150, s[68:71], s54 offen lds
    s_add_u32 m0, m0, 1024
    s_nop 0
    buffer_load_dwordx4 v151, s[68:71], s54 offen lds
    s_add_u32 m0, m0, 1024
    s_nop 0
    buffer_load_dwordx4 v152, s[68:71], s54 offen lds
    s_add_u32 s51, s60, s53
    buffer_load_dwordx4 v[92:95], v6, s[36:39], s51 offen
    s_add_u32 s51, s61, s53
    buffer_load_dwordx4 v[96:99], v6, s[36:39], s51 offen
    s_add_u32 s51, s62, s53
    buffer_load_dwordx4 v[100:103], v6, s[36:39], s51 offen
    s_add_u32 s51, s63, s53
    buffer_load_dwordx4 v[104:107], v6, s[36:39], s51 offen
    s_waitcnt vmcnt(9)
    ds_read_b64_tr_b16 v[124:125], v153 offset:5120
    ds_read_b64_tr_b16 v[126:127], v153 offset:7680
    ds_read_b64_tr_b16 v[128:129], v153 offset:5152
    ds_read_b64_tr_b16 v[130:131], v153 offset:7712
    ds_read_b64_tr_b16 v[132:133], v153 offset:5184
    ds_read_b64_tr_b16 v[134:135], v153 offset:7744
    ds_read_b64_tr_b16 v[136:137], v153 offset:5216
    ds_read_b64_tr_b16 v[138:139], v153 offset:7776
    ds_read_b64_tr_b16 v[140:141], v153 offset:5248
    ds_read_b64_tr_b16 v[142:143], v153 offset:7808
    s_waitcnt lgkmcnt(8)
    v_mfma_f32_16x16x32_bf16 v[12:15], v[124:127], v[108:111], v[12:15]
    v_mfma_f32_16x16x32_bf16 v[32:35], v[124:127], v[112:115], v[32:35]
    v_mfma_f32_16x16x32_bf16 v[52:55], v[124:127], v[116:119], v[52:55]
    v_mfma_f32_16x16x32_bf16 v[72:75], v[124:127], v[120:123], v[72:75]
    s_waitcnt lgkmcnt(6)
    v_mfma_f32_16x16x32_bf16 v[16:19], v[128:131], v[108:111], v[16:19]
    v_mfma_f32_16x16x32_bf16 v[36:39], v[128:131], v[112:115], v[36:39]
    v_mfma_f32_16x16x32_bf16 v[56:59], v[128:131], v[116:119], v[56:59]
    v_mfma_f32_16x16x32_bf16 v[76:79], v[128:131], v[120:123], v[76:79]
    s_waitcnt lgkmcnt(4)
    v_mfma_f32_16x16x32_bf16 v[20:23], v[132:135], v[108:111], v[20:23]
    v_mfma_f32_16x16x32_bf16 v[40:43], v[132:135], v[112:115], v[40:43]
    v_mfma_f32_16x16x32_bf16 v[60:63], v[132:135], v[116:119], v[60:63]
    v_mfma_f32_16x16x32_bf16 v[80:83], v[132:135], v[120:123], v[80:83]
    s_waitcnt lgkmcnt(2)
    v_mfma_f32_16x16x32_bf16 v[24:27], v[136:139], v[108:111], v[24:27]
    v_mfma_f32_16x16x32_bf16 v[44:47], v[136:139], v[112:115], v[44:47]
    v_mfma_f32_16x16x32_bf16 v[64:67], v[136:139], v[116:119], v[64:67]
    v_mfma_f32_16x16x32_bf16 v[84:87], v[136:139], v[120:123], v[84:87]
    s_waitcnt lgkmcnt(0)
    v_mfma_f32_16x16x32_bf16 v[28:31], v[140:143], v[108:111], v[28:31]
    v_mfma_f32_16x16x32_bf16 v[48:51], v[140:143], v[112:115], v[48:51]
    v_mfma_f32_16x16x32_bf16 v[68:71], v[140:143], v[116:119], v[68:71]
    v_mfma_f32_16x16x32_bf16 v[88:91], v[140:143], v[120:123], v[88:91]
    s_mul_i32 s53, s48, 12
    s_add_u32 s53, s53, 3
    s_mul_i32 s54, s53, 40960
    s_mul_i32 s49, s33, 160
    s_add_u32 s54, s54, s49
    s_lshl_b32 s53, s53, 10
    s_add_u32 m0, s52, 5120
    s_nop 0
    buffer_load_dwordx4 v148, s[68:71], s54 offen lds
    s_add_u32 m0, m0, 1024
    s_nop 0
    buffer_load_dwordx4 v149, s[68:71], s54 offen lds
    s_add_u32 m0, m0, 1024
    s_nop 0
    buffer_load_dwordx4 v150, s[68:71], s54 offen lds
    s_add_u32 m0, m0, 1024
    s_nop 0
    buffer_load_dwordx4 v151, s[68:71], s54 offen lds
    s_add_u32 m0, m0, 1024
    s_nop 0
    buffer_load_dwordx4 v152, s[68:71], s54 offen lds
    s_add_u32 s51, s60, s53
    buffer_load_dwordx4 v[108:111], v6, s[36:39], s51 offen
    s_add_u32 s51, s61, s53
    buffer_load_dwordx4 v[112:115], v6, s[36:39], s51 offen
    s_add_u32 s51, s62, s53
    buffer_load_dwordx4 v[116:119], v6, s[36:39], s51 offen
    s_add_u32 s51, s63, s53
    buffer_load_dwordx4 v[120:123], v6, s[36:39], s51 offen
    s_waitcnt vmcnt(9)
    ds_read_b64_tr_b16 v[124:125], v153 offset:0
    ds_read_b64_tr_b16 v[126:127], v153 offset:2560
    ds_read_b64_tr_b16 v[128:129], v153 offset:32
    ds_read_b64_tr_b16 v[130:131], v153 offset:2592
    ds_read_b64_tr_b16 v[132:133], v153 offset:64
    ds_read_b64_tr_b16 v[134:135], v153 offset:2624
    ds_read_b64_tr_b16 v[136:137], v153 offset:96
    ds_read_b64_tr_b16 v[138:139], v153 offset:2656
    ds_read_b64_tr_b16 v[140:141], v153 offset:128
    ds_read_b64_tr_b16 v[142:143], v153 offset:2688
    s_waitcnt lgkmcnt(8)
    v_mfma_f32_16x16x32_bf16 v[12:15], v[124:127], v[92:95], v[12:15]
    v_mfma_f32_16x16x32_bf16 v[32:35], v[124:127], v[96:99], v[32:35]
    v_mfma_f32_16x16x32_bf16 v[52:55], v[124:127], v[100:103], v[52:55]
    v_mfma_f32_16x16x32_bf16 v[72:75], v[124:127], v[104:107], v[72:75]
    s_waitcnt lgkmcnt(6)
    v_mfma_f32_16x16x32_bf16 v[16:19], v[128:131], v[92:95], v[16:19]
    v_mfma_f32_16x16x32_bf16 v[36:39], v[128:131], v[96:99], v[36:39]
    v_mfma_f32_16x16x32_bf16 v[56:59], v[128:131], v[100:103], v[56:59]
    v_mfma_f32_16x16x32_bf16 v[76:79], v[128:131], v[104:107], v[76:79]
    s_waitcnt lgkmcnt(4)
    v_mfma_f32_16x16x32_bf16 v[20:23], v[132:135], v[92:95], v[20:23]
    v_mfma_f32_16x16x32_bf16 v[40:43], v[132:135], v[96:99], v[40:43]
    v_mfma_f32_16x16x32_bf16 v[60:63], v[132:135], v[100:103], v[60:63]
    v_mfma_f32_16x16x32_bf16 v[80:83], v[132:135], v[104:107], v[80:83]
    s_waitcnt lgkmcnt(2)
    v_mfma_f32_16x16x32_bf16 v[24:27], v[136:139], v[92:95], v[24:27]
    v_mfma_f32_16x16x32_bf16 v[44:47], v[136:139], v[96:99], v[44:47]
    v_mfma_f32_16x16x32_bf16 v[64:67], v[136:139], v[100:103], v[64:67]
    v_mfma_f32_16x16x32_bf16 v[84:87], v[136:139], v[104:107], v[84:87]
    s_waitcnt lgkmcnt(0)
    v_mfma_f32_16x16x32_bf16 v[28:31], v[140:143], v[92:95], v[28:31]
    v_mfma_f32_16x16x32_bf16 v[48:51], v[140:143], v[96:99], v[48:51]
    v_mfma_f32_16x16x32_bf16 v[68:71], v[140:143], v[100:103], v[68:71]
    v_mfma_f32_16x16x32_bf16 v[88:91], v[140:143], v[104:107], v[88:91]
    s_mul_i32 s53, s48, 12
    s_add_u32 s53, s53, 4
    s_mul_i32 s54, s53, 40960
    s_mul_i32 s49, s33, 160
    s_add_u32 s54, s54, s49
    s_lshl_b32 s53, s53, 10
    s_add_u32 m0, s52, 0
    s_nop 0
    buffer_load_dwordx4 v148, s[68:71], s54 offen lds
    s_add_u32 m0, m0, 1024
    s_nop 0
    buffer_load_dwordx4 v149, s[68:71], s54 offen lds
    s_add_u32 m0, m0, 1024
    s_nop 0
    buffer_load_dwordx4 v150, s[68:71], s54 offen lds
    s_add_u32 m0, m0, 1024
    s_nop 0
    buffer_load_dwordx4 v151, s[68:71], s54 offen lds
    s_add_u32 m0, m0, 1024
    s_nop 0
    buffer_load_dwordx4 v152, s[68:71], s54 offen lds
    s_add_u32 s51, s60, s53
    buffer_load_dwordx4 v[92:95], v6, s[36:39], s51 offen
    s_add_u32 s51, s61, s53
    buffer_load_dwordx4 v[96:99], v6, s[36:39], s51 offen
    s_add_u32 s51, s62, s53
    buffer_load_dwordx4 v[100:103], v6, s[36:39], s51 offen
    s_add_u32 s51, s63, s53
    buffer_load_dwordx4 v[104:107], v6, s[36:39], s51 offen
    s_waitcnt vmcnt(9)
    ds_read_b64_tr_b16 v[124:125], v153 offset:5120
    ds_read_b64_tr_b16 v[126:127], v153 offset:7680
    ds_read_b64_tr_b16 v[128:129], v153 offset:5152
    ds_read_b64_tr_b16 v[130:131], v153 offset:7712
    ds_read_b64_tr_b16 v[132:133], v153 offset:5184
    ds_read_b64_tr_b16 v[134:135], v153 offset:7744
    ds_read_b64_tr_b16 v[136:137], v153 offset:5216
    ds_read_b64_tr_b16 v[138:139], v153 offset:7776
    ds_read_b64_tr_b16 v[140:141], v153 offset:5248
    ds_read_b64_tr_b16 v[142:143], v153 offset:7808
    s_waitcnt lgkmcnt(8)
    v_mfma_f32_16x16x32_bf16 v[12:15], v[124:127], v[108:111], v[12:15]
    v_mfma_f32_16x16x32_bf16 v[32:35], v[124:127], v[112:115], v[32:35]
    v_mfma_f32_16x16x32_bf16 v[52:55], v[124:127], v[116:119], v[52:55]
    v_mfma_f32_16x16x32_bf16 v[72:75], v[124:127], v[120:123], v[72:75]
    s_waitcnt lgkmcnt(6)
    v_mfma_f32_16x16x32_bf16 v[16:19], v[128:131], v[108:111], v[16:19]
    v_mfma_f32_16x16x32_bf16 v[36:39], v[128:131], v[112:115], v[36:39]
    v_mfma_f32_16x16x32_bf16 v[56:59], v[128:131], v[116:119], v[56:59]
    v_mfma_f32_16x16x32_bf16 v[76:79], v[128:131], v[120:123], v[76:79]
    s_waitcnt lgkmcnt(4)
    v_mfma_f32_16x16x32_bf16 v[20:23], v[132:135], v[108:111], v[20:23]
    v_mfma_f32_16x16x32_bf16 v[40:43], v[132:135], v[112:115], v[40:43]
    v_mfma_f32_16x16x32_bf16 v[60:63], v[132:135], v[116:119], v[60:63]
    v_mfma_f32_16x16x32_bf16 v[80:83], v[132:135], v[120:123], v[80:83]
    s_waitcnt lgkmcnt(2)
    v_mfma_f32_16x16x32_bf16 v[24:27], v[136:139], v[108:111], v[24:27]
    v_mfma_f32_16x16x32_bf16 v[44:47], v[136:139], v[112:115], v[44:47]
    v_mfma_f32_16x16x32_bf16 v[64:67], v[136:139], v[116:119], v[64:67]
    v_mfma_f32_16x16x32_bf16 v[84:87], v[136:139], v[120:123], v[84:87]
    s_waitcnt lgkmcnt(0)
    v_mfma_f32_16x16x32_bf16 v[28:31], v[140:143], v[108:111], v[28:31]
    v_mfma_f32_16x16x32_bf16 v[48:51], v[140:143], v[112:115], v[48:51]
    v_mfma_f32_16x16x32_bf16 v[68:71], v[140:143], v[116:119], v[68:71]
    v_mfma_f32_16x16x32_bf16 v[88:91], v[140:143], v[120:123], v[88:91]
    s_mul_i32 s53, s48, 12
    s_add_u32 s53, s53, 5
    s_mul_i32 s54, s53, 40960
    s_mul_i32 s49, s33, 160
    s_add_u32 s54, s54, s49
    s_lshl_b32 s53, s53, 10
    s_add_u32 m0, s52, 5120
    s_nop 0
    buffer_load_dwordx4 v148, s[68:71], s54 offen lds
    s_add_u32 m0, m0, 1024
    s_nop 0
    buffer_load_dwordx4 v149, s[68:71], s54 offen lds
    s_add_u32 m0, m0, 1024
    s_nop 0
    buffer_load_dwordx4 v150, s[68:71], s54 offen lds
    s_add_u32 m0, m0, 1024
    s_nop 0
    buffer_load_dwordx4 v151, s[68:71], s54 offen lds
    s_add_u32 m0, m0, 1024
    s_nop 0
    buffer_load_dwordx4 v152, s[68:71], s54 offen lds
    s_add_u32 s51, s60, s53
    buffer_load_dwordx4 v[108:111], v6, s[36:39], s51 offen
    s_add_u32 s51, s61, s53
    buffer_load_dwordx4 v[112:115], v6, s[36:39], s51 offen
    s_add_u32 s51, s62, s53
    buffer_load_dwordx4 v[116:119], v6, s[36:39], s51 offen
    s_add_u32 s51, s63, s53
    buffer_load_dwordx4 v[120:123], v6, s[36:39], s51 offen
    s_waitcnt vmcnt(9)
    ds_read_b64_tr_b16 v[124:125], v153 offset:0
    ds_read_b64_tr_b16 v[126:127], v153 offset:2560
    ds_read_b64_tr_b16 v[128:129], v153 offset:32
    ds_read_b64_tr_b16 v[130:131], v153 offset:2592
    ds_read_b64_tr_b16 v[132:133], v153 offset:64
    ds_read_b64_tr_b16 v[134:135], v153 offset:2624
    ds_read_b64_tr_b16 v[136:137], v153 offset:96
    ds_read_b64_tr_b16 v[138:139], v153 offset:2656
    ds_read_b64_tr_b16 v[140:141], v153 offset:128
    ds_read_b64_tr_b16 v[142:143], v153 offset:2688
    s_waitcnt lgkmcnt(8)
    v_mfma_f32_16x16x32_bf16 v[12:15], v[124:127], v[92:95], v[12:15]
    v_mfma_f32_16x16x32_bf16 v[32:35], v[124:127], v[96:99], v[32:35]
    v_mfma_f32_16x16x32_bf16 v[52:55], v[124:127], v[100:103], v[52:55]
    v_mfma_f32_16x16x32_bf16 v[72:75], v[124:127], v[104:107], v[72:75]
    s_waitcnt lgkmcnt(6)
    v_mfma_f32_16x16x32_bf16 v[16:19], v[128:131], v[92:95], v[16:19]
    v_mfma_f32_16x16x32_bf16 v[36:39], v[128:131], v[96:99], v[36:39]
    v_mfma_f32_16x16x32_bf16 v[56:59], v[128:131], v[100:103], v[56:59]
    v_mfma_f32_16x16x32_bf16 v[76:79], v[128:131], v[104:107], v[76:79]
    s_waitcnt lgkmcnt(4)
    v_mfma_f32_16x16x32_bf16 v[20:23], v[132:135], v[92:95], v[20:23]
    v_mfma_f32_16x16x32_bf16 v[40:43], v[132:135], v[96:99], v[40:43]
    v_mfma_f32_16x16x32_bf16 v[60:63], v[132:135], v[100:103], v[60:63]
    v_mfma_f32_16x16x32_bf16 v[80:83], v[132:135], v[104:107], v[80:83]
    s_waitcnt lgkmcnt(2)
    v_mfma_f32_16x16x32_bf16 v[24:27], v[136:139], v[92:95], v[24:27]
    v_mfma_f32_16x16x32_bf16 v[44:47], v[136:139], v[96:99], v[44:47]
    v_mfma_f32_16x16x32_bf16 v[64:67], v[136:139], v[100:103], v[64:67]
    v_mfma_f32_16x16x32_bf16 v[84:87], v[136:139], v[104:107], v[84:87]
    s_waitcnt lgkmcnt(0)
    v_mfma_f32_16x16x32_bf16 v[28:31], v[140:143], v[92:95], v[28:31]
    v_mfma_f32_16x16x32_bf16 v[48:51], v[140:143], v[96:99], v[48:51]
    v_mfma_f32_16x16x32_bf16 v[68:71], v[140:143], v[100:103], v[68:71]
    v_mfma_f32_16x16x32_bf16 v[88:91], v[140:143], v[104:107], v[88:91]
    s_mul_i32 s53, s48, 12
    s_add_u32 s53, s53, 6
    s_mul_i32 s54, s53, 40960
    s_mul_i32 s49, s33, 160
    s_add_u32 s54, s54, s49
    s_lshl_b32 s53, s53, 10
    s_add_u32 m0, s52, 0
    s_nop 0
    buffer_load_dwordx4 v148, s[68:71], s54 offen lds
    s_add_u32 m0, m0, 1024
    s_nop 0
    buffer_load_dwordx4 v149, s[68:71], s54 offen lds
    s_add_u32 m0, m0, 1024
    s_nop 0
    buffer_load_dwordx4 v150, s[68:71], s54 offen lds
    s_add_u32 m0, m0, 1024
    s_nop 0
    buffer_load_dwordx4 v151, s[68:71], s54 offen lds
    s_add_u32 m0, m0, 1024
    s_nop 0
    buffer_load_dwordx4 v152, s[68:71], s54 offen lds
    s_add_u32 s51, s60, s53
    buffer_load_dwordx4 v[92:95], v6, s[36:39], s51 offen
    s_add_u32 s51, s61, s53
    buffer_load_dwordx4 v[96:99], v6, s[36:39], s51 offen
    s_add_u32 s51, s62, s53
    buffer_load_dwordx4 v[100:103], v6, s[36:39], s51 offen
    s_add_u32 s51, s63, s53
    buffer_load_dwordx4 v[104:107], v6, s[36:39], s51 offen
    s_waitcnt vmcnt(9)
    ds_read_b64_tr_b16 v[124:125], v153 offset:5120
    ds_read_b64_tr_b16 v[126:127], v153 offset:7680
    ds_read_b64_tr_b16 v[128:129], v153 offset:5152
    ds_read_b64_tr_b16 v[130:131], v153 offset:7712
    ds_read_b64_tr_b16 v[132:133], v153 offset:5184
    ds_read_b64_tr_b16 v[134:135], v153 offset:7744
    ds_read_b64_tr_b16 v[136:137], v153 offset:5216
    ds_read_b64_tr_b16 v[138:139], v153 offset:7776
    ds_read_b64_tr_b16 v[140:141], v153 offset:5248
    ds_read_b64_tr_b16 v[142:143], v153 offset:7808
    s_waitcnt lgkmcnt(8)
    v_mfma_f32_16x16x32_bf16 v[12:15], v[124:127], v[108:111], v[12:15]
    v_mfma_f32_16x16x32_bf16 v[32:35], v[124:127], v[112:115], v[32:35]
    v_mfma_f32_16x16x32_bf16 v[52:55], v[124:127], v[116:119], v[52:55]
    v_mfma_f32_16x16x32_bf16 v[72:75], v[124:127], v[120:123], v[72:75]
    s_waitcnt lgkmcnt(6)
    v_mfma_f32_16x16x32_bf16 v[16:19], v[128:131], v[108:111], v[16:19]
    v_mfma_f32_16x16x32_bf16 v[36:39], v[128:131], v[112:115], v[36:39]
    v_mfma_f32_16x16x32_bf16 v[56:59], v[128:131], v[116:119], v[56:59]
    v_mfma_f32_16x16x32_bf16 v[76:79], v[128:131], v[120:123], v[76:79]
    s_waitcnt lgkmcnt(4)
    v_mfma_f32_16x16x32_bf16 v[20:23], v[132:135], v[108:111], v[20:23]
    v_mfma_f32_16x16x32_bf16 v[40:43], v[132:135], v[112:115], v[40:43]
    v_mfma_f32_16x16x32_bf16 v[60:63], v[132:135], v[116:119], v[60:63]
    v_mfma_f32_16x16x32_bf16 v[80:83], v[132:135], v[120:123], v[80:83]
    s_waitcnt lgkmcnt(2)
    v_mfma_f32_16x16x32_bf16 v[24:27], v[136:139], v[108:111], v[24:27]
    v_mfma_f32_16x16x32_bf16 v[44:47], v[136:139], v[112:115], v[44:47]
    v_mfma_f32_16x16x32_bf16 v[64:67], v[136:139], v[116:119], v[64:67]
    v_mfma_f32_16x16x32_bf16 v[84:87], v[136:139], v[120:123], v[84:87]
    s_waitcnt lgkmcnt(0)
    v_mfma_f32_16x16x32_bf16 v[28:31], v[140:143], v[108:111], v[28:31]
    v_mfma_f32_16x16x32_bf16 v[48:51], v[140:143], v[112:115], v[48:51]
    v_mfma_f32_16x16x32_bf16 v[68:71], v[140:143], v[116:119], v[68:71]
    v_mfma_f32_16x16x32_bf16 v[88:91], v[140:143], v[120:123], v[88:91]
    s_mul_i32 s53, s48, 12
    s_add_u32 s53, s53, 7
    s_mul_i32 s54, s53, 40960
    s_mul_i32 s49, s33, 160
    s_add_u32 s54, s54, s49
    s_lshl_b32 s53, s53, 10
    s_add_u32 m0, s52, 5120
    s_nop 0
    buffer_load_dwordx4 v148, s[68:71], s54 offen lds
    s_add_u32 m0, m0, 1024
    s_nop 0
    buffer_load_dwordx4 v149, s[68:71], s54 offen lds
    s_add_u32 m0, m0, 1024
    s_nop 0
    buffer_load_dwordx4 v150, s[68:71], s54 offen lds
    s_add_u32 m0, m0, 1024
    s_nop 0
    buffer_load_dwordx4 v151, s[68:71], s54 offen lds
    s_add_u32 m0, m0, 1024
    s_nop 0
    buffer_load_dwordx4 v152, s[68:71], s54 offen lds
    s_add_u32 s51, s60, s53
    buffer_load_dwordx4 v[108:111], v6, s[36:39], s51 offen
    s_add_u32 s51, s61, s53
    buffer_load_dwordx4 v[112:115], v6, s[36:39], s51 offen
    s_add_u32 s51, s62, s53
    buffer_load_dwordx4 v[116:119], v6, s[36:39], s51 offen
    s_add_u32 s51, s63, s53
    buffer_load_dwordx4 v[120:123], v6, s[36:39], s51 offen
    s_waitcnt vmcnt(9)
    ds_read_b64_tr_b16 v[124:125], v153 offset:0
    ds_read_b64_tr_b16 v[126:127], v153 offset:2560
    ds_read_b64_tr_b16 v[128:129], v153 offset:32
    ds_read_b64_tr_b16 v[130:131], v153 offset:2592
    ds_read_b64_tr_b16 v[132:133], v153 offset:64
    ds_read_b64_tr_b16 v[134:135], v153 offset:2624
    ds_read_b64_tr_b16 v[136:137], v153 offset:96
    ds_read_b64_tr_b16 v[138:139], v153 offset:2656
    ds_read_b64_tr_b16 v[140:141], v153 offset:128
    ds_read_b64_tr_b16 v[142:143], v153 offset:2688
    s_waitcnt lgkmcnt(8)
    v_mfma_f32_16x16x32_bf16 v[12:15], v[124:127], v[92:95], v[12:15]
    v_mfma_f32_16x16x32_bf16 v[32:35], v[124:127], v[96:99], v[32:35]
    v_mfma_f32_16x16x32_bf16 v[52:55], v[124:127], v[100:103], v[52:55]
    v_mfma_f32_16x16x32_bf16 v[72:75], v[124:127], v[104:107], v[72:75]
    s_waitcnt lgkmcnt(6)
    v_mfma_f32_16x16x32_bf16 v[16:19], v[128:131], v[92:95], v[16:19]
    v_mfma_f32_16x16x32_bf16 v[36:39], v[128:131], v[96:99], v[36:39]
    v_mfma_f32_16x16x32_bf16 v[56:59], v[128:131], v[100:103], v[56:59]
    v_mfma_f32_16x16x32_bf16 v[76:79], v[128:131], v[104:107], v[76:79]
    s_waitcnt lgkmcnt(4)
    v_mfma_f32_16x16x32_bf16 v[20:23], v[132:135], v[92:95], v[20:23]
    v_mfma_f32_16x16x32_bf16 v[40:43], v[132:135], v[96:99], v[40:43]
    v_mfma_f32_16x16x32_bf16 v[60:63], v[132:135], v[100:103], v[60:63]
    v_mfma_f32_16x16x32_bf16 v[80:83], v[132:135], v[104:107], v[80:83]
    s_waitcnt lgkmcnt(2)
    v_mfma_f32_16x16x32_bf16 v[24:27], v[136:139], v[92:95], v[24:27]
    v_mfma_f32_16x16x32_bf16 v[44:47], v[136:139], v[96:99], v[44:47]
    v_mfma_f32_16x16x32_bf16 v[64:67], v[136:139], v[100:103], v[64:67]
    v_mfma_f32_16x16x32_bf16 v[84:87], v[136:139], v[104:107], v[84:87]
    s_waitcnt lgkmcnt(0)
    v_mfma_f32_16x16x32_bf16 v[28:31], v[140:143], v[92:95], v[28:31]
    v_mfma_f32_16x16x32_bf16 v[48:51], v[140:143], v[96:99], v[48:51]
    v_mfma_f32_16x16x32_bf16 v[68:71], v[140:143], v[100:103], v[68:71]
    v_mfma_f32_16x16x32_bf16 v[88:91], v[140:143], v[104:107], v[88:91]
    s_mul_i32 s53, s48, 12
    s_add_u32 s53, s53, 8
    s_mul_i32 s54, s53, 40960
    s_mul_i32 s49, s33, 160
    s_add_u32 s54, s54, s49
    s_lshl_b32 s53, s53, 10
    s_add_u32 m0, s52, 0
    s_nop 0
    buffer_load_dwordx4 v148, s[68:71], s54 offen lds
    s_add_u32 m0, m0, 1024
    s_nop 0
    buffer_load_dwordx4 v149, s[68:71], s54 offen lds
    s_add_u32 m0, m0, 1024
    s_nop 0
    buffer_load_dwordx4 v150, s[68:71], s54 offen lds
    s_add_u32 m0, m0, 1024
    s_nop 0
    buffer_load_dwordx4 v151, s[68:71], s54 offen lds
    s_add_u32 m0, m0, 1024
    s_nop 0
    buffer_load_dwordx4 v152, s[68:71], s54 offen lds
    s_add_u32 s51, s60, s53
    buffer_load_dwordx4 v[92:95], v6, s[36:39], s51 offen
    s_add_u32 s51, s61, s53
    buffer_load_dwordx4 v[96:99], v6, s[36:39], s51 offen
    s_add_u32 s51, s62, s53
    buffer_load_dwordx4 v[100:103], v6, s[36:39], s51 offen
    s_add_u32 s51, s63, s53
    buffer_load_dwordx4 v[104:107], v6, s[36:39], s51 offen
    s_waitcnt vmcnt(9)
    ds_read_b64_tr_b16 v[124:125], v153 offset:5120
    ds_read_b64_tr_b16 v[126:127], v153 offset:7680
    ds_read_b64_tr_b16 v[128:129], v153 offset:5152
    ds_read_b64_tr_b16 v[130:131], v153 offset:7712
    ds_read_b64_tr_b16 v[132:133], v153 offset:5184
    ds_read_b64_tr_b16 v[134:135], v153 offset:7744
    ds_read_b64_tr_b16 v[136:137], v153 offset:5216
    ds_read_b64_tr_b16 v[138:139], v153 offset:7776
    ds_read_b64_tr_b16 v[140:141], v153 offset:5248
    ds_read_b64_tr_b16 v[142:143], v153 offset:7808
    s_waitcnt lgkmcnt(8)
    v_mfma_f32_16x16x32_bf16 v[12:15], v[124:127], v[108:111], v[12:15]
    v_mfma_f32_16x16x32_bf16 v[32:35], v[124:127], v[112:115], v[32:35]
    v_mfma_f32_16x16x32_bf16 v[52:55], v[124:127], v[116:119], v[52:55]
    v_mfma_f32_16x16x32_bf16 v[72:75], v[124:127], v[120:123], v[72:75]
    s_waitcnt lgkmcnt(6)
    v_mfma_f32_16x16x32_bf16 v[16:19], v[128:131], v[108:111], v[16:19]
    v_mfma_f32_16x16x32_bf16 v[36:39], v[128:131], v[112:115], v[36:39]
    v_mfma_f32_16x16x32_bf16 v[56:59], v[128:131], v[116:119], v[56:59]
    v_mfma_f32_16x16x32_bf16 v[76:79], v[128:131], v[120:123], v[76:79]
    s_waitcnt lgkmcnt(4)
    v_mfma_f32_16x16x32_bf16 v[20:23], v[132:135], v[108:111], v[20:23]
    v_mfma_f32_16x16x32_bf16 v[40:43], v[132:135], v[112:115], v[40:43]
    v_mfma_f32_16x16x32_bf16 v[60:63], v[132:135], v[116:119], v[60:63]
    v_mfma_f32_16x16x32_bf16 v[80:83], v[132:135], v[120:123], v[80:83]
    s_waitcnt lgkmcnt(2)
    v_mfma_f32_16x16x32_bf16 v[24:27], v[136:139], v[108:111], v[24:27]
    v_mfma_f32_16x16x32_bf16 v[44:47], v[136:139], v[112:115], v[44:47]
    v_mfma_f32_16x16x32_bf16 v[64:67], v[136:139], v[116:119], v[64:67]
    v_mfma_f32_16x16x32_bf16 v[84:87], v[136:139], v[120:123], v[84:87]
    s_waitcnt lgkmcnt(0)
    v_mfma_f32_16x16x32_bf16 v[28:31], v[140:143], v[108:111], v[28:31]
    v_mfma_f32_16x16x32_bf16 v[48:51], v[140:143], v[112:115], v[48:51]
    v_mfma_f32_16x16x32_bf16 v[68:71], v[140:143], v[116:119], v[68:71]
    v_mfma_f32_16x16x32_bf16 v[88:91], v[140:143], v[120:123], v[88:91]
    s_mul_i32 s53, s48, 12
    s_add_u32 s53, s53, 9
    s_mul_i32 s54, s53, 40960
    s_mul_i32 s49, s33, 160
    s_add_u32 s54, s54, s49
    s_lshl_b32 s53, s53, 10
    s_add_u32 m0, s52, 5120
    s_nop 0
    buffer_load_dwordx4 v148, s[68:71], s54 offen lds
    s_add_u32 m0, m0, 1024
    s_nop 0
    buffer_load_dwordx4 v149, s[68:71], s54 offen lds
    s_add_u32 m0, m0, 1024
    s_nop 0
    buffer_load_dwordx4 v150, s[68:71], s54 offen lds
    s_add_u32 m0, m0, 1024
    s_nop 0
    buffer_load_dwordx4 v151, s[68:71], s54 offen lds
    s_add_u32 m0, m0, 1024
    s_nop 0
    buffer_load_dwordx4 v152, s[68:71], s54 offen lds
    s_add_u32 s51, s60, s53
    buffer_load_dwordx4 v[108:111], v6, s[36:39], s51 offen
    s_add_u32 s51, s61, s53
    buffer_load_dwordx4 v[112:115], v6, s[36:39], s51 offen
    s_add_u32 s51, s62, s53
    buffer_load_dwordx4 v[116:119], v6, s[36:39], s51 offen
    s_add_u32 s51, s63, s53
    buffer_load_dwordx4 v[120:123], v6, s[36:39], s51 offen
    s_waitcnt vmcnt(9)
    ds_read_b64_tr_b16 v[124:125], v153 offset:0
    ds_read_b64_tr_b16 v[126:127], v153 offset:2560
    ds_read_b64_tr_b16 v[128:129], v153 offset:32
    ds_read_b64_tr_b16 v[130:131], v153 offset:2592
    ds_read_b64_tr_b16 v[132:133], v153 offset:64
    ds_read_b64_tr_b16 v[134:135], v153 offset:2624
    ds_read_b64_tr_b16 v[136:137], v153 offset:96
    ds_read_b64_tr_b16 v[138:139], v153 offset:2656
    ds_read_b64_tr_b16 v[140:141], v153 offset:128
    ds_read_b64_tr_b16 v[142:143], v153 offset:2688
    s_waitcnt lgkmcnt(8)
    v_mfma_f32_16x16x32_bf16 v[12:15], v[124:127], v[92:95], v[12:15]
    v_mfma_f32_16x16x32_bf16 v[32:35], v[124:127], v[96:99], v[32:35]
    v_mfma_f32_16x16x32_bf16 v[52:55], v[124:127], v[100:103], v[52:55]
    v_mfma_f32_16x16x32_bf16 v[72:75], v[124:127], v[104:107], v[72:75]
    s_waitcnt lgkmcnt(6)
    v_mfma_f32_16x16x32_bf16 v[16:19], v[128:131], v[92:95], v[16:19]
    v_mfma_f32_16x16x32_bf16 v[36:39], v[128:131], v[96:99], v[36:39]
    v_mfma_f32_16x16x32_bf16 v[56:59], v[128:131], v[100:103], v[56:59]
    v_mfma_f32_16x16x32_bf16 v[76:79], v[128:131], v[104:107], v[76:79]
    s_waitcnt lgkmcnt(4)
    v_mfma_f32_16x16x32_bf16 v[20:23], v[132:135], v[92:95], v[20:23]
    v_mfma_f32_16x16x32_bf16 v[40:43], v[132:135], v[96:99], v[40:43]
    v_mfma_f32_16x16x32_bf16 v[60:63], v[132:135], v[100:103], v[60:63]
    v_mfma_f32_16x16x32_bf16 v[80:83], v[132:135], v[104:107], v[80:83]
    s_waitcnt lgkmcnt(2)
    v_mfma_f32_16x16x32_bf16 v[24:27], v[136:139], v[92:95], v[24:27]
    v_mfma_f32_16x16x32_bf16 v[44:47], v[136:139], v[96:99], v[44:47]
    v_mfma_f32_16x16x32_bf16 v[64:67], v[136:139], v[100:103], v[64:67]
    v_mfma_f32_16x16x32_bf16 v[84:87], v[136:139], v[104:107], v[84:87]
    s_waitcnt lgkmcnt(0)
    v_mfma_f32_16x16x32_bf16 v[28:31], v[140:143], v[92:95], v[28:31]
    v_mfma_f32_16x16x32_bf16 v[48:51], v[140:143], v[96:99], v[48:51]
    v_mfma_f32_16x16x32_bf16 v[68:71], v[140:143], v[100:103], v[68:71]
    v_mfma_f32_16x16x32_bf16 v[88:91], v[140:143], v[104:107], v[88:91]
    s_mul_i32 s53, s48, 12
    s_add_u32 s53, s53, 10
    s_mul_i32 s54, s53, 40960
    s_mul_i32 s49, s33, 160
    s_add_u32 s54, s54, s49
    s_lshl_b32 s53, s53, 10
    s_add_u32 m0, s52, 0
    s_nop 0
    buffer_load_dwordx4 v148, s[68:71], s54 offen lds
    s_add_u32 m0, m0, 1024
    s_nop 0
    buffer_load_dwordx4 v149, s[68:71], s54 offen lds
    s_add_u32 m0, m0, 1024
    s_nop 0
    buffer_load_dwordx4 v150, s[68:71], s54 offen lds
    s_add_u32 m0, m0, 1024
    s_nop 0
    buffer_load_dwordx4 v151, s[68:71], s54 offen lds
    s_add_u32 m0, m0, 1024
    s_nop 0
    buffer_load_dwordx4 v152, s[68:71], s54 offen lds
    s_add_u32 s51, s60, s53
    buffer_load_dwordx4 v[92:95], v6, s[36:39], s51 offen
    s_add_u32 s51, s61, s53
    buffer_load_dwordx4 v[96:99], v6, s[36:39], s51 offen
    s_add_u32 s51, s62, s53
    buffer_load_dwordx4 v[100:103], v6, s[36:39], s51 offen
    s_add_u32 s51, s63, s53
    buffer_load_dwordx4 v[104:107], v6, s[36:39], s51 offen
    s_waitcnt vmcnt(9)
    ds_read_b64_tr_b16 v[124:125], v153 offset:5120
    ds_read_b64_tr_b16 v[126:127], v153 offset:7680
    ds_read_b64_tr_b16 v[128:129], v153 offset:5152
    ds_read_b64_tr_b16 v[130:131], v153 offset:7712
    ds_read_b64_tr_b16 v[132:133], v153 offset:5184
    ds_read_b64_tr_b16 v[134:135], v153 offset:7744
    ds_read_b64_tr_b16 v[136:137], v153 offset:5216
    ds_read_b64_tr_b16 v[138:139], v153 offset:7776
    ds_read_b64_tr_b16 v[140:141], v153 offset:5248
    ds_read_b64_tr_b16 v[142:143], v153 offset:7808
    s_waitcnt lgkmcnt(8)
    v_mfma_f32_16x16x32_bf16 v[12:15], v[124:127], v[108:111], v[12:15]
    v_mfma_f32_16x16x32_bf16 v[32:35], v[124:127], v[112:115], v[32:35]
    v_mfma_f32_16x16x32_bf16 v[52:55], v[124:127], v[116:119], v[52:55]
    v_mfma_f32_16x16x32_bf16 v[72:75], v[124:127], v[120:123], v[72:75]
    s_waitcnt lgkmcnt(6)
    v_mfma_f32_16x16x32_bf16 v[16:19], v[128:131], v[108:111], v[16:19]
    v_mfma_f32_16x16x32_bf16 v[36:39], v[128:131], v[112:115], v[36:39]
    v_mfma_f32_16x16x32_bf16 v[56:59], v[128:131], v[116:119], v[56:59]
    v_mfma_f32_16x16x32_bf16 v[76:79], v[128:131], v[120:123], v[76:79]
    s_waitcnt lgkmcnt(4)
    v_mfma_f32_16x16x32_bf16 v[20:23], v[132:135], v[108:111], v[20:23]
    v_mfma_f32_16x16x32_bf16 v[40:43], v[132:135], v[112:115], v[40:43]
    v_mfma_f32_16x16x32_bf16 v[60:63], v[132:135], v[116:119], v[60:63]
    v_mfma_f32_16x16x32_bf16 v[80:83], v[132:135], v[120:123], v[80:83]
    s_waitcnt lgkmcnt(2)
    v_mfma_f32_16x16x32_bf16 v[24:27], v[136:139], v[108:111], v[24:27]
    v_mfma_f32_16x16x32_bf16 v[44:47], v[136:139], v[112:115], v[44:47]
    v_mfma_f32_16x16x32_bf16 v[64:67], v[136:139], v[116:119], v[64:67]
    v_mfma_f32_16x16x32_bf16 v[84:87], v[136:139], v[120:123], v[84:87]
    s_waitcnt lgkmcnt(0)
    v_mfma_f32_16x16x32_bf16 v[28:31], v[140:143], v[108:111], v[28:31]
    v_mfma_f32_16x16x32_bf16 v[48:51], v[140:143], v[112:115], v[48:51]
    v_mfma_f32_16x16x32_bf16 v[68:71], v[140:143], v[116:119], v[68:71]
    v_mfma_f32_16x16x32_bf16 v[88:91], v[140:143], v[120:123], v[88:91]
    s_mul_i32 s53, s48, 12
    s_add_u32 s53, s53, 11
    s_mul_i32 s54, s53, 40960
    s_mul_i32 s49, s33, 160
    s_add_u32 s54, s54, s49
    s_lshl_b32 s53, s53, 10
    s_add_u32 m0, s52, 5120
    s_nop 0
    buffer_load_dwordx4 v148, s[68:71], s54 offen lds
    s_add_u32 m0, m0, 1024
    s_nop 0
    buffer_load_dwordx4 v149, s[68:71], s54 offen lds
    s_add_u32 m0, m0, 1024
    s_nop 0
    buffer_load_dwordx4 v150, s[68:71], s54 offen lds
    s_add_u32 m0, m0, 1024
    s_nop 0
    buffer_load_dwordx4 v151, s[68:71], s54 offen lds
    s_add_u32 m0, m0, 1024
    s_nop 0
    buffer_load_dwordx4 v152, s[68:71], s54 offen lds
    s_add_u32 s51, s60, s53
    buffer_load_dwordx4 v[108:111], v6, s[36:39], s51 offen
    s_add_u32 s51, s61, s53
    buffer_load_dwordx4 v[112:115], v6, s[36:39], s51 offen
    s_add_u32 s51, s62, s53
    buffer_load_dwordx4 v[116:119], v6, s[36:39], s51 offen
    s_add_u32 s51, s63, s53
    buffer_load_dwordx4 v[120:123], v6, s[36:39], s51 offen
    s_waitcnt vmcnt(9)
    ds_read_b64_tr_b16 v[124:125], v153 offset:0
    ds_read_b64_tr_b16 v[126:127], v153 offset:2560
    ds_read_b64_tr_b16 v[128:129], v153 offset:32
    ds_read_b64_tr_b16 v[130:131], v153 offset:2592
    ds_read_b64_tr_b16 v[132:133], v153 offset:64
    ds_read_b64_tr_b16 v[134:135], v153 offset:2624
    ds_read_b64_tr_b16 v[136:137], v153 offset:96
    ds_read_b64_tr_b16 v[138:139], v153 offset:2656
    ds_read_b64_tr_b16 v[140:141], v153 offset:128
    ds_read_b64_tr_b16 v[142:143], v153 offset:2688
    s_waitcnt lgkmcnt(8)
    v_mfma_f32_16x16x32_bf16 v[12:15], v[124:127], v[92:95], v[12:15]
    v_mfma_f32_16x16x32_bf16 v[32:35], v[124:127], v[96:99], v[32:35]
    v_mfma_f32_16x16x32_bf16 v[52:55], v[124:127], v[100:103], v[52:55]
    v_mfma_f32_16x16x32_bf16 v[72:75], v[124:127], v[104:107], v[72:75]
    s_waitcnt lgkmcnt(6)
    v_mfma_f32_16x16x32_bf16 v[16:19], v[128:131], v[92:95], v[16:19]
    v_mfma_f32_16x16x32_bf16 v[36:39], v[128:131], v[96:99], v[36:39]
    v_mfma_f32_16x16x32_bf16 v[56:59], v[128:131], v[100:103], v[56:59]
    v_mfma_f32_16x16x32_bf16 v[76:79], v[128:131], v[104:107], v[76:79]
    s_waitcnt lgkmcnt(4)
    v_mfma_f32_16x16x32_bf16 v[20:23], v[132:135], v[92:95], v[20:23]
    v_mfma_f32_16x16x32_bf16 v[40:43], v[132:135], v[96:99], v[40:43]
    v_mfma_f32_16x16x32_bf16 v[60:63], v[132:135], v[100:103], v[60:63]
    v_mfma_f32_16x16x32_bf16 v[80:83], v[132:135], v[104:107], v[80:83]
    s_waitcnt lgkmcnt(2)
    v_mfma_f32_16x16x32_bf16 v[24:27], v[136:139], v[92:95], v[24:27]
    v_mfma_f32_16x16x32_bf16 v[44:47], v[136:139], v[96:99], v[44:47]
    v_mfma_f32_16x16x32_bf16 v[64:67], v[136:139], v[100:103], v[64:67]
    v_mfma_f32_16x16x32_bf16 v[84:87], v[136:139], v[104:107], v[84:87]
    s_waitcnt lgkmcnt(0)
    v_mfma_f32_16x16x32_bf16 v[28:31], v[140:143], v[92:95], v[28:31]
    v_mfma_f32_16x16x32_bf16 v[48:51], v[140:143], v[96:99], v[48:51]
    v_mfma_f32_16x16x32_bf16 v[68:71], v[140:143], v[100:103], v[68:71]
    v_mfma_f32_16x16x32_bf16 v[88:91], v[140:143], v[104:107], v[88:91]
    s_waitcnt vmcnt(0)
    ds_read_b64_tr_b16 v[124:125], v153 offset:5120
    ds_read_b64_tr_b16 v[126:127], v153 offset:7680
    ds_read_b64_tr_b16 v[128:129], v153 offset:5152
    ds_read_b64_tr_b16 v[130:131], v153 offset:7712
    ds_read_b64_tr_b16 v[132:133], v153 offset:5184
    ds_read_b64_tr_b16 v[134:135], v153 offset:7744
    ds_read_b64_tr_b16 v[136:137], v153 offset:5216
    ds_read_b64_tr_b16 v[138:139], v153 offset:7776
    ds_read_b64_tr_b16 v[140:141], v153 offset:5248
    ds_read_b64_tr_b16 v[142:143], v153 offset:7808
    s_waitcnt lgkmcnt(8)
    v_mfma_f32_16x16x32_bf16 v[12:15], v[124:127], v[108:111], v[12:15]
    v_mfma_f32_16x16x32_bf16 v[32:35], v[124:127], v[112:115], v[32:35]
    v_mfma_f32_16x16x32_bf16 v[52:55], v[124:127], v[116:119], v[52:55]
    v_mfma_f32_16x16x32_bf16 v[72:75], v[124:127], v[120:123], v[72:75]
    s_waitcnt lgkmcnt(6)
    v_mfma_f32_16x16x32_bf16 v[16:19], v[128:131], v[108:111], v[16:19]
    v_mfma_f32_16x16x32_bf16 v[36:39], v[128:131], v[112:115], v[36:39]
    v_mfma_f32_16x16x32_bf16 v[56:59], v[128:131], v[116:119], v[56:59]
    v_mfma_f32_16x16x32_bf16 v[76:79], v[128:131], v[120:123], v[76:79]
    s_waitcnt lgkmcnt(4)
    v_mfma_f32_16x16x32_bf16 v[20:23], v[132:135], v[108:111], v[20:23]
    v_mfma_f32_16x16x32_bf16 v[40:43], v[132:135], v[112:115], v[40:43]
    v_mfma_f32_16x16x32_bf16 v[60:63], v[132:135], v[116:119], v[60:63]
    v_mfma_f32_16x16x32_bf16 v[80:83], v[132:135], v[120:123], v[80:83]
    s_waitcnt lgkmcnt(2)
    v_mfma_f32_16x16x32_bf16 v[24:27], v[136:139], v[108:111], v[24:27]
    v_mfma_f32_16x16x32_bf16 v[44:47], v[136:139], v[112:115], v[44:47]
    v_mfma_f32_16x16x32_bf16 v[64:67], v[136:139], v[116:119], v[64:67]
    v_mfma_f32_16x16x32_bf16 v[84:87], v[136:139], v[120:123], v[84:87]
    s_waitcnt lgkmcnt(0)
    v_mfma_f32_16x16x32_bf16 v[28:31], v[140:143], v[108:111], v[28:31]
    v_mfma_f32_16x16x32_bf16 v[48:51], v[140:143], v[112:115], v[48:51]
    v_mfma_f32_16x16x32_bf16 v[68:71], v[140:143], v[116:119], v[68:71]
    v_mfma_f32_16x16x32_bf16 v[88:91], v[140:143], v[120:123], v[88:91]
    buffer_load_dwordx2 v[108:109], v8, s[16:19], 0 offen offset:0
    buffer_load_dwordx2 v[110:111], v8, s[16:19], 0 offen offset:32
    buffer_load_dwordx2 v[112:113], v8, s[16:19], 0 offen offset:64
    buffer_load_dwordx2 v[114:115], v8, s[16:19], 0 offen offset:96
    buffer_load_dwordx2 v[116:117], v8, s[16:19], 0 offen offset:128
    buffer_load_dwordx2 v[118:119], v9, s[20:23], 0 offen offset:0
    buffer_load_dwordx2 v[120:121], v9, s[20:23], 0 offen offset:32
    buffer_load_dwordx2 v[122:123], v9, s[20:23], 0 offen offset:64
    buffer_load_dwordx2 v[124:125], v9, s[20:23], 0 offen offset:96
    buffer_load_dwordx2 v[126:127], v9, s[20:23], 0 offen offset:128
    s_add_u32 s49, s48, 1
    s_and_b32 s49, s49, 3
    s_mul_i32 s49, s49, 9216
    s_add_u32 s49, s49, 0
    v_add_u32 v2, s49, v6
    s_add_u32 s49, s48, 2
    s_and_b32 s49, s49, 3
    s_mul_i32 s49, s49, 9216
    s_add_u32 s49, s49, 3072
    v_add_u32 v3, s49, v6
    s_add_u32 s49, s48, 3
    s_and_b32 s49, s49, 3
    s_mul_i32 s49, s49, 9216
    s_add_u32 s49, s49, 6144
    v_add_u32 v4, s49, v6
    s_nop 4
    s_barrier
    ds_write_b128 v2, v[32:35] offset:0
    ds_write_b128 v2, v[36:39] offset:1024
    ds_write_b128 v2, v[40:43] offset:2048
    ds_write_b128 v3, v[52:55] offset:0
    ds_write_b128 v3, v[56:59] offset:1024
    ds_write_b128 v3, v[60:63] offset:2048
    ds_write_b128 v4, v[72:75] offset:0
    ds_write_b128 v4, v[76:79] offset:1024
    ds_write_b128 v4, v[80:83] offset:2048
    s_mul_i32 s49, s48, 9216
    s_waitcnt lgkmcnt(0)
    s_barrier
    v_add_u32 v2, s49, v6
    ds_read_b128 v[32:35], v2 offset:0
    ds_read_b128 v[36:39], v2 offset:1024
    ds_read_b128 v[40:43], v2 offset:2048
    ds_read_b128 v[52:55], v2 offset:3072
    ds_read_b128 v[56:59], v2 offset:4096
    ds_read_b128 v[60:63], v2 offset:5120
    ds_read_b128 v[72:75], v2 offset:6144
    ds_read_b128 v[76:79], v2 offset:7168
    ds_read_b128 v[80:83], v2 offset:8192
    s_waitcnt lgkmcnt(0)
    s_add_u32 s49, s48, 1
    s_and_b32 s49, s49, 3
    s_mul_i32 s49, s49, 6144
    s_add_u32 s49, s49, 0
    v_add_u32 v2, s49, v6
    s_add_u32 s49, s48, 2
    s_and_b32 s49, s49, 3
    s_mul_i32 s49, s49, 6144
    s_add_u32 s49, s49, 2048
    v_add_u32 v3, s49, v6
    s_add_u32 s49, s48, 3
    s_and_b32 s49, s49, 3
    s_mul_i32 s49, s49, 6144
    s_add_u32 s49, s49, 4096
    v_add_u32 v4, s49, v6
    s_barrier
    ds_write_b128 v2, v[44:47] offset:0
    ds_write_b128 v2, v[48:51] offset:1024
    ds_write_b128 v3, v[64:67] offset:0
    ds_write_b128 v3, v[68:71] offset:1024
    ds_write_b128 v4, v[84:87] offset:0
    ds_write_b128 v4, v[88:91] offset:1024
    s_mul_i32 s49, s48, 6144
    s_waitcnt lgkmcnt(0)
    s_barrier
    v_add_u32 v2, s49, v6
    ds_read_b128 v[44:47], v2 offset:0
    ds_read_b128 v[48:51], v2 offset:1024
    ds_read_b128 v[64:67], v2 offset:2048
    ds_read_b128 v[68:71], v2 offset:3072
    ds_read_b128 v[84:87], v2 offset:4096
    ds_read_b128 v[88:91], v2 offset:5120
    s_waitcnt lgkmcnt(0)
    v_pk_add_f32 v[12:13], v[12:13], v[32:33]
    v_pk_add_f32 v[52:53], v[52:53], v[72:73]
    v_pk_add_f32 v[14:15], v[14:15], v[34:35]
    v_pk_add_f32 v[54:55], v[54:55], v[74:75]
    v_pk_add_f32 v[12:13], v[12:13], v[52:53]
    v_pk_add_f32 v[14:15], v[14:15], v[54:55]
    v_pk_add_f32 v[16:17], v[16:17], v[36:37]
    v_pk_add_f32 v[56:57], v[56:57], v[76:77]
    v_pk_add_f32 v[18:19], v[18:19], v[38:39]
    v_pk_add_f32 v[58:59], v[58:59], v[78:79]
    v_pk_add_f32 v[16:17], v[16:17], v[56:57]
    v_pk_add_f32 v[18:19], v[18:19], v[58:59]
    v_pk_add_f32 v[20:21], v[20:21], v[40:41]
    v_pk_add_f32 v[60:61], v[60:61], v[80:81]
    v_pk_add_f32 v[22:23], v[22:23], v[42:43]
    v_pk_add_f32 v[62:63], v[62:63], v[82:83]
    v_pk_add_f32 v[20:21], v[20:21], v[60:61]
    v_pk_add_f32 v[22:23], v[22:23], v[62:63]
    v_pk_add_f32 v[24:25], v[24:25], v[44:45]
    v_pk_add_f32 v[64:65], v[64:65], v[84:85]
    v_pk_add_f32 v[26:27], v[26:27], v[46:47]
    v_pk_add_f32 v[66:67], v[66:67], v[86:87]
    v_pk_add_f32 v[24:25], v[24:25], v[64:65]
    v_pk_add_f32 v[26:27], v[26:27], v[66:67]
    v_pk_add_f32 v[28:29], v[28:29], v[48:49]
    v_pk_add_f32 v[68:69], v[68:69], v[88:89]
    v_pk_add_f32 v[30:31], v[30:31], v[50:51]
    v_pk_add_f32 v[70:71], v[70:71], v[90:91]
    v_pk_add_f32 v[28:29], v[28:29], v[68:69]
    v_pk_add_f32 v[30:31], v[30:31], v[70:71]
    s_waitcnt vmcnt(0)
    v_lshlrev_b32 v100, 16, v108
    v_and_b32 v101, 0xffff0000, v108
    v_lshlrev_b32 v102, 16, v109
    v_and_b32 v103, 0xffff0000, v109
    v_pk_add_f32 v[12:13], v[12:13], v[100:101]
    v_pk_add_f32 v[14:15], v[14:15], v[102:103]
    v_lshlrev_b32 v100, 16, v118
    v_and_b32 v101, 0xffff0000, v118
    v_lshlrev_b32 v102, 16, v119
    v_and_b32 v103, 0xffff0000, v119
    v_pk_add_f32 v[12:13], v[12:13], v[100:101]
    v_pk_add_f32 v[14:15], v[14:15], v[102:103]
    v_lshlrev_b32 v100, 16, v110
    v_and_b32 v101, 0xffff0000, v110
    v_lshlrev_b32 v102, 16, v111
    v_and_b32 v103, 0xffff0000, v111
    v_pk_add_f32 v[16:17], v[16:17], v[100:101]
    v_pk_add_f32 v[18:19], v[18:19], v[102:103]
    v_lshlrev_b32 v100, 16, v120
    v_and_b32 v101, 0xffff0000, v120
    v_lshlrev_b32 v102, 16, v121
    v_and_b32 v103, 0xffff0000, v121
    v_pk_add_f32 v[16:17], v[16:17], v[100:101]
    v_pk_add_f32 v[18:19], v[18:19], v[102:103]
    v_lshlrev_b32 v100, 16, v112
    v_and_b32 v101, 0xffff0000, v112
    v_lshlrev_b32 v102, 16, v113
    v_and_b32 v103, 0xffff0000, v113
    v_pk_add_f32 v[20:21], v[20:21], v[100:101]
    v_pk_add_f32 v[22:23], v[22:23], v[102:103]
    v_lshlrev_b32 v100, 16, v122
    v_and_b32 v101, 0xffff0000, v122
    v_lshlrev_b32 v102, 16, v123
    v_and_b32 v103, 0xffff0000, v123
    v_pk_add_f32 v[20:21], v[20:21], v[100:101]
    v_pk_add_f32 v[22:23], v[22:23], v[102:103]
    v_lshlrev_b32 v100, 16, v114
    v_and_b32 v101, 0xffff0000, v114
    v_lshlrev_b32 v102, 16, v115
    v_and_b32 v103, 0xffff0000, v115
    v_pk_add_f32 v[24:25], v[24:25], v[100:101]
    v_pk_add_f32 v[26:27], v[26:27], v[102:103]
    v_lshlrev_b32 v100, 16, v124
    v_and_b32 v101, 0xffff0000, v124
    v_lshlrev_b32 v102, 16, v125
    v_and_b32 v103, 0xffff0000, v125
    v_pk_add_f32 v[24:25], v[24:25], v[100:101]
    v_pk_add_f32 v[26:27], v[26:27], v[102:103]
    v_lshlrev_b32 v100, 16, v116
    v_and_b32 v101, 0xffff0000, v116
    v_lshlrev_b32 v102, 16, v117
    v_and_b32 v103, 0xffff0000, v117
    v_pk_add_f32 v[28:29], v[28:29], v[100:101]
    v_pk_add_f32 v[30:31], v[30:31], v[102:103]
    v_lshlrev_b32 v100, 16, v126
    v_and_b32 v101, 0xffff0000, v126
    v_lshlrev_b32 v102, 16, v127
    v_and_b32 v103, 0xffff0000, v127
    v_pk_add_f32 v[28:29], v[28:29], v[100:101]
    v_pk_add_f32 v[30:31], v[30:31], v[102:103]
    s_nop 1
    s_lshl_b32 s53, s48, 2
    s_add_u32 s53, s53, 0
    s_mul_i32 s54, s33, 20
    s_add_u32 s54, s54, s53
    s_mul_i32 s54, s54, 5120
    buffer_load_dwordx4 v[108:111], v6, s[40:43], s54 offen offset:0
    buffer_load_dwordx4 v[112:115], v6, s[40:43], s54 offen offset:1024
    buffer_load_dwordx4 v[116:119], v6, s[40:43], s54 offen offset:2048
    buffer_load_dwordx4 v[120:123], v6, s[40:43], s54 offen offset:3072
    buffer_load_dwordx4 v[124:127], v7, s[40:43], s54 offen
    s_lshl_b32 s53, s48, 2
    s_add_u32 s53, s53, 1
    s_mul_i32 s54, s33, 20
    s_add_u32 s54, s54, s53
    s_mul_i32 s54, s54, 5120
    buffer_load_dwordx4 v[144:147], v6, s[40:43], s54 offen offset:0
    buffer_load_dwordx4 v[148:151], v6, s[40:43], s54 offen offset:1024
    buffer_load_dwordx4 v[152:155], v6, s[40:43], s54 offen offset:2048
    buffer_load_dwordx4 v[156:159], v6, s[40:43], s54 offen offset:3072
    buffer_load_dwordx4 v[160:163], v7, s[40:43], s54 offen
    s_cmp_lg_u32 s48, 0
    s_cbranch_scc1 .pskip_51
    s_lshr_b32 s49, s32, 1
    s_lshl_b32 s49, s49, 8
    v_mov_b32 v2, s49
.poll_52:
    s_mov_b64 exec, 1
    buffer_load_dword v3, v2, s[44:47], 0 offen sc1
    s_mov_b64 exec, -1
    s_waitcnt vmcnt(0)
    v_readfirstlane_b32 s50, v3
    s_nop 3
    s_cmp_ge_u32 s50, 32
    s_cbranch_scc1 .pok_53
    s_sleep 12
    s_branch .poll_52
.pok_53:
.pskip_51:
    s_barrier
    s_lshl_b32 s53, s48, 2
    s_add_u32 s53, s53, 0
    s_lshl_b32 s53, s53, 10
    s_add_u32 s51, s56, s53
    buffer_load_dwordx4 v[92:95], v6, s[28:31], s51 offen sc1
    s_add_u32 s51, s57, s53
    buffer_load_dwordx4 v[96:99], v6, s[28:31], s51 offen sc1
    s_add_u32 s51, s58, s53
    buffer_load_dwordx4 v[100:103], v6, s[28:31], s51 offen sc1
    s_add_u32 s51, s59, s53
    buffer_load_dwordx4 v[104:107], v6, s[28:31], s51 offen sc1
    s_lshl_b32 s53, s48, 2
    s_add_u32 s53, s53, 1
    s_lshl_b32 s53, s53, 10
    s_add_u32 s51, s56, s53
    buffer_load_dwordx4 v[128:131], v6, s[28:31], s51 offen sc1
    s_add_u32 s51, s57, s53
    buffer_load_dwordx4 v[132:135], v6, s[28:31], s51 offen sc1
    s_add_u32 s51, s58, s53
    buffer_load_dwordx4 v[136:139], v6, s[28:31], s51 offen sc1
    s_add_u32 s51, s59, s53
    buffer_load_dwordx4 v[140:143], v6, s[28:31], s51 offen sc1
    s_waitcnt vmcnt(4)
    v_mfma_f32_16x16x32_bf16 v[12:15], v[108:111], v[92:95], v[12:15]
    v_mfma_f32_16x16x32_bf16 v[32:35], v[108:111], v[96:99], 0
    v_mfma_f32_16x16x32_bf16 v[52:55], v[108:111], v[100:103], 0
    v_mfma_f32_16x16x32_bf16 v[72:75], v[108:111], v[104:107], 0
    v_mfma_f32_16x16x32_bf16 v[16:19], v[112:115], v[92:95], v[16:19]
    v_mfma_f32_16x16x32_bf16 v[36:39], v[112:115], v[96:99], 0
    v_mfma_f32_16x16x32_bf16 v[56:59], v[112:115], v[100:103], 0
    v_mfma_f32_16x16x32_bf16 v[76:79], v[112:115], v[104:107], 0
    v_mfma_f32_16x16x32_bf16 v[20:23], v[116:119], v[92:95], v[20:23]
    v_mfma_f32_16x16x32_bf16 v[40:43], v[116:119], v[96:99], 0
    v_mfma_f32_16x16x32_bf16 v[60:63], v[116:119], v[100:103], 0
    v_mfma_f32_16x16x32_bf16 v[80:83], v[116:119], v[104:107], 0
    v_mfma_f32_16x16x32_bf16 v[24:27], v[120:123], v[92:95], v[24:27]
    v_mfma_f32_16x16x32_bf16 v[44:47], v[120:123], v[96:99], 0
    v_mfma_f32_16x16x32_bf16 v[64:67], v[120:123], v[100:103], 0
    v_mfma_f32_16x16x32_bf16 v[84:87], v[120:123], v[104:107], 0
    v_mfma_f32_16x16x32_bf16 v[28:31], v[124:127], v[92:95], v[28:31]
    v_mfma_f32_16x16x32_bf16 v[48:51], v[124:127], v[96:99], 0
    v_mfma_f32_16x16x32_bf16 v[68:71], v[124:127], v[100:103], 0
    v_mfma_f32_16x16x32_bf16 v[88:91], v[124:127], v[104:107], 0
    s_lshl_b32 s53, s48, 2
    s_add_u32 s53, s53, 2
    s_lshl_b32 s53, s53, 10
    s_add_u32 s51, s56, s53
    buffer_load_dwordx4 v[92:95], v6, s[28:31], s51 offen sc1
    s_add_u32 s51, s57, s53
    buffer_load_dwordx4 v[96:99], v6, s[28:31], s51 offen sc1
    s_add_u32 s51, s58, s53
    buffer_load_dwordx4 v[100:103], v6, s[28:31], s51 offen sc1
    s_add_u32 s51, s59, s53
    buffer_load_dwordx4 v[104:107], v6, s[28:31], s51 offen sc1
    s_lshl_b32 s53, s48, 2
    s_add_u32 s53, s53, 2
    s_mul_i32 s54, s33, 20
    s_add_u32 s54, s54, s53
    s_mul_i32 s54, s54, 5120
    buffer_load_dwordx4 v[108:111], v6, s[40:43], s54 offen offset:0
    buffer_load_dwordx4 v[112:115], v6, s[40:43], s54 offen offset:1024
    buffer_load_dwordx4 v[116:119], v6, s[40:43], s54 offen offset:2048
    buffer_load_dwordx4 v[120:123], v6, s[40:43], s54 offen offset:3072
    buffer_load_dwordx4 v[124:127], v7, s[40:43], s54 offen
    s_waitcnt vmcnt(9)
    v_mfma_f32_16x16x32_bf16 v[12:15], v[144:147], v[128:131], v[12:15]
    v_mfma_f32_16x16x32_bf16 v[32:35], v[144:147], v[132:135], v[32:35]
    v_mfma_f32_16x16x32_bf16 v[52:55], v[144:147], v[136:139], v[52:55]
    v_mfma_f32_16x16x32_bf16 v[72:75], v[144:147], v[140:143], v[72:75]
    v_mfma_f32_16x16x32_bf16 v[16:19], v[148:151], v[128:131], v[16:19]
    v_mfma_f32_16x16x32_bf16 v[36:39], v[148:151], v[132:135], v[36:39]
    v_mfma_f32_16x16x32_bf16 v[56:59], v[148:151], v[136:139], v[56:59]
    v_mfma_f32_16x16x32_bf16 v[76:79], v[148:151], v[140:143], v[76:79]
    v_mfma_f32_16x16x32_bf16 v[20:23], v[152:155], v[128:131], v[20:23]
    v_mfma_f32_16x16x32_bf16 v[40:43], v[152:155], v[132:135], v[40:43]
    v_mfma_f32_16x16x32_bf16 v[60:63], v[152:155], v[136:139], v[60:63]
    v_mfma_f32_16x16x32_bf16 v[80:83], v[152:155], v[140:143], v[80:83]
    v_mfma_f32_16x16x32_bf16 v[24:27], v[156:159], v[128:131], v[24:27]
    v_mfma_f32_16x16x32_bf16 v[44:47], v[156:159], v[132:135], v[44:47]
    v_mfma_f32_16x16x32_bf16 v[64:67], v[156:159], v[136:139], v[64:67]
    v_mfma_f32_16x16x32_bf16 v[84:87], v[156:159], v[140:143], v[84:87]
    v_mfma_f32_16x16x32_bf16 v[28:31], v[160:163], v[128:131], v[28:31]
    v_mfma_f32_16x16x32_bf16 v[48:51], v[160:163], v[132:135], v[48:51]
    v_mfma_f32_16x16x32_bf16 v[68:71], v[160:163], v[136:139], v[68:71]
    v_mfma_f32_16x16x32_bf16 v[88:91], v[160:163], v[140:143], v[88:91]
    s_lshl_b32 s53, s48, 2
    s_add_u32 s53, s53, 3
    s_lshl_b32 s53, s53, 10
    s_add_u32 s51, s56, s53
    buffer_load_dwordx4 v[128:131], v6, s[28:31], s51 offen sc1
    s_add_u32 s51, s57, s53
    buffer_load_dwordx4 v[132:135], v6, s[28:31], s51 offen sc1
    s_add_u32 s51, s58, s53
    buffer_load_dwordx4 v[136:139], v6, s[28:31], s51 offen sc1
    s_add_u32 s51, s59, s53
    buffer_load_dwordx4 v[140:143], v6, s[28:31], s51 offen sc1
    s_lshl_b32 s53, s48, 2
    s_add_u32 s53, s53, 3
    s_mul_i32 s54, s33, 20
    s_add_u32 s54, s54, s53
    s_mul_i32 s54, s54, 5120
    buffer_load_dwordx4 v[144:147], v6, s[40:43], s54 offen offset:0
    buffer_load_dwordx4 v[148:151], v6, s[40:43], s54 offen offset:1024
    buffer_load_dwordx4 v[152:155], v6, s[40:43], s54 offen offset:2048
    buffer_load_dwordx4 v[156:159], v6, s[40:43], s54 offen offset:3072
    buffer_load_dwordx4 v[160:163], v7, s[40:43], s54 offen
    s_waitcnt vmcnt(9)
    v_mfma_f32_16x16x32_bf16 v[12:15], v[108:111], v[92:95], v[12:15]
    v_mfma_f32_16x16x32_bf16 v[32:35], v[108:111], v[96:99], v[32:35]
    v_mfma_f32_16x16x32_bf16 v[52:55], v[108:111], v[100:103], v[52:55]
    v_mfma_f32_16x16x32_bf16 v[72:75], v[108:111], v[104:107], v[72:75]
    v_mfma_f32_16x16x32_bf16 v[16:19], v[112:115], v[92:95], v[16:19]
    v_mfma_f32_16x16x32_bf16 v[36:39], v[112:115], v[96:99], v[36:39]
    v_mfma_f32_16x16x32_bf16 v[56:59], v[112:115], v[100:103], v[56:59]
    v_mfma_f32_16x16x32_bf16 v[76:79], v[112:115], v[104:107], v[76:79]
    v_mfma_f32_16x16x32_bf16 v[20:23], v[116:119], v[92:95], v[20:23]
    v_mfma_f32_16x16x32_bf16 v[40:43], v[116:119], v[96:99], v[40:43]
    v_mfma_f32_16x16x32_bf16 v[60:63], v[116:119], v[100:103], v[60:63]
    v_mfma_f32_16x16x32_bf16 v[80:83], v[116:119], v[104:107], v[80:83]
    v_mfma_f32_16x16x32_bf16 v[24:27], v[120:123], v[92:95], v[24:27]
    v_mfma_f32_16x16x32_bf16 v[44:47], v[120:123], v[96:99], v[44:47]
    v_mfma_f32_16x16x32_bf16 v[64:67], v[120:123], v[100:103], v[64:67]
    v_mfma_f32_16x16x32_bf16 v[84:87], v[120:123], v[104:107], v[84:87]
    v_mfma_f32_16x16x32_bf16 v[28:31], v[124:127], v[92:95], v[28:31]
    v_mfma_f32_16x16x32_bf16 v[48:51], v[124:127], v[96:99], v[48:51]
    v_mfma_f32_16x16x32_bf16 v[68:71], v[124:127], v[100:103], v[68:71]
    v_mfma_f32_16x16x32_bf16 v[88:91], v[124:127], v[104:107], v[88:91]
    s_add_u32 s53, s48, 16
    s_lshl_b32 s53, s53, 10
    s_add_u32 s51, s56, s53
    buffer_load_dwordx4 v[92:95], v6, s[28:31], s51 offen sc1
    s_add_u32 s51, s57, s53
    buffer_load_dwordx4 v[96:99], v6, s[28:31], s51 offen sc1
    s_add_u32 s51, s58, s53
    buffer_load_dwordx4 v[100:103], v6, s[28:31], s51 offen sc1
    s_add_u32 s51, s59, s53
    buffer_load_dwordx4 v[104:107], v6, s[28:31], s51 offen sc1
    s_add_u32 s53, s48, 16
    s_mul_i32 s54, s33, 20
    s_add_u32 s54, s54, s53
    s_mul_i32 s54, s54, 5120
    buffer_load_dwordx4 v[108:111], v6, s[40:43], s54 offen offset:0
    buffer_load_dwordx4 v[112:115], v6, s[40:43], s54 offen offset:1024
    buffer_load_dwordx4 v[116:119], v6, s[40:43], s54 offen offset:2048
    buffer_load_dwordx4 v[120:123], v6, s[40:43], s54 offen offset:3072
    buffer_load_dwordx4 v[124:127], v7, s[40:43], s54 offen
    s_waitcnt vmcnt(9)
    v_mfma_f32_16x16x32_bf16 v[12:15], v[144:147], v[128:131], v[12:15]
    v_mfma_f32_16x16x32_bf16 v[32:35], v[144:147], v[132:135], v[32:35]
    v_mfma_f32_16x16x32_bf16 v[52:55], v[144:147], v[136:139], v[52:55]
    v_mfma_f32_16x16x32_bf16 v[72:75], v[144:147], v[140:143], v[72:75]
    v_mfma_f32_16x16x32_bf16 v[16:19], v[148:151], v[128:131], v[16:19]
    v_mfma_f32_16x16x32_bf16 v[36:39], v[148:151], v[132:135], v[36:39]
    v_mfma_f32_16x16x32_bf16 v[56:59], v[148:151], v[136:139], v[56:59]
    v_mfma_f32_16x16x32_bf16 v[76:79], v[148:151], v[140:143], v[76:79]
    v_mfma_f32_16x16x32_bf16 v[20:23], v[152:155], v[128:131], v[20:23]
    v_mfma_f32_16x16x32_bf16 v[40:43], v[152:155], v[132:135], v[40:43]
    v_mfma_f32_16x16x32_bf16 v[60:63], v[152:155], v[136:139], v[60:63]
    v_mfma_f32_16x16x32_bf16 v[80:83], v[152:155], v[140:143], v[80:83]
    v_mfma_f32_16x16x32_bf16 v[24:27], v[156:159], v[128:131], v[24:27]
    v_mfma_f32_16x16x32_bf16 v[44:47], v[156:159], v[132:135], v[44:47]
    v_mfma_f32_16x16x32_bf16 v[64:67], v[156:159], v[136:139], v[64:67]
    v_mfma_f32_16x16x32_bf16 v[84:87], v[156:159], v[140:143], v[84:87]
    v_mfma_f32_16x16x32_bf16 v[28:31], v[160:163], v[128:131], v[28:31]
    v_mfma_f32_16x16x32_bf16 v[48:51], v[160:163], v[132:135], v[48:51]
    v_mfma_f32_16x16x32_bf16 v[68:71], v[160:163], v[136:139], v[68:71]
    v_mfma_f32_16x16x32_bf16 v[88:91], v[160:163], v[140:143], v[88:91]
    s_waitcnt vmcnt(0)
    v_mfma_f32_16x16x32_bf16 v[12:15], v[108:111], v[92:95], v[12:15]
    v_mfma_f32_16x16x32_bf16 v[32:35], v[108:111], v[96:99], v[32:35]
    v_mfma_f32_16x16x32_bf16 v[52:55], v[108:111], v[100:103], v[52:55]
    v_mfma_f32_16x16x32_bf16 v[72:75], v[108:111], v[104:107], v[72:75]
    v_mfma_f32_16x16x32_bf16 v[16:19], v[112:115], v[92:95], v[16:19]
    v_mfma_f32_16x16x32_bf16 v[36:39], v[112:115], v[96:99], v[36:39]
    v_mfma_f32_16x16x32_bf16 v[56:59], v[112:115], v[100:103], v[56:59]
    v_mfma_f32_16x16x32_bf16 v[76:79], v[112:115], v[104:107], v[76:79]
    v_mfma_f32_16x16x32_bf16 v[20:23], v[116:119], v[92:95], v[20:23]
    v_mfma_f32_16x16x32_bf16 v[40:43], v[116:119], v[96:99], v[40:43]
    v_mfma_f32_16x16x32_bf16 v[60:63], v[116:119], v[100:103], v[60:63]
    v_mfma_f32_16x16x32_bf16 v[80:83], v[116:119], v[104:107], v[80:83]
    v_mfma_f32_16x16x32_bf16 v[24:27], v[120:123], v[92:95], v[24:27]
    v_mfma_f32_16x16x32_bf16 v[44:47], v[120:123], v[96:99], v[44:47]
    v_mfma_f32_16x16x32_bf16 v[64:67], v[120:123], v[100:103], v[64:67]
    v_mfma_f32_16x16x32_bf16 v[84:87], v[120:123], v[104:107], v[84:87]
    v_mfma_f32_16x16x32_bf16 v[28:31], v[124:127], v[92:95], v[28:31]
    v_mfma_f32_16x16x32_bf16 v[48:51], v[124:127], v[96:99], v[48:51]
    v_mfma_f32_16x16x32_bf16 v[68:71], v[124:127], v[100:103], v[68:71]
    v_mfma_f32_16x16x32_bf16 v[88:91], v[124:127], v[104:107], v[88:91]
    s_add_u32 s49, s48, 1
    s_and_b32 s49, s49, 3
    s_mul_i32 s49, s49, 9216
    s_add_u32 s49, s49, 0
    v_add_u32 v2, s49, v6
    s_add_u32 s49, s48, 2
    s_and_b32 s49, s49, 3
    s_mul_i32 s49, s49, 9216
    s_add_u32 s49, s49, 3072
    v_add_u32 v3, s49, v6
    s_add_u32 s49, s48, 3
    s_and_b32 s49, s49, 3
    s_mul_i32 s49, s49, 9216
    s_add_u32 s49, s49, 6144
    v_add_u32 v4, s49, v6
    s_nop 4
    ds_write_b128 v2, v[32:35] offset:0
    ds_write_b128 v2, v[36:39] offset:1024
    ds_write_b128 v2, v[40:43] offset:2048
    ds_write_b128 v3, v[52:55] offset:0
    ds_write_b128 v3, v[56:59] offset:1024
    ds_write_b128 v3, v[60:63] offset:2048
    ds_write_b128 v4, v[72:75] offset:0
    ds_write_b128 v4, v[76:79] offset:1024
    ds_write_b128 v4, v[80:83] offset:2048
    s_mul_i32 s49, s48, 9216
    s_waitcnt lgkmcnt(0)
    s_barrier
    v_add_u32 v2, s49, v6
    ds_read_b128 v[32:35], v2 offset:0
    ds_read_b128 v[36:39], v2 offset:1024
    ds_read_b128 v[40:43], v2 offset:2048
    ds_read_b128 v[52:55], v2 offset:3072
    ds_read_b128 v[56:59], v2 offset:4096
    ds_read_b128 v[60:63], v2 offset:5120
    ds_read_b128 v[72:75], v2 offset:6144
    ds_read_b128 v[76:79], v2 offset:7168
    ds_read_b128 v[80:83], v2 offset:8192
    s_waitcnt lgkmcnt(0)
    s_add_u32 s49, s48, 1
    s_and_b32 s49, s49, 3
    s_mul_i32 s49, s49, 6144
    s_add_u32 s49, s49, 0
    v_add_u32 v2, s49, v6
    s_add_u32 s49, s48, 2
    s_and_b32 s49, s49, 3
    s_mul_i32 s49, s49, 6144
    s_add_u32 s49, s49, 2048
    v_add_u32 v3, s49, v6
    s_add_u32 s49, s48, 3
    s_and_b32 s49, s49, 3
    s_mul_i32 s49, s49, 6144
    s_add_u32 s49, s49, 4096
    v_add_u32 v4, s49, v6
    s_barrier
    ds_write_b128 v2, v[44:47] offset:0
    ds_write_b128 v2, v[48:51] offset:1024
    ds_write_b128 v3, v[64:67] offset:0
    ds_write_b128 v3, v[68:71] offset:1024
    ds_write_b128 v4, v[84:87] offset:0
    ds_write_b128 v4, v[88:91] offset:1024
    s_mul_i32 s49, s48, 6144
    s_waitcnt lgkmcnt(0)
    s_barrier
    v_add_u32 v2, s49, v6
    ds_read_b128 v[44:47], v2 offset:0
    ds_read_b128 v[48:51], v2 offset:1024
    ds_read_b128 v[64:67], v2 offset:2048
    ds_read_b128 v[68:71], v2 offset:3072
    ds_read_b128 v[84:87], v2 offset:4096
    ds_read_b128 v[88:91], v2 offset:5120
    s_waitcnt lgkmcnt(0)
    v_pk_add_f32 v[12:13], v[12:13], v[32:33]
    v_pk_add_f32 v[52:53], v[52:53], v[72:73]
    v_pk_add_f32 v[14:15], v[14:15], v[34:35]
    v_pk_add_f32 v[54:55], v[54:55], v[74:75]
    v_pk_add_f32 v[12:13], v[12:13], v[52:53]
    v_pk_add_f32 v[14:15], v[14:15], v[54:55]
    v_pk_add_f32 v[16:17], v[16:17], v[36:37]
    v_pk_add_f32 v[56:57], v[56:57], v[76:77]
    v_pk_add_f32 v[18:19], v[18:19], v[38:39]
    v_pk_add_f32 v[58:59], v[58:59], v[78:79]
    v_pk_add_f32 v[16:17], v[16:17], v[56:57]
    v_pk_add_f32 v[18:19], v[18:19], v[58:59]
    v_pk_add_f32 v[20:21], v[20:21], v[40:41]
    v_pk_add_f32 v[60:61], v[60:61], v[80:81]
    v_pk_add_f32 v[22:23], v[22:23], v[42:43]
    v_pk_add_f32 v[62:63], v[62:63], v[82:83]
    v_pk_add_f32 v[20:21], v[20:21], v[60:61]
    v_pk_add_f32 v[22:23], v[22:23], v[62:63]
    v_pk_add_f32 v[24:25], v[24:25], v[44:45]
    v_pk_add_f32 v[64:65], v[64:65], v[84:85]
    v_pk_add_f32 v[26:27], v[26:27], v[46:47]
    v_pk_add_f32 v[66:67], v[66:67], v[86:87]
    v_pk_add_f32 v[24:25], v[24:25], v[64:65]
    v_pk_add_f32 v[26:27], v[26:27], v[66:67]
    v_pk_add_f32 v[28:29], v[28:29], v[48:49]
    v_pk_add_f32 v[68:69], v[68:69], v[88:89]
    v_pk_add_f32 v[30:31], v[30:31], v[50:51]
    v_pk_add_f32 v[70:71], v[70:71], v[90:91]
    v_pk_add_f32 v[28:29], v[28:29], v[68:69]
    v_pk_add_f32 v[30:31], v[30:31], v[70:71]
    v_cvt_pk_bf16_f32 v92, v12, v13
    v_cvt_pk_bf16_f32 v93, v14, v15
    buffer_store_dwordx2 v[92:93], v8, s[24:27], 0 offen offset:0
    v_cvt_pk_bf16_f32 v94, v16, v17
    v_cvt_pk_bf16_f32 v95, v18, v19
    buffer_store_dwordx2 v[94:95], v8, s[24:27], 0 offen offset:32
    v_cvt_pk_bf16_f32 v92, v20, v21
    v_cvt_pk_bf16_f32 v93, v22, v23
    buffer_store_dwordx2 v[92:93], v8, s[24:27], 0 offen offset:64
    v_cvt_pk_bf16_f32 v94, v24, v25
    v_cvt_pk_bf16_f32 v95, v26, v27
    buffer_store_dwordx2 v[94:95], v8, s[24:27], 0 offen offset:96
    v_cvt_pk_bf16_f32 v92, v28, v29
    v_cvt_pk_bf16_f32 v93, v30, v31
    buffer_store_dwordx2 v[92:93], v8, s[24:27], 0 offen offset:128
    s_endpgm
.k2end_33:
    s_endpgm
.section .rodata,"a"
.p2align 6
.amdhsa_kernel k1_kernel
  .amdhsa_next_free_vgpr 250
  .amdhsa_next_free_sgpr 102
  .amdhsa_accum_offset 252
  .amdhsa_group_segment_fixed_size 0
  .amdhsa_kernarg_size 88
  .amdhsa_user_sgpr_count 2
  .amdhsa_user_sgpr_kernarg_segment_ptr 1
  .amdhsa_system_sgpr_workgroup_id_x 1
.end_amdhsa_kernel
.p2align 6
.amdhsa_kernel k2_kernel
  .amdhsa_next_free_vgpr 164
  .amdhsa_next_free_sgpr 102
  .amdhsa_accum_offset 164
  .amdhsa_group_segment_fixed_size 0
  .amdhsa_kernarg_size 88
  .amdhsa_user_sgpr_count 2
  .amdhsa_user_sgpr_kernarg_segment_ptr 1
  .amdhsa_system_sgpr_workgroup_id_x 1
.end_amdhsa_kernel
```
